```python
import torch

def _softmax(x, axis=-1):
    return torch.softmax(x, dim=axis)

def _gelu(x):
    return torch.nn.functional.gelu(x, approximate='tanh')

def _silu(x):
    return torch.nn.functional.silu(x)

def _sigmoid(x):
    return torch.sigmoid(x)

def _layernorm(x, axis=-1, eps=1e-05):
    m = x.mean(dim=axis, keepdim=True)
    v = x.var(dim=axis, keepdim=True, unbiased=False)
    return (x - m) / torch.sqrt(v + eps)

def _scatter_add(tgt, idx, src, axis=0):
    return tgt.clone().index_add_(axis, idx, src)

def _segment_sum(src, seg, n):
    out = torch.zeros((n,) + src.shape[1:], dtype=src.dtype)
    return out.index_add_(0, seg, src)

def _pad(x, pw):
    flat = tuple((v for pair in reversed(pw) for v in pair))
    return torch.nn.functional.pad(x, flat)
kernel_name = 'concat_heads__mha_block__memory_aug_recurrent_mem_tr__prompt'

def setup_inputs():

    _w = lambda a: (lambda t: t.to(torch.bfloat16) if t.is_floating_point() else t)(torch.as_tensor(a))

    def _A_setup():
        B, S, D, H = (1, 2048, 576, 32)
        return {'x': _w((lambda *s: torch.randn(*s, dtype=torch.bfloat16) * 0.2)(B, S, D)), 'wqkv': _w((lambda *s: torch.randn(*s, dtype=torch.bfloat16) * 0.2)(D, 3 * D)), 'wo': _w((lambda *s: torch.randn(*s, dtype=torch.bfloat16) * 0.05)(D, D))}
    _A_in = _A_setup()

    def _B_setup():
        B, S, Dm = (1, 2048, 576)
        H, Dh = (32, 128)
        M, seg = (8, 32)
        seg = min(seg, S)
        S = S // seg * seg
        return {'x': _w((lambda *s: torch.randn(*s, dtype=torch.bfloat16) * 0.05)(B, S, Dm)), 'mem0': _w((lambda *s: torch.randn(*s, dtype=torch.bfloat16) * 0.8)(B, M, Dm)), 'Wq': _w((lambda *s: torch.randn(*s, dtype=torch.bfloat16) * 1.6)(Dm, H, Dh) * Dm ** (-0.5)), 'Wk': _w((lambda *s: torch.randn(*s, dtype=torch.bfloat16) * 1.6)(Dm, H, Dh) * Dm ** (-0.5)), 'Wv': _w((lambda *s: torch.randn(*s, dtype=torch.bfloat16) * 0.8)(Dm, H, Dh) * Dm ** (-0.5)), 'Wo': _w((lambda *s: torch.randn(*s, dtype=torch.bfloat16) * 0.8)(H, Dh, Dm) * (H * Dh) ** (-0.5)), 'seg_len': seg}
    _B_in = _B_setup()
    return {'A_x': _A_in['x'], 'A_wqkv': _A_in['wqkv'], 'A_wo': _A_in['wo'], 'B_x': _B_in['x'], 'B_mem0': _B_in['mem0'], 'B_Wq': _B_in['Wq'], 'B_Wk': _B_in['Wk'], 'B_Wv': _B_in['Wv'], 'B_Wo': _B_in['Wo'], 'B_seg_len': _B_in['seg_len']}

def reference(A_x, A_wqkv, A_wo, B_x, B_mem0, B_Wq, B_Wk, B_Wv, B_Wo, B_seg_len):

    def _A_ref(x, wqkv, wo):
        B, S, D = x.shape
        H = 32
        Dh = D // H
        qkv = (lambda x, *d: x.permute(*d))((x @ wqkv).reshape(B, S, 3, H, Dh), 2, 0, 3, 1, 4)
        q, k, v = (qkv[0], qkv[1], qkv[2])
        scores = torch.einsum('bhqd,bhkd->bhqk', q, k) * Dh ** (-0.5)
        p = _softmax(scores, axis=-1)
        o = torch.einsum('bhqk,bhkd->bhqd', p, v)
        return (lambda x, *d: x.permute(*d))(o, 0, 2, 1, 3).reshape(B, S, D) @ wo

    def _B_ref(x, mem0, Wq, Wk, Wv, Wo, seg_len):
        B, S, Dm = x.shape
        H, Dh = (Wq.shape[1], Wq.shape[2])
        M = mem0.shape[1]
        scale = Dh ** (-0.5)
        n_seg = S // seg_len
        L = M + seg_len
        idx = torch.arange(L)
        mask = (idx[:, None] < M) | (idx[:, None] >= idx[None, :])
        mem = mem0
        outs = []
        for s in range(n_seg):
            xs = x[:, s * seg_len:(s + 1) * seg_len, :].clone()
            h = torch.concatenate([mem, xs], axis=1)
            q = torch.einsum('btd,dhe->bhte', h, Wq)
            k = torch.einsum('btd,dhe->bhte', h, Wk)
            v = torch.einsum('btd,dhe->bhte', h, Wv)
            scores = torch.einsum('bhqe,bhke->bhqk', q, k) * scale
            scores = torch.where(mask[None, None], scores, -1000000000.0)
            p = _softmax(scores, axis=-1)
            o = torch.einsum('bhqk,bhke->bhqe', p, v)
            o = torch.einsum('bhte,hed->btd', o, Wo)
            mem = o[:, :M, :].clone()
            outs.append(o[:, M:, :])
        return torch.concatenate(outs, axis=1)
    a = _A_ref(A_x, A_wqkv, A_wo)
    b = _B_ref(B_x, B_mem0, B_Wq, B_Wk, B_Wv, B_Wo, B_seg_len)
    return torch.concatenate([a, b], axis=-1)
```

```asm
; @launch grid=(256,1,1) block=(256,1,1) lds=163840
.amdgcn_target "amdgcn-amd-amdhsa--gfx950"
.text
.globl concat_heads__mha_block__memory_aug_recurrent_mem_tr__prompt_kernel
.p2align 8
.type concat_heads__mha_block__memory_aug_recurrent_mem_tr__prompt_kernel,@function
concat_heads__mha_block__memory_aug_recurrent_mem_tr__prompt_kernel:
  s_load_dwordx2 s[4:5], s[0:1], 0
  s_load_dwordx2 s[6:7], s[0:1], 8
  s_load_dwordx2 s[8:9], s[0:1], 16
  s_load_dwordx2 s[10:11], s[0:1], 24
  s_load_dwordx2 s[12:13], s[0:1], 32
  s_load_dwordx2 s[14:15], s[0:1], 40
  s_load_dwordx2 s[16:17], s[0:1], 48
  s_load_dwordx2 s[18:19], s[0:1], 56
  s_load_dwordx2 s[20:21], s[0:1], 64
  s_load_dwordx2 s[22:23], s[0:1], 80
  s_load_dwordx2 s[24:25], s[0:1], 88
  s_load_dwordx2 s[26:27], s[0:1], 96
  v_lshrrev_b32 v2, 6, v0
  v_and_b32 v1, 63, v0
  v_readfirstlane_b32 s28, v2
  s_waitcnt lgkmcnt(0)
  s_cmp_ge_u32 s2, 256
  s_cbranch_scc1 .Lconcat_heads__mha_block__memory_aug_recurrent_mem_tr__prompt_kernel_end
  s_getreg_b32 s30, hwreg(HW_REG_XCC_ID, 0, 4)
  s_add_u32 s98, s30, 1
  s_cmp_lg_u32 s28, 0
  s_cbranch_scc1 .Lconcat_heads__mha_block__memory_aug_recurrent_mem_tr__prompt_kernel_bar
  s_mov_b64 exec, 1
  v_mov_b32 v3, 1
  s_cmp_lg_u32 s30, 0
  s_cbranch_scc1 .Lconcat_heads__mha_block__memory_aug_recurrent_mem_tr__prompt_kernel_grace
  v_mov_b32 v2, 128
  global_atomic_add v4, v2, v3, s[24:25] sc0
  s_waitcnt vmcnt(0)
  v_readfirstlane_b32 s31, v4
  s_cmp_ge_u32 s31, 32
  s_cbranch_scc1 .Lconcat_heads__mha_block__memory_aug_recurrent_mem_tr__prompt_kernel_shadow
  s_cmp_lg_u32 s31, 31
  s_cbranch_scc1 .Lconcat_heads__mha_block__memory_aug_recurrent_mem_tr__prompt_kernel_cand
  v_mov_b32 v2, 64
  v_mov_b32 v6, 1
  v_mov_b32 v7, 0
  global_atomic_cmpswap v2, v[6:7], s[24:25]
.Lconcat_heads__mha_block__memory_aug_recurrent_mem_tr__prompt_kernel_cand:
  s_add_u32 s31, s31, 224
  v_mov_b32 v4, s31
  s_branch .Lconcat_heads__mha_block__memory_aug_recurrent_mem_tr__prompt_kernel_wr
.Lconcat_heads__mha_block__memory_aug_recurrent_mem_tr__prompt_kernel_grace:
  v_mov_b32 v2, 64
  s_mov_b32 s33, 12
.Lconcat_heads__mha_block__memory_aug_recurrent_mem_tr__prompt_kernel_gp:
  global_load_dword v5, v2, s[24:25] sc1
  s_waitcnt vmcnt(0)
  v_readfirstlane_b32 s34, v5
  s_cmp_lg_u32 s34, 0
  s_cbranch_scc1 .Lconcat_heads__mha_block__memory_aug_recurrent_mem_tr__prompt_kernel_shadow
  s_sleep 4
  s_sub_u32 s33, s33, 1
  s_cmp_lg_u32 s33, 0
  s_cbranch_scc1 .Lconcat_heads__mha_block__memory_aug_recurrent_mem_tr__prompt_kernel_gp
  s_lshl_b32 s31, s30, 2
  v_mov_b32 v2, s31
  v_mov_b32 v3, 1
  global_atomic_add v4, v2, v3, s[24:25] sc0
  s_waitcnt vmcnt(0)
  v_readfirstlane_b32 s31, v4
  s_add_u32 s32, s30, 1
  v_mov_b32 v2, 64
  s_cmp_lg_u32 s31, 31
  s_cbranch_scc1 .Lconcat_heads__mha_block__memory_aug_recurrent_mem_tr__prompt_kernel_nocas
  v_mov_b32 v6, s32
  v_mov_b32 v7, 0
  global_atomic_cmpswap v2, v[6:7], s[24:25]
.Lconcat_heads__mha_block__memory_aug_recurrent_mem_tr__prompt_kernel_nocas:
  s_cmp_ge_u32 s31, 32
  s_cbranch_scc1 .Lconcat_heads__mha_block__memory_aug_recurrent_mem_tr__prompt_kernel_shadow
  s_mov_b32 s33, 4000000
.Lconcat_heads__mha_block__memory_aug_recurrent_mem_tr__prompt_kernel_hp:
  global_load_dword v5, v2, s[24:25] sc1
  s_waitcnt vmcnt(0)
  v_readfirstlane_b32 s34, v5
  s_cmp_lg_u32 s34, 0
  s_cbranch_scc1 .Lconcat_heads__mha_block__memory_aug_recurrent_mem_tr__prompt_kernel_hd
  s_sub_u32 s33, s33, 1
  s_cmp_lg_u32 s33, 0
  s_cbranch_scc1 .Lconcat_heads__mha_block__memory_aug_recurrent_mem_tr__prompt_kernel_hp
.Lconcat_heads__mha_block__memory_aug_recurrent_mem_tr__prompt_kernel_hd:
  s_cmp_lg_u32 s34, s32
  s_cbranch_scc1 .Lconcat_heads__mha_block__memory_aug_recurrent_mem_tr__prompt_kernel_shadow
  s_add_u32 s31, s31, 224
  v_mov_b32 v4, s31
  s_branch .Lconcat_heads__mha_block__memory_aug_recurrent_mem_tr__prompt_kernel_wr
  .Lconcat_heads__mha_block__memory_aug_recurrent_mem_tr__prompt_kernel_aband:
  s_waitcnt vmcnt(0) lgkmcnt(0)
  s_barrier
  v_lshrrev_b32 v0, 4, v0
  s_lshl_b32 s74, s35, 6
  v_add_u32 v0, s74, v0
  s_load_dwordx2 s[4:5], s[0:1], 0
  s_load_dwordx2 s[6:7], s[0:1], 8
  s_load_dwordx2 s[8:9], s[0:1], 16
  s_load_dwordx2 s[10:11], s[0:1], 24
  s_load_dwordx2 s[12:13], s[0:1], 32
  s_load_dwordx2 s[14:15], s[0:1], 40
  s_load_dwordx2 s[16:17], s[0:1], 48
  s_load_dwordx2 s[18:19], s[0:1], 56
  s_load_dwordx2 s[20:21], s[0:1], 64
  s_load_dwordx2 s[22:23], s[0:1], 80
  s_load_dwordx2 s[24:25], s[0:1], 88
  s_load_dwordx2 s[26:27], s[0:1], 96
  v_lshrrev_b32 v2, 6, v0
  v_and_b32 v1, 63, v0
  v_readfirstlane_b32 s28, v2
  s_waitcnt lgkmcnt(0)
  s_cmp_lg_u32 s28, 0
  s_cbranch_scc1 .Lconcat_heads__mha_block__memory_aug_recurrent_mem_tr__prompt_kernel_bar
  s_mov_b64 exec, 1
  v_mov_b32 v3, 1
.Lconcat_heads__mha_block__memory_aug_recurrent_mem_tr__prompt_kernel_shadow:
  v_mov_b32 v2, 68
  global_atomic_add v4, v2, v3, s[24:25] sc0
  s_waitcnt vmcnt(0)
  v_readfirstlane_b32 s31, v4
  s_cmp_ge_u32 s31, 224
  s_cselect_b32 s31, 256, s31
  v_mov_b32 v4, s31
.Lconcat_heads__mha_block__memory_aug_recurrent_mem_tr__prompt_kernel_wr:
  v_mov_b32 v2, 0
  ds_write_b32 v2, v4
  s_waitcnt lgkmcnt(0)
  s_mov_b64 exec, -1
.Lconcat_heads__mha_block__memory_aug_recurrent_mem_tr__prompt_kernel_bar:
  s_barrier
  v_mov_b32 v2, 0
  ds_read_b32 v4, v2
  s_waitcnt lgkmcnt(0)
  v_readfirstlane_b32 s90, v4
  s_barrier
  s_cmp_ge_u32 s90, 256
  s_cbranch_scc1 .Lconcat_heads__mha_block__memory_aug_recurrent_mem_tr__prompt_kernel_end
  s_cmp_ge_u32 s90, 224
  s_cbranch_scc1 .Lconcat_heads__mha_block__memory_aug_recurrent_mem_tr__prompt_kernel_rec
  s_cmp_lg_u32 s90, 0
  s_cbranch_scc1 .Lconcat_heads__mha_block__memory_aug_recurrent_mem_tr__prompt_kernel_noinit
  v_lshlrev_b32 v2, 4, v0
  v_add_u32 v2, 69992448, v2
  v_mov_b32 v4, 0
  v_mov_b32 v5, 0
  v_mov_b32 v6, 0
  v_mov_b32 v7, 0
  global_store_dwordx4 v2, v[4:7], s[26:27] sc1
  v_add_u32 v2, 4096, v2
  global_store_dwordx4 v2, v[4:7], s[26:27] sc1
  v_add_u32 v2, 4096, v2
  global_store_dwordx4 v2, v[4:7], s[26:27] sc1
  v_add_u32 v2, 4096, v2
  global_store_dwordx4 v2, v[4:7], s[26:27] sc1
  v_add_u32 v2, 4096, v2
  global_store_dwordx4 v2, v[4:7], s[26:27] sc1
  v_add_u32 v2, 4096, v2
  global_store_dwordx4 v2, v[4:7], s[26:27] sc1
  v_add_u32 v2, 4096, v2
  global_store_dwordx4 v2, v[4:7], s[26:27] sc1
  v_add_u32 v2, 4096, v2
  global_store_dwordx4 v2, v[4:7], s[26:27] sc1
  v_add_u32 v2, 4096, v2
  global_store_dwordx4 v2, v[4:7], s[26:27] sc1
  v_add_u32 v2, 4096, v2
  s_waitcnt vmcnt(0)
  s_barrier
  s_cmp_lg_u32 s28, 0
  s_cbranch_scc1 .Lconcat_heads__mha_block__memory_aug_recurrent_mem_tr__prompt_kernel_noinit
  v_mov_b32 v2, 72
  v_mov_b32 v4, 1
  s_mov_b64 exec, 1
  global_store_dword v2, v4, s[24:25] sc1
  s_mov_b64 exec, -1
.Lconcat_heads__mha_block__memory_aug_recurrent_mem_tr__prompt_kernel_noinit:
  s_cmp_ge_u32 s90, 96
  s_cbranch_scc1 .Lconcat_heads__mha_block__memory_aug_recurrent_mem_tr__prompt_kernel_A
  s_mov_b32 s29, s90
  s_cmp_ge_u32 s29, 96
  s_cbranch_scc1 .Lconcat_heads__mha_block__memory_aug_recurrent_mem_tr__prompt_kernel_kvx
  s_mov_b32 s32, s10
  s_mov_b32 s33, s11
  s_mov_b32 s34, 2359296
  s_mov_b32 s35, 0x00020000
  s_mov_b32 s36, s16
  s_mov_b32 s37, s17
  s_mov_b32 s38, 4718592
  s_mov_b32 s39, 0x00020000
  s_mov_b32 s40, s18
  s_mov_b32 s41, s19
  s_mov_b32 s42, 4718592
  s_mov_b32 s43, 0x00020000
  s_mov_b32 s44, s26
  s_mov_b32 s45, s27
  s_mov_b32 s46, 268435456
  s_mov_b32 s47, 0x00020000
  s_and_b32 s60, s29, 31
  s_lshr_b32 s61, s29, 5
  s_mov_b32 s59, 8192
  s_lshl_b32 s57, s60, 8
  s_lshl_b32 s62, s28, 6
  s_add_u32 s57, s57, s62
  s_mov_b32 s58, s57
  s_mul_i32 s48, s61, 36864
  s_mov_b32 s49, 110592
  s_lshl_b32 s51, s61, 19
  s_lshl_b32 s62, s60, 14
  s_add_u32 s51, s51, s62
  s_lshl_b32 s62, s28, 11
  s_add_u32 s51, s51, s62
  s_add_u32 s51, s51, 0
  s_add_u32 s52, s51, 8192
  s_mov_b32 s53, 1572864
  s_cmp_lt_u32 s61, 1
  s_cselect_b32 s50, 22, 21
  s_lshl_b32 s75, s61, 7
  s_lshl_b32 s76, s60, 2
  s_add_u32 s75, s75, s76
  s_add_u32 s75, s75, 69992448
  s_cmp_eq_u32 s28, 0
  s_cselect_b32 s75, s75, 1073741824
  s_cselect_b32 s76, 384, 0
  s_mov_b32 s71, s53
  s_mul_i32 s54, s28, 36864
  v_lshrrev_b32 v19, 3, v1
  s_lshl_b32 s60, s28, 3
  v_add_u32 v19, s60, v19
  v_lshrrev_b32 v2, 1, v19
  v_and_b32 v2, 7, v2
  v_and_b32 v3, 7, v1
  v_xor_b32 v2, v2, v3
  v_lshlrev_b32 v2, 4, v2
  v_mul_u32_u24 v19, 1152, v19
  v_add_u32 v2, v2, v19
  v_lshrrev_b32 v19, 2, v1
  v_mul_lo_u32 v19, v19, s59
  v_and_b32 v3, 3, v1
  v_lshlrev_b32 v3, 4, v3
  v_add_u32 v3, v3, v19
  v_lshrrev_b32 v19, 5, v1
  v_lshlrev_b32 v4, 9, v19
  v_bfe_u32 v5, v1, 2, 2
  v_lshlrev_b32 v5, 6, v5
  v_add_u32 v4, v4, v5
  v_bfe_u32 v5, v1, 4, 1
  v_lshlrev_b32 v5, 5, v5
  v_add_u32 v4, v4, v5
  v_and_b32 v5, 3, v1
  v_lshlrev_b32 v5, 3, v5
  v_add_u32 v4, v4, v5
  v_add_u32 v4, s54, v4
  v_and_b32 v9, 31, v1
  v_lshrrev_b32 v10, 3, v9
  v_mul_u32_u24 v10, 36864, v10
  v_and_b32 v11, 7, v9
  v_lshlrev_b32 v11, 7, v11
  v_add_u32 v10, v10, v11
  v_lshrrev_b32 v11, 1, v9
  v_and_b32 v11, 7, v11
  v_add_u32 v12, 0, v19
  v_xor_b32 v12, v12, v11
  v_lshlrev_b32 v12, 4, v12
  v_add_u32 v5, v10, v12
  v_add_u32 v12, 2, v19
  v_xor_b32 v12, v12, v11
  v_lshlrev_b32 v12, 4, v12
  v_add_u32 v6, v10, v12
  v_add_u32 v12, 4, v19
  v_xor_b32 v12, v12, v11
  v_lshlrev_b32 v12, 4, v12
  v_add_u32 v7, v10, v12
  v_add_u32 v12, 6, v19
  v_xor_b32 v12, v12, v11
  v_lshlrev_b32 v12, 4, v12
  v_add_u32 v8, v10, v12
  v_bfe_u32 v19, v1, 4, 1
  v_lshlrev_b32 v17, 10, v19
  v_and_b32 v19, 15, v1
  v_lshlrev_b32 v19, 4, v19
  v_add_u32 v17, v17, v19
  v_lshrrev_b32 v19, 5, v1
  v_lshlrev_b32 v19, 8, v19
  v_add_u32 v17, v17, v19
  v_bfe_u32 v19, v1, 4, 1
  v_lshlrev_b32 v18, 10, v19
  v_and_b32 v19, 15, v1
  v_lshlrev_b32 v19, 4, v19
  v_add_u32 v18, v18, v19
  v_lshrrev_b32 v19, 5, v1
  v_lshlrev_b32 v19, 8, v19
  v_add_u32 v18, v18, v19
  s_mov_b32 s64, s50
  s_mov_b32 s65, 0
  s_mov_b32 s55, s54
  s_mul_i32 s63, s59, 16
  s_mul_i32 s62, s59, 0
  s_add_u32 s62, s62, s57
  s_add_u32 m0, s54, 0
  s_nop 0
  buffer_load_dwordx4 v3, s[36:39], s62 offen lds
  s_add_u32 m0, s54, 1024
  s_add_u32 s62, s62, s63
  buffer_load_dwordx4 v3, s[36:39], s62 offen lds
  s_add_u32 m0, s54, 2048
  s_add_u32 s62, s62, s63
  buffer_load_dwordx4 v3, s[36:39], s62 offen lds
  s_add_u32 m0, s54, 3072
  s_add_u32 s62, s62, s63
  buffer_load_dwordx4 v3, s[36:39], s62 offen lds
  s_add_u32 m0, s54, 4096
  s_add_u32 s62, s62, s63
  buffer_load_dwordx4 v3, s[36:39], s62 offen lds
  s_add_u32 m0, s54, 5120
  s_add_u32 s62, s62, s63
  buffer_load_dwordx4 v3, s[36:39], s62 offen lds
  s_add_u32 m0, s54, 6144
  s_add_u32 s62, s62, s63
  buffer_load_dwordx4 v3, s[36:39], s62 offen lds
  s_add_u32 m0, s54, 7168
  s_add_u32 s62, s62, s63
  buffer_load_dwordx4 v3, s[36:39], s62 offen lds
  s_add_u32 m0, s54, 8192
  s_add_u32 s62, s62, s63
  buffer_load_dwordx4 v3, s[36:39], s62 offen lds
  s_mul_i32 s62, s59, 144
  s_add_u32 s62, s62, s57
  s_add_u32 m0, s54, 9216
  s_nop 0
  buffer_load_dwordx4 v3, s[36:39], s62 offen lds
  s_add_u32 m0, s54, 10240
  s_add_u32 s62, s62, s63
  buffer_load_dwordx4 v3, s[36:39], s62 offen lds
  s_add_u32 m0, s54, 11264
  s_add_u32 s62, s62, s63
  buffer_load_dwordx4 v3, s[36:39], s62 offen lds
  s_add_u32 m0, s54, 12288
  s_add_u32 s62, s62, s63
  buffer_load_dwordx4 v3, s[36:39], s62 offen lds
  s_add_u32 m0, s54, 13312
  s_add_u32 s62, s62, s63
  buffer_load_dwordx4 v3, s[36:39], s62 offen lds
  s_add_u32 m0, s54, 14336
  s_add_u32 s62, s62, s63
  buffer_load_dwordx4 v3, s[36:39], s62 offen lds
  s_add_u32 m0, s54, 15360
  s_add_u32 s62, s62, s63
  buffer_load_dwordx4 v3, s[36:39], s62 offen lds
  s_add_u32 m0, s54, 16384
  s_add_u32 s62, s62, s63
  buffer_load_dwordx4 v3, s[36:39], s62 offen lds
  s_add_u32 m0, s54, 17408
  s_add_u32 s62, s62, s63
  buffer_load_dwordx4 v3, s[36:39], s62 offen lds
  s_mul_i32 s62, s59, 288
  s_add_u32 s62, s62, s57
  s_add_u32 m0, s54, 18432
  s_nop 0
  buffer_load_dwordx4 v3, s[36:39], s62 offen lds
  s_add_u32 m0, s54, 19456
  s_add_u32 s62, s62, s63
  buffer_load_dwordx4 v3, s[36:39], s62 offen lds
  s_add_u32 m0, s54, 20480
  s_add_u32 s62, s62, s63
  buffer_load_dwordx4 v3, s[36:39], s62 offen lds
  s_add_u32 m0, s54, 21504
  s_add_u32 s62, s62, s63
  buffer_load_dwordx4 v3, s[36:39], s62 offen lds
  s_add_u32 m0, s54, 22528
  s_add_u32 s62, s62, s63
  buffer_load_dwordx4 v3, s[36:39], s62 offen lds
  s_add_u32 m0, s54, 23552
  s_add_u32 s62, s62, s63
  buffer_load_dwordx4 v3, s[36:39], s62 offen lds
  s_add_u32 m0, s54, 24576
  s_add_u32 s62, s62, s63
  buffer_load_dwordx4 v3, s[36:39], s62 offen lds
  s_add_u32 m0, s54, 25600
  s_add_u32 s62, s62, s63
  buffer_load_dwordx4 v3, s[36:39], s62 offen lds
  s_add_u32 m0, s54, 26624
  s_add_u32 s62, s62, s63
  buffer_load_dwordx4 v3, s[36:39], s62 offen lds
  s_mul_i32 s62, s59, 432
  s_add_u32 s62, s62, s57
  s_add_u32 m0, s54, 27648
  s_nop 0
  buffer_load_dwordx4 v3, s[36:39], s62 offen lds
  s_add_u32 m0, s54, 28672
  s_add_u32 s62, s62, s63
  buffer_load_dwordx4 v3, s[36:39], s62 offen lds
  s_add_u32 m0, s54, 29696
  s_add_u32 s62, s62, s63
  buffer_load_dwordx4 v3, s[36:39], s62 offen lds
  s_add_u32 m0, s54, 30720
  s_add_u32 s62, s62, s63
  buffer_load_dwordx4 v3, s[36:39], s62 offen lds
  s_add_u32 m0, s54, 31744
  s_add_u32 s62, s62, s63
  buffer_load_dwordx4 v3, s[36:39], s62 offen lds
  s_add_u32 m0, s54, 32768
  s_add_u32 s62, s62, s63
  buffer_load_dwordx4 v3, s[36:39], s62 offen lds
  s_add_u32 m0, s54, 33792
  s_add_u32 s62, s62, s63
  buffer_load_dwordx4 v3, s[36:39], s62 offen lds
  s_add_u32 m0, s54, 34816
  s_add_u32 s62, s62, s63
  buffer_load_dwordx4 v3, s[36:39], s62 offen lds
  s_add_u32 m0, s54, 35840
  s_add_u32 s62, s62, s63
  buffer_load_dwordx4 v3, s[36:39], s62 offen lds
  s_waitcnt vmcnt(27)
  ds_read_b64_tr_b16 a[0:1], v4 offset:0
  ds_read_b64_tr_b16 a[2:3], v4 offset:256
  ds_read_b64_tr_b16 a[4:5], v4 offset:1024
  ds_read_b64_tr_b16 a[6:7], v4 offset:1280
  ds_read_b64_tr_b16 a[8:9], v4 offset:2048
  ds_read_b64_tr_b16 a[10:11], v4 offset:2304
  ds_read_b64_tr_b16 a[12:13], v4 offset:3072
  ds_read_b64_tr_b16 a[14:15], v4 offset:3328
  ds_read_b64_tr_b16 a[16:17], v4 offset:4096
  ds_read_b64_tr_b16 a[18:19], v4 offset:4352
  ds_read_b64_tr_b16 a[20:21], v4 offset:5120
  ds_read_b64_tr_b16 a[22:23], v4 offset:5376
  ds_read_b64_tr_b16 a[24:25], v4 offset:6144
  ds_read_b64_tr_b16 a[26:27], v4 offset:6400
  ds_read_b64_tr_b16 a[28:29], v4 offset:7168
  ds_read_b64_tr_b16 a[30:31], v4 offset:7424
  ds_read_b64_tr_b16 a[32:33], v4 offset:8192
  ds_read_b64_tr_b16 a[34:35], v4 offset:8448
  s_waitcnt lgkmcnt(0)
  s_mul_i32 s62, s59, 0
  s_add_u32 s62, s62, s58
  s_add_u32 m0, s54, 0
  s_nop 0
  buffer_load_dwordx4 v3, s[40:43], s62 offen lds
  s_add_u32 m0, s54, 1024
  s_add_u32 s62, s62, s63
  buffer_load_dwordx4 v3, s[40:43], s62 offen lds
  s_add_u32 m0, s54, 2048
  s_add_u32 s62, s62, s63
  buffer_load_dwordx4 v3, s[40:43], s62 offen lds
  s_add_u32 m0, s54, 3072
  s_add_u32 s62, s62, s63
  buffer_load_dwordx4 v3, s[40:43], s62 offen lds
  s_add_u32 m0, s54, 4096
  s_add_u32 s62, s62, s63
  buffer_load_dwordx4 v3, s[40:43], s62 offen lds
  s_add_u32 m0, s54, 5120
  s_add_u32 s62, s62, s63
  buffer_load_dwordx4 v3, s[40:43], s62 offen lds
  s_add_u32 m0, s54, 6144
  s_add_u32 s62, s62, s63
  buffer_load_dwordx4 v3, s[40:43], s62 offen lds
  s_add_u32 m0, s54, 7168
  s_add_u32 s62, s62, s63
  buffer_load_dwordx4 v3, s[40:43], s62 offen lds
  s_add_u32 m0, s54, 8192
  s_add_u32 s62, s62, s63
  buffer_load_dwordx4 v3, s[40:43], s62 offen lds
  s_waitcnt vmcnt(27)
  ds_read_b64_tr_b16 a[36:37], v4 offset:9216
  ds_read_b64_tr_b16 a[38:39], v4 offset:9472
  ds_read_b64_tr_b16 a[40:41], v4 offset:10240
  ds_read_b64_tr_b16 a[42:43], v4 offset:10496
  ds_read_b64_tr_b16 a[44:45], v4 offset:11264
  ds_read_b64_tr_b16 a[46:47], v4 offset:11520
  ds_read_b64_tr_b16 a[48:49], v4 offset:12288
  ds_read_b64_tr_b16 a[50:51], v4 offset:12544
  ds_read_b64_tr_b16 a[52:53], v4 offset:13312
  ds_read_b64_tr_b16 a[54:55], v4 offset:13568
  ds_read_b64_tr_b16 a[56:57], v4 offset:14336
  ds_read_b64_tr_b16 a[58:59], v4 offset:14592
  ds_read_b64_tr_b16 a[60:61], v4 offset:15360
  ds_read_b64_tr_b16 a[62:63], v4 offset:15616
  ds_read_b64_tr_b16 a[64:65], v4 offset:16384
  ds_read_b64_tr_b16 a[66:67], v4 offset:16640
  ds_read_b64_tr_b16 a[68:69], v4 offset:17408
  ds_read_b64_tr_b16 a[70:71], v4 offset:17664
  s_waitcnt lgkmcnt(0)
  s_mul_i32 s62, s59, 144
  s_add_u32 s62, s62, s58
  s_add_u32 m0, s54, 9216
  s_nop 0
  buffer_load_dwordx4 v3, s[40:43], s62 offen lds
  s_add_u32 m0, s54, 10240
  s_add_u32 s62, s62, s63
  buffer_load_dwordx4 v3, s[40:43], s62 offen lds
  s_add_u32 m0, s54, 11264
  s_add_u32 s62, s62, s63
  buffer_load_dwordx4 v3, s[40:43], s62 offen lds
  s_add_u32 m0, s54, 12288
  s_add_u32 s62, s62, s63
  buffer_load_dwordx4 v3, s[40:43], s62 offen lds
  s_add_u32 m0, s54, 13312
  s_add_u32 s62, s62, s63
  buffer_load_dwordx4 v3, s[40:43], s62 offen lds
  s_add_u32 m0, s54, 14336
  s_add_u32 s62, s62, s63
  buffer_load_dwordx4 v3, s[40:43], s62 offen lds
  s_add_u32 m0, s54, 15360
  s_add_u32 s62, s62, s63
  buffer_load_dwordx4 v3, s[40:43], s62 offen lds
  s_add_u32 m0, s54, 16384
  s_add_u32 s62, s62, s63
  buffer_load_dwordx4 v3, s[40:43], s62 offen lds
  s_add_u32 m0, s54, 17408
  s_add_u32 s62, s62, s63
  buffer_load_dwordx4 v3, s[40:43], s62 offen lds
  s_waitcnt vmcnt(27)
  ds_read_b64_tr_b16 a[72:73], v4 offset:18432
  ds_read_b64_tr_b16 a[74:75], v4 offset:18688
  ds_read_b64_tr_b16 a[76:77], v4 offset:19456
  ds_read_b64_tr_b16 a[78:79], v4 offset:19712
  ds_read_b64_tr_b16 a[80:81], v4 offset:20480
  ds_read_b64_tr_b16 a[82:83], v4 offset:20736
  ds_read_b64_tr_b16 a[84:85], v4 offset:21504
  ds_read_b64_tr_b16 a[86:87], v4 offset:21760
  ds_read_b64_tr_b16 a[88:89], v4 offset:22528
  ds_read_b64_tr_b16 a[90:91], v4 offset:22784
  ds_read_b64_tr_b16 a[92:93], v4 offset:23552
  ds_read_b64_tr_b16 a[94:95], v4 offset:23808
  ds_read_b64_tr_b16 a[96:97], v4 offset:24576
  ds_read_b64_tr_b16 a[98:99], v4 offset:24832
  ds_read_b64_tr_b16 a[100:101], v4 offset:25600
  ds_read_b64_tr_b16 a[102:103], v4 offset:25856
  ds_read_b64_tr_b16 a[104:105], v4 offset:26624
  ds_read_b64_tr_b16 a[106:107], v4 offset:26880
  s_waitcnt lgkmcnt(0)
  s_mul_i32 s62, s59, 288
  s_add_u32 s62, s62, s58
  s_add_u32 m0, s54, 18432
  s_nop 0
  buffer_load_dwordx4 v3, s[40:43], s62 offen lds
  s_add_u32 m0, s54, 19456
  s_add_u32 s62, s62, s63
  buffer_load_dwordx4 v3, s[40:43], s62 offen lds
  s_add_u32 m0, s54, 20480
  s_add_u32 s62, s62, s63
  buffer_load_dwordx4 v3, s[40:43], s62 offen lds
  s_add_u32 m0, s54, 21504
  s_add_u32 s62, s62, s63
  buffer_load_dwordx4 v3, s[40:43], s62 offen lds
  s_add_u32 m0, s54, 22528
  s_add_u32 s62, s62, s63
  buffer_load_dwordx4 v3, s[40:43], s62 offen lds
  s_add_u32 m0, s54, 23552
  s_add_u32 s62, s62, s63
  buffer_load_dwordx4 v3, s[40:43], s62 offen lds
  s_add_u32 m0, s54, 24576
  s_add_u32 s62, s62, s63
  buffer_load_dwordx4 v3, s[40:43], s62 offen lds
  s_add_u32 m0, s54, 25600
  s_add_u32 s62, s62, s63
  buffer_load_dwordx4 v3, s[40:43], s62 offen lds
  s_add_u32 m0, s54, 26624
  s_add_u32 s62, s62, s63
  buffer_load_dwordx4 v3, s[40:43], s62 offen lds
  s_waitcnt vmcnt(27)
  ds_read_b64_tr_b16 a[108:109], v4 offset:27648
  ds_read_b64_tr_b16 a[110:111], v4 offset:27904
  ds_read_b64_tr_b16 a[112:113], v4 offset:28672
  ds_read_b64_tr_b16 a[114:115], v4 offset:28928
  ds_read_b64_tr_b16 a[116:117], v4 offset:29696
  ds_read_b64_tr_b16 a[118:119], v4 offset:29952
  ds_read_b64_tr_b16 a[120:121], v4 offset:30720
  ds_read_b64_tr_b16 a[122:123], v4 offset:30976
  ds_read_b64_tr_b16 a[124:125], v4 offset:31744
  ds_read_b64_tr_b16 a[126:127], v4 offset:32000
  ds_read_b64_tr_b16 a[128:129], v4 offset:32768
  ds_read_b64_tr_b16 a[130:131], v4 offset:33024
  ds_read_b64_tr_b16 a[132:133], v4 offset:33792
  ds_read_b64_tr_b16 a[134:135], v4 offset:34048
  ds_read_b64_tr_b16 a[136:137], v4 offset:34816
  ds_read_b64_tr_b16 a[138:139], v4 offset:35072
  ds_read_b64_tr_b16 a[140:141], v4 offset:35840
  ds_read_b64_tr_b16 a[142:143], v4 offset:36096
  s_waitcnt lgkmcnt(0)
  s_mul_i32 s62, s59, 432
  s_add_u32 s62, s62, s58
  s_add_u32 m0, s54, 27648
  s_nop 0
  buffer_load_dwordx4 v3, s[40:43], s62 offen lds
  s_add_u32 m0, s54, 28672
  s_add_u32 s62, s62, s63
  buffer_load_dwordx4 v3, s[40:43], s62 offen lds
  s_add_u32 m0, s54, 29696
  s_add_u32 s62, s62, s63
  buffer_load_dwordx4 v3, s[40:43], s62 offen lds
  s_add_u32 m0, s54, 30720
  s_add_u32 s62, s62, s63
  buffer_load_dwordx4 v3, s[40:43], s62 offen lds
  s_add_u32 m0, s54, 31744
  s_add_u32 s62, s62, s63
  buffer_load_dwordx4 v3, s[40:43], s62 offen lds
  s_add_u32 m0, s54, 32768
  s_add_u32 s62, s62, s63
  buffer_load_dwordx4 v3, s[40:43], s62 offen lds
  s_add_u32 m0, s54, 33792
  s_add_u32 s62, s62, s63
  buffer_load_dwordx4 v3, s[40:43], s62 offen lds
  s_add_u32 m0, s54, 34816
  s_add_u32 s62, s62, s63
  buffer_load_dwordx4 v3, s[40:43], s62 offen lds
  s_add_u32 m0, s54, 35840
  s_add_u32 s62, s62, s63
  buffer_load_dwordx4 v3, s[40:43], s62 offen lds
  s_waitcnt vmcnt(27)
  ds_read_b64_tr_b16 a[144:145], v4 offset:0
  ds_read_b64_tr_b16 a[146:147], v4 offset:256
  ds_read_b64_tr_b16 a[148:149], v4 offset:1024
  ds_read_b64_tr_b16 a[150:151], v4 offset:1280
  ds_read_b64_tr_b16 a[152:153], v4 offset:2048
  ds_read_b64_tr_b16 a[154:155], v4 offset:2304
  ds_read_b64_tr_b16 a[156:157], v4 offset:3072
  ds_read_b64_tr_b16 a[158:159], v4 offset:3328
  ds_read_b64_tr_b16 a[160:161], v4 offset:4096
  ds_read_b64_tr_b16 a[162:163], v4 offset:4352
  ds_read_b64_tr_b16 a[164:165], v4 offset:5120
  ds_read_b64_tr_b16 a[166:167], v4 offset:5376
  ds_read_b64_tr_b16 a[168:169], v4 offset:6144
  ds_read_b64_tr_b16 a[170:171], v4 offset:6400
  ds_read_b64_tr_b16 a[172:173], v4 offset:7168
  ds_read_b64_tr_b16 a[174:175], v4 offset:7424
  ds_read_b64_tr_b16 a[176:177], v4 offset:8192
  ds_read_b64_tr_b16 a[178:179], v4 offset:8448
  s_waitcnt lgkmcnt(0)
  s_add_u32 m0, s55, 0
  s_nop 0
  buffer_load_dwordx4 v2, s[32:35], s48 offen offset:0 lds
  s_add_u32 m0, s55, 896
  s_nop 0
  buffer_load_dwordx4 v2, s[32:35], s48 offen offset:128 lds
  s_add_u32 m0, s55, 1792
  s_nop 0
  buffer_load_dwordx4 v2, s[32:35], s48 offen offset:256 lds
  s_add_u32 m0, s55, 2688
  s_nop 0
  buffer_load_dwordx4 v2, s[32:35], s48 offen offset:384 lds
  s_add_u32 m0, s55, 3584
  s_nop 0
  buffer_load_dwordx4 v2, s[32:35], s48 offen offset:512 lds
  s_add_u32 m0, s55, 4480
  s_nop 0
  buffer_load_dwordx4 v2, s[32:35], s48 offen offset:640 lds
  s_add_u32 m0, s55, 5376
  s_nop 0
  buffer_load_dwordx4 v2, s[32:35], s48 offen offset:768 lds
  s_add_u32 m0, s55, 6272
  s_nop 0
  buffer_load_dwordx4 v2, s[32:35], s48 offen offset:896 lds
  s_add_u32 m0, s55, 7168
  s_nop 0
  buffer_load_dwordx4 v2, s[32:35], s48 offen offset:1024 lds
  s_add_u32 s48, s48, s49
  s_sub_u32 s64, s64, 1
  s_cmp_gt_i32 s64, 0
  s_cselect_b32 s48, s48, 1073741824
  s_add_u32 s65, s65, 9216
  s_cmp_eq_u32 s65, 36864
  s_cselect_b32 s65, 0, s65
  s_add_u32 s55, s54, s65
  s_waitcnt vmcnt(27)
  ds_read_b64_tr_b16 a[180:181], v4 offset:9216
  ds_read_b64_tr_b16 a[182:183], v4 offset:9472
  ds_read_b64_tr_b16 a[184:185], v4 offset:10240
  ds_read_b64_tr_b16 a[186:187], v4 offset:10496
  ds_read_b64_tr_b16 a[188:189], v4 offset:11264
  ds_read_b64_tr_b16 a[190:191], v4 offset:11520
  ds_read_b64_tr_b16 a[192:193], v4 offset:12288
  ds_read_b64_tr_b16 a[194:195], v4 offset:12544
  ds_read_b64_tr_b16 a[196:197], v4 offset:13312
  ds_read_b64_tr_b16 a[198:199], v4 offset:13568
  ds_read_b64_tr_b16 a[200:201], v4 offset:14336
  ds_read_b64_tr_b16 a[202:203], v4 offset:14592
  ds_read_b64_tr_b16 a[204:205], v4 offset:15360
  ds_read_b64_tr_b16 a[206:207], v4 offset:15616
  ds_read_b64_tr_b16 a[208:209], v4 offset:16384
  ds_read_b64_tr_b16 a[210:211], v4 offset:16640
  ds_read_b64_tr_b16 a[212:213], v4 offset:17408
  ds_read_b64_tr_b16 a[214:215], v4 offset:17664
  s_waitcnt lgkmcnt(0)
  s_add_u32 m0, s55, 0
  s_nop 0
  buffer_load_dwordx4 v2, s[32:35], s48 offen offset:0 lds
  s_add_u32 m0, s55, 896
  s_nop 0
  buffer_load_dwordx4 v2, s[32:35], s48 offen offset:128 lds
  s_add_u32 m0, s55, 1792
  s_nop 0
  buffer_load_dwordx4 v2, s[32:35], s48 offen offset:256 lds
  s_add_u32 m0, s55, 2688
  s_nop 0
  buffer_load_dwordx4 v2, s[32:35], s48 offen offset:384 lds
  s_add_u32 m0, s55, 3584
  s_nop 0
  buffer_load_dwordx4 v2, s[32:35], s48 offen offset:512 lds
  s_add_u32 m0, s55, 4480
  s_nop 0
  buffer_load_dwordx4 v2, s[32:35], s48 offen offset:640 lds
  s_add_u32 m0, s55, 5376
  s_nop 0
  buffer_load_dwordx4 v2, s[32:35], s48 offen offset:768 lds
  s_add_u32 m0, s55, 6272
  s_nop 0
  buffer_load_dwordx4 v2, s[32:35], s48 offen offset:896 lds
  s_add_u32 m0, s55, 7168
  s_nop 0
  buffer_load_dwordx4 v2, s[32:35], s48 offen offset:1024 lds
  s_add_u32 s48, s48, s49
  s_sub_u32 s64, s64, 1
  s_cmp_gt_i32 s64, 0
  s_cselect_b32 s48, s48, 1073741824
  s_add_u32 s65, s65, 9216
  s_cmp_eq_u32 s65, 36864
  s_cselect_b32 s65, 0, s65
  s_add_u32 s55, s54, s65
  s_waitcnt vmcnt(27)
  ds_read_b64_tr_b16 a[216:217], v4 offset:18432
  ds_read_b64_tr_b16 a[218:219], v4 offset:18688
  ds_read_b64_tr_b16 a[220:221], v4 offset:19456
  ds_read_b64_tr_b16 a[222:223], v4 offset:19712
  ds_read_b64_tr_b16 a[224:225], v4 offset:20480
  ds_read_b64_tr_b16 a[226:227], v4 offset:20736
  ds_read_b64_tr_b16 a[228:229], v4 offset:21504
  ds_read_b64_tr_b16 a[230:231], v4 offset:21760
  ds_read_b64_tr_b16 a[232:233], v4 offset:22528
  ds_read_b64_tr_b16 a[234:235], v4 offset:22784
  ds_read_b64_tr_b16 a[236:237], v4 offset:23552
  ds_read_b64_tr_b16 a[238:239], v4 offset:23808
  ds_read_b64_tr_b16 a[240:241], v4 offset:24576
  ds_read_b64_tr_b16 a[242:243], v4 offset:24832
  ds_read_b64_tr_b16 a[244:245], v4 offset:25600
  ds_read_b64_tr_b16 a[246:247], v4 offset:25856
  ds_read_b64_tr_b16 a[248:249], v4 offset:26624
  ds_read_b64_tr_b16 a[250:251], v4 offset:26880
  s_waitcnt lgkmcnt(0)
  s_add_u32 m0, s55, 0
  s_nop 0
  buffer_load_dwordx4 v2, s[32:35], s48 offen offset:0 lds
  s_add_u32 m0, s55, 896
  s_nop 0
  buffer_load_dwordx4 v2, s[32:35], s48 offen offset:128 lds
  s_add_u32 m0, s55, 1792
  s_nop 0
  buffer_load_dwordx4 v2, s[32:35], s48 offen offset:256 lds
  s_add_u32 m0, s55, 2688
  s_nop 0
  buffer_load_dwordx4 v2, s[32:35], s48 offen offset:384 lds
  s_add_u32 m0, s55, 3584
  s_nop 0
  buffer_load_dwordx4 v2, s[32:35], s48 offen offset:512 lds
  s_add_u32 m0, s55, 4480
  s_nop 0
  buffer_load_dwordx4 v2, s[32:35], s48 offen offset:640 lds
  s_add_u32 m0, s55, 5376
  s_nop 0
  buffer_load_dwordx4 v2, s[32:35], s48 offen offset:768 lds
  s_add_u32 m0, s55, 6272
  s_nop 0
  buffer_load_dwordx4 v2, s[32:35], s48 offen offset:896 lds
  s_add_u32 m0, s55, 7168
  s_nop 0
  buffer_load_dwordx4 v2, s[32:35], s48 offen offset:1024 lds
  s_add_u32 s48, s48, s49
  s_sub_u32 s64, s64, 1
  s_cmp_gt_i32 s64, 0
  s_cselect_b32 s48, s48, 1073741824
  s_add_u32 s65, s65, 9216
  s_cmp_eq_u32 s65, 36864
  s_cselect_b32 s65, 0, s65
  s_add_u32 s55, s54, s65
  s_waitcnt vmcnt(27)
  ds_read_b64_tr_b16 a[252:253], v4 offset:27648
  ds_read_b64_tr_b16 a[254:255], v4 offset:27904
  ds_read_b64_tr_b16 v[124:125], v4 offset:28672
  ds_read_b64_tr_b16 v[126:127], v4 offset:28928
  ds_read_b64_tr_b16 v[128:129], v4 offset:29696
  ds_read_b64_tr_b16 v[130:131], v4 offset:29952
  ds_read_b64_tr_b16 v[132:133], v4 offset:30720
  ds_read_b64_tr_b16 v[134:135], v4 offset:30976
  ds_read_b64_tr_b16 v[136:137], v4 offset:31744
  ds_read_b64_tr_b16 v[138:139], v4 offset:32000
  ds_read_b64_tr_b16 v[140:141], v4 offset:32768
  ds_read_b64_tr_b16 v[142:143], v4 offset:33024
  ds_read_b64_tr_b16 v[144:145], v4 offset:33792
  ds_read_b64_tr_b16 v[146:147], v4 offset:34048
  ds_read_b64_tr_b16 v[148:149], v4 offset:34816
  ds_read_b64_tr_b16 v[150:151], v4 offset:35072
  ds_read_b64_tr_b16 v[152:153], v4 offset:35840
  ds_read_b64_tr_b16 v[154:155], v4 offset:36096
  s_waitcnt lgkmcnt(0)
  v_mov_b32 v250, 72
  s_mov_b32 s95, 4000000
.ww1:
  global_load_dword v251, v250, s[24:25] sc1
  s_waitcnt vmcnt(0)
  v_readfirstlane_b32 s94, v251
  s_cmp_lg_u32 s94, 0
  s_cbranch_scc1 .ww1_ok
  s_sleep 1
  s_sub_u32 s95, s95, 1
  s_cmp_lg_u32 s95, 0
  s_cbranch_scc1 .ww1
.ww1_ok:
  s_mov_b32 s72, 1073741824
  s_mov_b32 s73, 1073741824
  s_mov_b32 s74, 1073741824
  v_mov_b32 v159, 1
  s_mov_b32 s61, s51
  s_mov_b32 s62, s52
  s_mov_b32 s51, 1073741824
  s_mov_b32 s52, 1073741824
  s_mov_b32 s56, 0
  v_mov_b32 v9, v5
  v_mov_b32 v10, v6
  v_mov_b32 v11, v7
  v_mov_b32 v12, v8
  s_waitcnt vmcnt(9)
  s_barrier
  ds_read_b128 v[20:23], v9 offset:0
  ds_read_b128 v[24:27], v10 offset:0
  ds_read_b128 v[28:31], v11 offset:0
  ds_read_b128 v[32:35], v12 offset:0
  ds_read_b128 v[36:39], v9 offset:1024
.Lconcat_heads__mha_block__memory_aug_recurrent_mem_tr__prompt_kernelkv_loop:
  ds_read_b128 v[40:43], v10 offset:1024
  s_waitcnt lgkmcnt(5)
  v_mfma_f32_32x32x16_bf16 v[60:75], a[0:3], v[20:23], 0
  s_add_u32 s56, s56, 9216
  s_cmp_eq_u32 s56, 36864
  s_cselect_b32 s56, 0, s56
  v_mfma_f32_32x32x16_bf16 v[76:91], v[20:23], a[144:147], 0
  v_add_u32 v13, s56, v5
  ds_read_b128 v[20:23], v11 offset:1024
  s_waitcnt lgkmcnt(5)
  v_mfma_f32_32x32x16_bf16 v[60:75], a[4:7], v[24:27], v[60:75]
  v_add_u32 v14, s56, v6
  v_mfma_f32_32x32x16_bf16 v[76:91], v[24:27], a[148:151], v[76:91]
  v_add_u32 v15, s56, v7
  ds_read_b128 v[24:27], v12 offset:1024
  s_waitcnt lgkmcnt(5)
  v_mfma_f32_32x32x16_bf16 v[60:75], a[8:11], v[28:31], v[60:75]
  v_add_u32 v16, s56, v8
  v_mfma_f32_32x32x16_bf16 v[76:91], v[28:31], a[152:155], v[76:91]
  v_cvt_pk_bf16_f32 v44, v92, v93
  ds_read_b128 v[28:31], v9 offset:2048
  s_waitcnt lgkmcnt(5)
  v_mfma_f32_32x32x16_bf16 v[60:75], a[12:15], v[32:35], v[60:75]
  v_cvt_pk_bf16_f32 v45, v94, v95
  v_mfma_f32_32x32x16_bf16 v[76:91], v[32:35], a[156:159], v[76:91]
  v_cvt_pk_bf16_f32 v46, v100, v101
  ds_read_b128 v[32:35], v10 offset:2048
  s_waitcnt lgkmcnt(5)
  v_mfma_f32_32x32x16_bf16 v[60:75], a[16:19], v[36:39], v[60:75]
  v_cvt_pk_bf16_f32 v47, v102, v103
  v_mfma_f32_32x32x16_bf16 v[76:91], v[36:39], a[160:163], v[76:91]
  buffer_store_dwordx4 v[44:47], v17, s[44:47], s51 offen offset:0 sc1
  ds_read_b128 v[36:39], v11 offset:2048
  s_waitcnt lgkmcnt(5)
  v_mfma_f32_32x32x16_bf16 v[60:75], a[20:23], v[40:43], v[60:75]
  v_cvt_pk_bf16_f32 v48, v96, v97
  v_mfma_f32_32x32x16_bf16 v[76:91], v[40:43], a[164:167], v[76:91]
  v_cvt_pk_bf16_f32 v49, v98, v99
  ds_read_b128 v[40:43], v12 offset:2048
  s_waitcnt lgkmcnt(5)
  v_mfma_f32_32x32x16_bf16 v[60:75], a[24:27], v[20:23], v[60:75]
  v_cvt_pk_bf16_f32 v50, v104, v105
  v_mfma_f32_32x32x16_bf16 v[76:91], v[20:23], a[168:171], v[76:91]
  v_cvt_pk_bf16_f32 v51, v106, v107
  ds_read_b128 v[20:23], v9 offset:3072
  s_waitcnt lgkmcnt(5)
  v_mfma_f32_32x32x16_bf16 v[60:75], a[28:31], v[24:27], v[60:75]
  buffer_store_dwordx4 v[48:51], v17, s[44:47], s51 offen offset:512 sc1
  v_mfma_f32_32x32x16_bf16 v[76:91], v[24:27], a[172:175], v[76:91]
  v_cvt_pk_bf16_f32 v52, v108, v109
  ds_read_b128 v[24:27], v10 offset:3072
  s_waitcnt lgkmcnt(5)
  v_mfma_f32_32x32x16_bf16 v[60:75], a[32:35], v[28:31], v[60:75]
  v_cvt_pk_bf16_f32 v53, v110, v111
  v_mfma_f32_32x32x16_bf16 v[76:91], v[28:31], a[176:179], v[76:91]
  v_cvt_pk_bf16_f32 v54, v116, v117
  ds_read_b128 v[28:31], v11 offset:3072
  s_waitcnt lgkmcnt(5)
  v_mfma_f32_32x32x16_bf16 v[60:75], a[36:39], v[32:35], v[60:75]
  v_cvt_pk_bf16_f32 v55, v118, v119
  v_mfma_f32_32x32x16_bf16 v[76:91], v[32:35], a[180:183], v[76:91]
  buffer_store_dwordx4 v[52:55], v18, s[44:47], s52 offen offset:0 sc1
  ds_read_b128 v[32:35], v12 offset:3072
  s_waitcnt lgkmcnt(5)
  v_mfma_f32_32x32x16_bf16 v[60:75], a[40:43], v[36:39], v[60:75]
  v_cvt_pk_bf16_f32 v56, v112, v113
  v_mfma_f32_32x32x16_bf16 v[76:91], v[36:39], a[184:187], v[76:91]
  v_cvt_pk_bf16_f32 v57, v114, v115
  ds_read_b128 v[36:39], v9 offset:4096
  s_waitcnt lgkmcnt(5)
  v_mfma_f32_32x32x16_bf16 v[60:75], a[44:47], v[40:43], v[60:75]
  v_cvt_pk_bf16_f32 v58, v120, v121
  v_mfma_f32_32x32x16_bf16 v[76:91], v[40:43], a[188:191], v[76:91]
  v_cvt_pk_bf16_f32 v59, v122, v123
  ds_read_b128 v[40:43], v10 offset:4096
  s_waitcnt lgkmcnt(5)
  v_mfma_f32_32x32x16_bf16 v[60:75], a[48:51], v[20:23], v[60:75]
  buffer_store_dwordx4 v[56:59], v18, s[44:47], s52 offen offset:512 sc1
  v_mfma_f32_32x32x16_bf16 v[76:91], v[20:23], a[192:195], v[76:91]
  ds_read_b128 v[20:23], v11 offset:4096
  s_waitcnt lgkmcnt(5)
  v_mfma_f32_32x32x16_bf16 v[60:75], a[52:55], v[24:27], v[60:75]
  v_mfma_f32_32x32x16_bf16 v[76:91], v[24:27], a[196:199], v[76:91]
  ds_read_b128 v[24:27], v12 offset:4096
  s_waitcnt lgkmcnt(5)
  v_mfma_f32_32x32x16_bf16 v[60:75], a[56:59], v[28:31], v[60:75]
  v_mfma_f32_32x32x16_bf16 v[76:91], v[28:31], a[200:203], v[76:91]
  ds_read_b128 v[28:31], v9 offset:5120
  s_waitcnt lgkmcnt(5)
  v_mfma_f32_32x32x16_bf16 v[60:75], a[60:63], v[32:35], v[60:75]
  v_mfma_f32_32x32x16_bf16 v[76:91], v[32:35], a[204:207], v[76:91]
  ds_read_b128 v[32:35], v10 offset:5120
  s_waitcnt lgkmcnt(5)
  v_mfma_f32_32x32x16_bf16 v[60:75], a[64:67], v[36:39], v[60:75]
  v_mfma_f32_32x32x16_bf16 v[76:91], v[36:39], a[208:211], v[76:91]
  ds_read_b128 v[36:39], v11 offset:5120
  s_waitcnt lgkmcnt(5)
  v_mfma_f32_32x32x16_bf16 v[60:75], a[68:71], v[40:43], v[60:75]
  v_mfma_f32_32x32x16_bf16 v[76:91], v[40:43], a[212:215], v[76:91]
  ds_read_b128 v[40:43], v12 offset:5120
  s_waitcnt lgkmcnt(5)
  v_mfma_f32_32x32x16_bf16 v[60:75], a[72:75], v[20:23], v[60:75]
  v_mfma_f32_32x32x16_bf16 v[76:91], v[20:23], a[216:219], v[76:91]
  ds_read_b128 v[20:23], v9 offset:6144
  s_waitcnt lgkmcnt(5)
  v_mfma_f32_32x32x16_bf16 v[60:75], a[76:79], v[24:27], v[60:75]
  v_mfma_f32_32x32x16_bf16 v[76:91], v[24:27], a[220:223], v[76:91]
  ds_read_b128 v[24:27], v10 offset:6144
  s_waitcnt lgkmcnt(5)
  v_mfma_f32_32x32x16_bf16 v[60:75], a[80:83], v[28:31], v[60:75]
  v_mfma_f32_32x32x16_bf16 v[76:91], v[28:31], a[224:227], v[76:91]
  ds_read_b128 v[28:31], v11 offset:6144
  s_waitcnt lgkmcnt(5)
  v_mfma_f32_32x32x16_bf16 v[60:75], a[84:87], v[32:35], v[60:75]
  v_mfma_f32_32x32x16_bf16 v[76:91], v[32:35], a[228:231], v[76:91]
  ds_read_b128 v[32:35], v12 offset:6144
  s_waitcnt lgkmcnt(5)
  v_mfma_f32_32x32x16_bf16 v[60:75], a[88:91], v[36:39], v[60:75]
  s_mov_b32 s51, s61
  s_mov_b32 s52, s62
  s_add_u32 s61, s61, s53
  s_add_u32 s62, s62, s71
  v_mfma_f32_32x32x16_bf16 v[76:91], v[36:39], a[232:235], v[76:91]
  s_waitcnt vmcnt(18)
  s_barrier
  ds_read_b128 v[36:39], v9 offset:7168
  s_waitcnt lgkmcnt(5)
  v_mfma_f32_32x32x16_bf16 v[60:75], a[92:95], v[40:43], v[60:75]
  s_mov_b64 exec, 1
  buffer_store_dword v159, off, s[44:47], s72 sc1
  s_mov_b64 exec, -1
  s_mov_b32 s72, s73
  s_mov_b32 s73, s74
  s_mov_b32 s74, s75
  s_add_u32 s75, s75, s76
  v_mfma_f32_32x32x16_bf16 v[76:91], v[40:43], a[236:239], v[76:91]
  s_add_u32 m0, s55, 0
  ds_read_b128 v[40:43], v10 offset:7168
  s_waitcnt lgkmcnt(5)
  v_mfma_f32_32x32x16_bf16 v[60:75], a[96:99], v[20:23], v[60:75]
  buffer_load_dwordx4 v2, s[32:35], s48 offen offset:0 lds
  v_mfma_f32_32x32x16_bf16 v[76:91], v[20:23], a[240:243], v[76:91]
  s_add_u32 m0, s55, 896
  ds_read_b128 v[20:23], v11 offset:7168
  s_waitcnt lgkmcnt(5)
  v_mfma_f32_32x32x16_bf16 v[60:75], a[100:103], v[24:27], v[60:75]
  buffer_load_dwordx4 v2, s[32:35], s48 offen offset:128 lds
  v_mfma_f32_32x32x16_bf16 v[76:91], v[24:27], a[244:247], v[76:91]
  s_add_u32 m0, s55, 1792
  ds_read_b128 v[24:27], v12 offset:7168
  s_waitcnt lgkmcnt(5)
  v_mfma_f32_32x32x16_bf16 v[60:75], a[104:107], v[28:31], v[60:75]
  buffer_load_dwordx4 v2, s[32:35], s48 offen offset:256 lds
  v_mfma_f32_32x32x16_bf16 v[76:91], v[28:31], a[248:251], v[76:91]
  s_add_u32 m0, s55, 2688
  ds_read_b128 v[28:31], v9 offset:8192
  s_waitcnt lgkmcnt(5)
  v_mfma_f32_32x32x16_bf16 v[60:75], a[108:111], v[32:35], v[60:75]
  buffer_load_dwordx4 v2, s[32:35], s48 offen offset:384 lds
  v_mfma_f32_32x32x16_bf16 v[76:91], v[32:35], a[252:255], v[76:91]
  s_add_u32 m0, s55, 3584
  ds_read_b128 v[32:35], v10 offset:8192
  s_waitcnt lgkmcnt(5)
  v_mfma_f32_32x32x16_bf16 v[60:75], a[112:115], v[36:39], v[60:75]
  buffer_load_dwordx4 v2, s[32:35], s48 offen offset:512 lds
  v_mfma_f32_32x32x16_bf16 v[76:91], v[36:39], v[124:127], v[76:91]
  s_add_u32 m0, s55, 4480
  ds_read_b128 v[36:39], v11 offset:8192
  s_waitcnt lgkmcnt(5)
  v_mfma_f32_32x32x16_bf16 v[60:75], a[116:119], v[40:43], v[60:75]
  buffer_load_dwordx4 v2, s[32:35], s48 offen offset:640 lds
  v_mfma_f32_32x32x16_bf16 v[76:91], v[40:43], v[128:131], v[76:91]
  s_add_u32 m0, s55, 5376
  ds_read_b128 v[40:43], v12 offset:8192
  s_waitcnt lgkmcnt(5)
  v_mfma_f32_32x32x16_bf16 v[60:75], a[120:123], v[20:23], v[60:75]
  buffer_load_dwordx4 v2, s[32:35], s48 offen offset:768 lds
  v_mfma_f32_32x32x16_bf16 v[76:91], v[20:23], v[132:135], v[76:91]
  s_add_u32 m0, s55, 6272
  ds_read_b128 v[20:23], v13 offset:0
  s_waitcnt lgkmcnt(5)
  v_mfma_f32_32x32x16_bf16 v[60:75], a[124:127], v[24:27], v[60:75]
  buffer_load_dwordx4 v2, s[32:35], s48 offen offset:896 lds
  v_mfma_f32_32x32x16_bf16 v[76:91], v[24:27], v[136:139], v[76:91]
  s_add_u32 m0, s55, 7168
  ds_read_b128 v[24:27], v14 offset:0
  s_waitcnt lgkmcnt(5)
  v_mfma_f32_32x32x16_bf16 v[60:75], a[128:131], v[28:31], v[60:75]
  buffer_load_dwordx4 v2, s[32:35], s48 offen offset:1024 lds
  v_mfma_f32_32x32x16_bf16 v[76:91], v[28:31], v[140:143], v[76:91]
  ds_read_b128 v[28:31], v15 offset:0
  s_waitcnt lgkmcnt(5)
  v_mfma_f32_32x32x16_bf16 v[60:75], a[132:135], v[32:35], v[60:75]
  s_add_u32 s48, s48, s49
  s_sub_u32 s64, s64, 1
  s_cmp_gt_i32 s64, 0
  s_cselect_b32 s48, s48, 1073741824
  s_add_u32 s65, s65, 9216
  s_cmp_eq_u32 s65, 36864
  s_cselect_b32 s65, 0, s65
  s_add_u32 s55, s54, s65
  v_mfma_f32_32x32x16_bf16 v[76:91], v[32:35], v[144:147], v[76:91]
  ds_read_b128 v[32:35], v16 offset:0
  s_waitcnt lgkmcnt(5)
  v_mfma_f32_32x32x16_bf16 v[60:75], a[136:139], v[36:39], v[60:75]
  v_mfma_f32_32x32x16_bf16 v[76:91], v[36:39], v[148:151], v[76:91]
  ds_read_b128 v[36:39], v13 offset:1024
  s_waitcnt lgkmcnt(5)
  v_mfma_f32_32x32x16_bf16 v[60:75], a[140:143], v[40:43], v[60:75]
  v_mfma_f32_32x32x16_bf16 v[76:91], v[40:43], v[152:155], v[76:91]
  s_sub_u32 s50, s50, 1
  s_cmp_eq_u32 s50, 0
  s_cbranch_scc1 .Lconcat_heads__mha_block__memory_aug_recurrent_mem_tr__prompt_kernelkv_tail0
  ds_read_b128 v[40:43], v14 offset:1024
  s_waitcnt lgkmcnt(5)
  v_mfma_f32_32x32x16_bf16 v[92:107], a[0:3], v[20:23], 0
  s_add_u32 s56, s56, 9216
  s_cmp_eq_u32 s56, 36864
  s_cselect_b32 s56, 0, s56
  v_mfma_f32_32x32x16_bf16 v[108:123], v[20:23], a[144:147], 0
  v_add_u32 v9, s56, v5
  ds_read_b128 v[20:23], v15 offset:1024
  s_waitcnt lgkmcnt(5)
  v_mfma_f32_32x32x16_bf16 v[92:107], a[4:7], v[24:27], v[92:107]
  v_add_u32 v10, s56, v6
  v_mfma_f32_32x32x16_bf16 v[108:123], v[24:27], a[148:151], v[108:123]
  v_add_u32 v11, s56, v7
  ds_read_b128 v[24:27], v16 offset:1024
  s_waitcnt lgkmcnt(5)
  v_mfma_f32_32x32x16_bf16 v[92:107], a[8:11], v[28:31], v[92:107]
  v_add_u32 v12, s56, v8
  v_mfma_f32_32x32x16_bf16 v[108:123], v[28:31], a[152:155], v[108:123]
  v_cvt_pk_bf16_f32 v44, v60, v61
  ds_read_b128 v[28:31], v13 offset:2048
  s_waitcnt lgkmcnt(5)
  v_mfma_f32_32x32x16_bf16 v[92:107], a[12:15], v[32:35], v[92:107]
  v_cvt_pk_bf16_f32 v45, v62, v63
  v_mfma_f32_32x32x16_bf16 v[108:123], v[32:35], a[156:159], v[108:123]
  v_cvt_pk_bf16_f32 v46, v68, v69
  ds_read_b128 v[32:35], v14 offset:2048
  s_waitcnt lgkmcnt(5)
  v_mfma_f32_32x32x16_bf16 v[92:107], a[16:19], v[36:39], v[92:107]
  v_cvt_pk_bf16_f32 v47, v70, v71
  v_mfma_f32_32x32x16_bf16 v[108:123], v[36:39], a[160:163], v[108:123]
  buffer_store_dwordx4 v[44:47], v17, s[44:47], s51 offen offset:0 sc1
  ds_read_b128 v[36:39], v15 offset:2048
  s_waitcnt lgkmcnt(5)
  v_mfma_f32_32x32x16_bf16 v[92:107], a[20:23], v[40:43], v[92:107]
  v_cvt_pk_bf16_f32 v48, v64, v65
  v_mfma_f32_32x32x16_bf16 v[108:123], v[40:43], a[164:167], v[108:123]
  v_cvt_pk_bf16_f32 v49, v66, v67
  ds_read_b128 v[40:43], v16 offset:2048
  s_waitcnt lgkmcnt(5)
  v_mfma_f32_32x32x16_bf16 v[92:107], a[24:27], v[20:23], v[92:107]
  v_cvt_pk_bf16_f32 v50, v72, v73
  v_mfma_f32_32x32x16_bf16 v[108:123], v[20:23], a[168:171], v[108:123]
  v_cvt_pk_bf16_f32 v51, v74, v75
  ds_read_b128 v[20:23], v13 offset:3072
  s_waitcnt lgkmcnt(5)
  v_mfma_f32_32x32x16_bf16 v[92:107], a[28:31], v[24:27], v[92:107]
  buffer_store_dwordx4 v[48:51], v17, s[44:47], s51 offen offset:512 sc1
  v_mfma_f32_32x32x16_bf16 v[108:123], v[24:27], a[172:175], v[108:123]
  v_cvt_pk_bf16_f32 v52, v76, v77
  ds_read_b128 v[24:27], v14 offset:3072
  s_waitcnt lgkmcnt(5)
  v_mfma_f32_32x32x16_bf16 v[92:107], a[32:35], v[28:31], v[92:107]
  v_cvt_pk_bf16_f32 v53, v78, v79
  v_mfma_f32_32x32x16_bf16 v[108:123], v[28:31], a[176:179], v[108:123]
  v_cvt_pk_bf16_f32 v54, v84, v85
  ds_read_b128 v[28:31], v15 offset:3072
  s_waitcnt lgkmcnt(5)
  v_mfma_f32_32x32x16_bf16 v[92:107], a[36:39], v[32:35], v[92:107]
  v_cvt_pk_bf16_f32 v55, v86, v87
  v_mfma_f32_32x32x16_bf16 v[108:123], v[32:35], a[180:183], v[108:123]
  buffer_store_dwordx4 v[52:55], v18, s[44:47], s52 offen offset:0 sc1
  ds_read_b128 v[32:35], v16 offset:3072
  s_waitcnt lgkmcnt(5)
  v_mfma_f32_32x32x16_bf16 v[92:107], a[40:43], v[36:39], v[92:107]
  v_cvt_pk_bf16_f32 v56, v80, v81
  v_mfma_f32_32x32x16_bf16 v[108:123], v[36:39], a[184:187], v[108:123]
  v_cvt_pk_bf16_f32 v57, v82, v83
  ds_read_b128 v[36:39], v13 offset:4096
  s_waitcnt lgkmcnt(5)
  v_mfma_f32_32x32x16_bf16 v[92:107], a[44:47], v[40:43], v[92:107]
  v_cvt_pk_bf16_f32 v58, v88, v89
  v_mfma_f32_32x32x16_bf16 v[108:123], v[40:43], a[188:191], v[108:123]
  v_cvt_pk_bf16_f32 v59, v90, v91
  ds_read_b128 v[40:43], v14 offset:4096
  s_waitcnt lgkmcnt(5)
  v_mfma_f32_32x32x16_bf16 v[92:107], a[48:51], v[20:23], v[92:107]
  buffer_store_dwordx4 v[56:59], v18, s[44:47], s52 offen offset:512 sc1
  v_mfma_f32_32x32x16_bf16 v[108:123], v[20:23], a[192:195], v[108:123]
  ds_read_b128 v[20:23], v15 offset:4096
  s_waitcnt lgkmcnt(5)
  v_mfma_f32_32x32x16_bf16 v[92:107], a[52:55], v[24:27], v[92:107]
  v_mfma_f32_32x32x16_bf16 v[108:123], v[24:27], a[196:199], v[108:123]
  ds_read_b128 v[24:27], v16 offset:4096
  s_waitcnt lgkmcnt(5)
  v_mfma_f32_32x32x16_bf16 v[92:107], a[56:59], v[28:31], v[92:107]
  v_mfma_f32_32x32x16_bf16 v[108:123], v[28:31], a[200:203], v[108:123]
  ds_read_b128 v[28:31], v13 offset:5120
  s_waitcnt lgkmcnt(5)
  v_mfma_f32_32x32x16_bf16 v[92:107], a[60:63], v[32:35], v[92:107]
  v_mfma_f32_32x32x16_bf16 v[108:123], v[32:35], a[204:207], v[108:123]
  ds_read_b128 v[32:35], v14 offset:5120
  s_waitcnt lgkmcnt(5)
  v_mfma_f32_32x32x16_bf16 v[92:107], a[64:67], v[36:39], v[92:107]
  v_mfma_f32_32x32x16_bf16 v[108:123], v[36:39], a[208:211], v[108:123]
  ds_read_b128 v[36:39], v15 offset:5120
  s_waitcnt lgkmcnt(5)
  v_mfma_f32_32x32x16_bf16 v[92:107], a[68:71], v[40:43], v[92:107]
  v_mfma_f32_32x32x16_bf16 v[108:123], v[40:43], a[212:215], v[108:123]
  ds_read_b128 v[40:43], v16 offset:5120
  s_waitcnt lgkmcnt(5)
  v_mfma_f32_32x32x16_bf16 v[92:107], a[72:75], v[20:23], v[92:107]
  v_mfma_f32_32x32x16_bf16 v[108:123], v[20:23], a[216:219], v[108:123]
  ds_read_b128 v[20:23], v13 offset:6144
  s_waitcnt lgkmcnt(5)
  v_mfma_f32_32x32x16_bf16 v[92:107], a[76:79], v[24:27], v[92:107]
  v_mfma_f32_32x32x16_bf16 v[108:123], v[24:27], a[220:223], v[108:123]
  ds_read_b128 v[24:27], v14 offset:6144
  s_waitcnt lgkmcnt(5)
  v_mfma_f32_32x32x16_bf16 v[92:107], a[80:83], v[28:31], v[92:107]
  v_mfma_f32_32x32x16_bf16 v[108:123], v[28:31], a[224:227], v[108:123]
  ds_read_b128 v[28:31], v15 offset:6144
  s_waitcnt lgkmcnt(5)
  v_mfma_f32_32x32x16_bf16 v[92:107], a[84:87], v[32:35], v[92:107]
  v_mfma_f32_32x32x16_bf16 v[108:123], v[32:35], a[228:231], v[108:123]
  ds_read_b128 v[32:35], v16 offset:6144
  s_waitcnt lgkmcnt(5)
  v_mfma_f32_32x32x16_bf16 v[92:107], a[88:91], v[36:39], v[92:107]
  s_mov_b32 s51, s61
  s_mov_b32 s52, s62
  s_add_u32 s61, s61, s53
  s_add_u32 s62, s62, s71
  v_mfma_f32_32x32x16_bf16 v[108:123], v[36:39], a[232:235], v[108:123]
  s_waitcnt vmcnt(18)
  s_barrier
  ds_read_b128 v[36:39], v13 offset:7168
  s_waitcnt lgkmcnt(5)
  v_mfma_f32_32x32x16_bf16 v[92:107], a[92:95], v[40:43], v[92:107]
  s_mov_b64 exec, 1
  buffer_store_dword v159, off, s[44:47], s72 sc1
  s_mov_b64 exec, -1
  s_mov_b32 s72, s73
  s_mov_b32 s73, s74
  s_mov_b32 s74, s75
  s_add_u32 s75, s75, s76
  v_mfma_f32_32x32x16_bf16 v[108:123], v[40:43], a[236:239], v[108:123]
  s_add_u32 m0, s55, 0
  ds_read_b128 v[40:43], v14 offset:7168
  s_waitcnt lgkmcnt(5)
  v_mfma_f32_32x32x16_bf16 v[92:107], a[96:99], v[20:23], v[92:107]
  buffer_load_dwordx4 v2, s[32:35], s48 offen offset:0 lds
  v_mfma_f32_32x32x16_bf16 v[108:123], v[20:23], a[240:243], v[108:123]
  s_add_u32 m0, s55, 896
  ds_read_b128 v[20:23], v15 offset:7168
  s_waitcnt lgkmcnt(5)
  v_mfma_f32_32x32x16_bf16 v[92:107], a[100:103], v[24:27], v[92:107]
  buffer_load_dwordx4 v2, s[32:35], s48 offen offset:128 lds
  v_mfma_f32_32x32x16_bf16 v[108:123], v[24:27], a[244:247], v[108:123]
  s_add_u32 m0, s55, 1792
  ds_read_b128 v[24:27], v16 offset:7168
  s_waitcnt lgkmcnt(5)
  v_mfma_f32_32x32x16_bf16 v[92:107], a[104:107], v[28:31], v[92:107]
  buffer_load_dwordx4 v2, s[32:35], s48 offen offset:256 lds
  v_mfma_f32_32x32x16_bf16 v[108:123], v[28:31], a[248:251], v[108:123]
  s_add_u32 m0, s55, 2688
  ds_read_b128 v[28:31], v13 offset:8192
  s_waitcnt lgkmcnt(5)
  v_mfma_f32_32x32x16_bf16 v[92:107], a[108:111], v[32:35], v[92:107]
  buffer_load_dwordx4 v2, s[32:35], s48 offen offset:384 lds
  v_mfma_f32_32x32x16_bf16 v[108:123], v[32:35], a[252:255], v[108:123]
  s_add_u32 m0, s55, 3584
  ds_read_b128 v[32:35], v14 offset:8192
  s_waitcnt lgkmcnt(5)
  v_mfma_f32_32x32x16_bf16 v[92:107], a[112:115], v[36:39], v[92:107]
  buffer_load_dwordx4 v2, s[32:35], s48 offen offset:512 lds
  v_mfma_f32_32x32x16_bf16 v[108:123], v[36:39], v[124:127], v[108:123]
  s_add_u32 m0, s55, 4480
  ds_read_b128 v[36:39], v15 offset:8192
  s_waitcnt lgkmcnt(5)
  v_mfma_f32_32x32x16_bf16 v[92:107], a[116:119], v[40:43], v[92:107]
  buffer_load_dwordx4 v2, s[32:35], s48 offen offset:640 lds
  v_mfma_f32_32x32x16_bf16 v[108:123], v[40:43], v[128:131], v[108:123]
  s_add_u32 m0, s55, 5376
  ds_read_b128 v[40:43], v16 offset:8192
  s_waitcnt lgkmcnt(5)
  v_mfma_f32_32x32x16_bf16 v[92:107], a[120:123], v[20:23], v[92:107]
  buffer_load_dwordx4 v2, s[32:35], s48 offen offset:768 lds
  v_mfma_f32_32x32x16_bf16 v[108:123], v[20:23], v[132:135], v[108:123]
  s_add_u32 m0, s55, 6272
  ds_read_b128 v[20:23], v9 offset:0
  s_waitcnt lgkmcnt(5)
  v_mfma_f32_32x32x16_bf16 v[92:107], a[124:127], v[24:27], v[92:107]
  buffer_load_dwordx4 v2, s[32:35], s48 offen offset:896 lds
  v_mfma_f32_32x32x16_bf16 v[108:123], v[24:27], v[136:139], v[108:123]
  s_add_u32 m0, s55, 7168
  ds_read_b128 v[24:27], v10 offset:0
  s_waitcnt lgkmcnt(5)
  v_mfma_f32_32x32x16_bf16 v[92:107], a[128:131], v[28:31], v[92:107]
  buffer_load_dwordx4 v2, s[32:35], s48 offen offset:1024 lds
  v_mfma_f32_32x32x16_bf16 v[108:123], v[28:31], v[140:143], v[108:123]
  ds_read_b128 v[28:31], v11 offset:0
  s_waitcnt lgkmcnt(5)
  v_mfma_f32_32x32x16_bf16 v[92:107], a[132:135], v[32:35], v[92:107]
  s_add_u32 s48, s48, s49
  s_sub_u32 s64, s64, 1
  s_cmp_gt_i32 s64, 0
  s_cselect_b32 s48, s48, 1073741824
  s_add_u32 s65, s65, 9216
  s_cmp_eq_u32 s65, 36864
  s_cselect_b32 s65, 0, s65
  s_add_u32 s55, s54, s65
  v_mfma_f32_32x32x16_bf16 v[108:123], v[32:35], v[144:147], v[108:123]
  ds_read_b128 v[32:35], v12 offset:0
  s_waitcnt lgkmcnt(5)
  v_mfma_f32_32x32x16_bf16 v[92:107], a[136:139], v[36:39], v[92:107]
  v_mfma_f32_32x32x16_bf16 v[108:123], v[36:39], v[148:151], v[108:123]
  ds_read_b128 v[36:39], v9 offset:1024
  s_waitcnt lgkmcnt(5)
  v_mfma_f32_32x32x16_bf16 v[92:107], a[140:143], v[40:43], v[92:107]
  v_mfma_f32_32x32x16_bf16 v[108:123], v[40:43], v[152:155], v[108:123]
  s_sub_u32 s50, s50, 1
  s_cmp_lg_u32 s50, 0
  s_cbranch_scc1 .Lconcat_heads__mha_block__memory_aug_recurrent_mem_tr__prompt_kernelkv_loop
.Lconcat_heads__mha_block__memory_aug_recurrent_mem_tr__prompt_kernelkv_tail1:
  s_nop 7
  s_nop 7
  v_cvt_pk_bf16_f32 v44, v92, v93
  v_cvt_pk_bf16_f32 v45, v94, v95
  v_cvt_pk_bf16_f32 v46, v100, v101
  v_cvt_pk_bf16_f32 v47, v102, v103
  buffer_store_dwordx4 v[44:47], v17, s[44:47], s51 offen offset:0 sc1
  v_cvt_pk_bf16_f32 v48, v96, v97
  v_cvt_pk_bf16_f32 v49, v98, v99
  v_cvt_pk_bf16_f32 v50, v104, v105
  v_cvt_pk_bf16_f32 v51, v106, v107
  buffer_store_dwordx4 v[48:51], v17, s[44:47], s51 offen offset:512 sc1
  v_cvt_pk_bf16_f32 v52, v108, v109
  v_cvt_pk_bf16_f32 v53, v110, v111
  v_cvt_pk_bf16_f32 v54, v116, v117
  v_cvt_pk_bf16_f32 v55, v118, v119
  buffer_store_dwordx4 v[52:55], v18, s[44:47], s52 offen offset:0 sc1
  v_cvt_pk_bf16_f32 v56, v112, v113
  v_cvt_pk_bf16_f32 v57, v114, v115
  v_cvt_pk_bf16_f32 v58, v120, v121
  v_cvt_pk_bf16_f32 v59, v122, v123
  buffer_store_dwordx4 v[56:59], v18, s[44:47], s52 offen offset:512 sc1
  s_branch .Lconcat_heads__mha_block__memory_aug_recurrent_mem_tr__prompt_kernelkv_done
.Lconcat_heads__mha_block__memory_aug_recurrent_mem_tr__prompt_kernelkv_tail0:
  s_nop 7
  s_nop 7
  v_cvt_pk_bf16_f32 v44, v60, v61
  v_cvt_pk_bf16_f32 v45, v62, v63
  v_cvt_pk_bf16_f32 v46, v68, v69
  v_cvt_pk_bf16_f32 v47, v70, v71
  buffer_store_dwordx4 v[44:47], v17, s[44:47], s51 offen offset:0 sc1
  v_cvt_pk_bf16_f32 v48, v64, v65
  v_cvt_pk_bf16_f32 v49, v66, v67
  v_cvt_pk_bf16_f32 v50, v72, v73
  v_cvt_pk_bf16_f32 v51, v74, v75
  buffer_store_dwordx4 v[48:51], v17, s[44:47], s51 offen offset:512 sc1
  v_cvt_pk_bf16_f32 v52, v76, v77
  v_cvt_pk_bf16_f32 v53, v78, v79
  v_cvt_pk_bf16_f32 v54, v84, v85
  v_cvt_pk_bf16_f32 v55, v86, v87
  buffer_store_dwordx4 v[52:55], v18, s[44:47], s52 offen offset:0 sc1
  v_cvt_pk_bf16_f32 v56, v80, v81
  v_cvt_pk_bf16_f32 v57, v82, v83
  v_cvt_pk_bf16_f32 v58, v88, v89
  v_cvt_pk_bf16_f32 v59, v90, v91
  buffer_store_dwordx4 v[56:59], v18, s[44:47], s52 offen offset:512 sc1
.Lconcat_heads__mha_block__memory_aug_recurrent_mem_tr__prompt_kernelkv_done:
  s_waitcnt vmcnt(0) lgkmcnt(0)
  s_barrier
  s_mov_b64 exec, 1
  buffer_store_dword v159, off, s[44:47], s72 sc1
  s_mov_b64 exec, -1
  s_mov_b64 exec, 1
  buffer_store_dword v159, off, s[44:47], s73 sc1
  s_mov_b64 exec, -1
  s_mov_b64 exec, 1
  buffer_store_dword v159, off, s[44:47], s74 sc1
  s_mov_b64 exec, -1
.Lconcat_heads__mha_block__memory_aug_recurrent_mem_tr__prompt_kernel_kvx:
  s_mov_b32 s29, s90
  s_cmp_ge_u32 s29, 96
  s_cbranch_scc1 .Lconcat_heads__mha_block__memory_aug_recurrent_mem_tr__prompt_kernel_qx
  s_mov_b32 s32, s10
  s_mov_b32 s33, s11
  s_mov_b32 s34, 2359296
  s_mov_b32 s35, 0x00020000
  s_mov_b32 s36, s14
  s_mov_b32 s37, s15
  s_mov_b32 s38, 4718592
  s_mov_b32 s39, 0x00020000
  s_mov_b32 s40, s14
  s_mov_b32 s41, s15
  s_mov_b32 s42, 4718592
  s_mov_b32 s43, 0x00020000
  s_mov_b32 s44, s26
  s_mov_b32 s45, s27
  s_mov_b32 s46, 268435456
  s_mov_b32 s47, 0x00020000
  s_and_b32 s60, s29, 15
  s_lshr_b32 s61, s29, 4
  s_mov_b32 s59, 8192
  s_lshl_b32 s57, s60, 9
  s_lshl_b32 s62, s28, 6
  s_add_u32 s57, s57, s62
  s_add_u32 s58, s57, 256
  s_mul_i32 s48, s61, 36864
  s_mov_b32 s49, 221184
  s_lshl_b32 s51, s61, 18
  s_lshl_b32 s62, s60, 14
  s_add_u32 s51, s51, s62
  s_lshl_b32 s62, s28, 11
  s_add_u32 s51, s51, s62
  s_add_u32 s51, s51, 33554432
  s_add_u32 s52, s51, 8192
  s_mov_b32 s53, 1572864
  s_cmp_lt_u32 s61, 4
  s_cselect_b32 s50, 11, 10
  s_lshl_b32 s75, s61, 7
  s_lshl_b32 s76, s60, 2
  s_add_u32 s75, s75, s76
  s_add_u32 s75, s75, 70000640
  s_cmp_eq_u32 s28, 0
  s_cselect_b32 s75, s75, 1073741824
  s_cselect_b32 s76, 768, 0
  s_mov_b32 s71, s53
  s_mul_i32 s54, s28, 36864
  v_lshrrev_b32 v19, 3, v1
  s_lshl_b32 s60, s28, 3
  v_add_u32 v19, s60, v19
  v_lshrrev_b32 v2, 1, v19
  v_and_b32 v2, 7, v2
  v_and_b32 v3, 7, v1
  v_xor_b32 v2, v2, v3
  v_lshlrev_b32 v2, 4, v2
  v_mul_u32_u24 v19, 1152, v19
  v_add_u32 v2, v2, v19
  v_lshrrev_b32 v19, 2, v1
  v_mul_lo_u32 v19, v19, s59
  v_and_b32 v3, 3, v1
  v_lshlrev_b32 v3, 4, v3
  v_add_u32 v3, v3, v19
  v_lshrrev_b32 v19, 5, v1
  v_lshlrev_b32 v4, 9, v19
  v_bfe_u32 v5, v1, 2, 2
  v_lshlrev_b32 v5, 6, v5
  v_add_u32 v4, v4, v5
  v_bfe_u32 v5, v1, 4, 1
  v_lshlrev_b32 v5, 5, v5
  v_add_u32 v4, v4, v5
  v_and_b32 v5, 3, v1
  v_lshlrev_b32 v5, 3, v5
  v_add_u32 v4, v4, v5
  v_add_u32 v4, s54, v4
  v_and_b32 v9, 31, v1
  v_lshrrev_b32 v10, 3, v9
  v_mul_u32_u24 v10, 36864, v10
  v_and_b32 v11, 7, v9
  v_lshlrev_b32 v11, 7, v11
  v_add_u32 v10, v10, v11
  v_lshrrev_b32 v11, 1, v9
  v_and_b32 v11, 7, v11
  v_add_u32 v12, 0, v19
  v_xor_b32 v12, v12, v11
  v_lshlrev_b32 v12, 4, v12
  v_add_u32 v5, v10, v12
  v_add_u32 v12, 2, v19
  v_xor_b32 v12, v12, v11
  v_lshlrev_b32 v12, 4, v12
  v_add_u32 v6, v10, v12
  v_add_u32 v12, 4, v19
  v_xor_b32 v12, v12, v11
  v_lshlrev_b32 v12, 4, v12
  v_add_u32 v7, v10, v12
  v_add_u32 v12, 6, v19
  v_xor_b32 v12, v12, v11
  v_lshlrev_b32 v12, 4, v12
  v_add_u32 v8, v10, v12
  v_bfe_u32 v19, v1, 4, 1
  v_lshlrev_b32 v17, 10, v19
  v_and_b32 v19, 15, v1
  v_lshlrev_b32 v19, 4, v19
  v_add_u32 v17, v17, v19
  v_lshrrev_b32 v19, 5, v1
  v_lshlrev_b32 v19, 8, v19
  v_add_u32 v17, v17, v19
  v_bfe_u32 v19, v1, 4, 1
  v_lshlrev_b32 v18, 10, v19
  v_and_b32 v19, 15, v1
  v_lshlrev_b32 v19, 4, v19
  v_add_u32 v18, v18, v19
  v_lshrrev_b32 v19, 5, v1
  v_lshlrev_b32 v19, 8, v19
  v_add_u32 v18, v18, v19
  s_mov_b32 s64, s50
  s_mov_b32 s65, 0
  s_mov_b32 s55, s54
  s_mul_i32 s63, s59, 16
  s_mul_i32 s62, s59, 0
  s_add_u32 s62, s62, s57
  s_add_u32 m0, s54, 0
  s_nop 0
  buffer_load_dwordx4 v3, s[36:39], s62 offen lds
  s_add_u32 m0, s54, 1024
  s_add_u32 s62, s62, s63
  buffer_load_dwordx4 v3, s[36:39], s62 offen lds
  s_add_u32 m0, s54, 2048
  s_add_u32 s62, s62, s63
  buffer_load_dwordx4 v3, s[36:39], s62 offen lds
  s_add_u32 m0, s54, 3072
  s_add_u32 s62, s62, s63
  buffer_load_dwordx4 v3, s[36:39], s62 offen lds
  s_add_u32 m0, s54, 4096
  s_add_u32 s62, s62, s63
  buffer_load_dwordx4 v3, s[36:39], s62 offen lds
  s_add_u32 m0, s54, 5120
  s_add_u32 s62, s62, s63
  buffer_load_dwordx4 v3, s[36:39], s62 offen lds
  s_add_u32 m0, s54, 6144
  s_add_u32 s62, s62, s63
  buffer_load_dwordx4 v3, s[36:39], s62 offen lds
  s_add_u32 m0, s54, 7168
  s_add_u32 s62, s62, s63
  buffer_load_dwordx4 v3, s[36:39], s62 offen lds
  s_add_u32 m0, s54, 8192
  s_add_u32 s62, s62, s63
  buffer_load_dwordx4 v3, s[36:39], s62 offen lds
  s_mul_i32 s62, s59, 144
  s_add_u32 s62, s62, s57
  s_add_u32 m0, s54, 9216
  s_nop 0
  buffer_load_dwordx4 v3, s[36:39], s62 offen lds
  s_add_u32 m0, s54, 10240
  s_add_u32 s62, s62, s63
  buffer_load_dwordx4 v3, s[36:39], s62 offen lds
  s_add_u32 m0, s54, 11264
  s_add_u32 s62, s62, s63
  buffer_load_dwordx4 v3, s[36:39], s62 offen lds
  s_add_u32 m0, s54, 12288
  s_add_u32 s62, s62, s63
  buffer_load_dwordx4 v3, s[36:39], s62 offen lds
  s_add_u32 m0, s54, 13312
  s_add_u32 s62, s62, s63
  buffer_load_dwordx4 v3, s[36:39], s62 offen lds
  s_add_u32 m0, s54, 14336
  s_add_u32 s62, s62, s63
  buffer_load_dwordx4 v3, s[36:39], s62 offen lds
  s_add_u32 m0, s54, 15360
  s_add_u32 s62, s62, s63
  buffer_load_dwordx4 v3, s[36:39], s62 offen lds
  s_add_u32 m0, s54, 16384
  s_add_u32 s62, s62, s63
  buffer_load_dwordx4 v3, s[36:39], s62 offen lds
  s_add_u32 m0, s54, 17408
  s_add_u32 s62, s62, s63
  buffer_load_dwordx4 v3, s[36:39], s62 offen lds
  s_mul_i32 s62, s59, 288
  s_add_u32 s62, s62, s57
  s_add_u32 m0, s54, 18432
  s_nop 0
  buffer_load_dwordx4 v3, s[36:39], s62 offen lds
  s_add_u32 m0, s54, 19456
  s_add_u32 s62, s62, s63
  buffer_load_dwordx4 v3, s[36:39], s62 offen lds
  s_add_u32 m0, s54, 20480
  s_add_u32 s62, s62, s63
  buffer_load_dwordx4 v3, s[36:39], s62 offen lds
  s_add_u32 m0, s54, 21504
  s_add_u32 s62, s62, s63
  buffer_load_dwordx4 v3, s[36:39], s62 offen lds
  s_add_u32 m0, s54, 22528
  s_add_u32 s62, s62, s63
  buffer_load_dwordx4 v3, s[36:39], s62 offen lds
  s_add_u32 m0, s54, 23552
  s_add_u32 s62, s62, s63
  buffer_load_dwordx4 v3, s[36:39], s62 offen lds
  s_add_u32 m0, s54, 24576
  s_add_u32 s62, s62, s63
  buffer_load_dwordx4 v3, s[36:39], s62 offen lds
  s_add_u32 m0, s54, 25600
  s_add_u32 s62, s62, s63
  buffer_load_dwordx4 v3, s[36:39], s62 offen lds
  s_add_u32 m0, s54, 26624
  s_add_u32 s62, s62, s63
  buffer_load_dwordx4 v3, s[36:39], s62 offen lds
  s_mul_i32 s62, s59, 432
  s_add_u32 s62, s62, s57
  s_add_u32 m0, s54, 27648
  s_nop 0
  buffer_load_dwordx4 v3, s[36:39], s62 offen lds
  s_add_u32 m0, s54, 28672
  s_add_u32 s62, s62, s63
  buffer_load_dwordx4 v3, s[36:39], s62 offen lds
  s_add_u32 m0, s54, 29696
  s_add_u32 s62, s62, s63
  buffer_load_dwordx4 v3, s[36:39], s62 offen lds
  s_add_u32 m0, s54, 30720
  s_add_u32 s62, s62, s63
  buffer_load_dwordx4 v3, s[36:39], s62 offen lds
  s_add_u32 m0, s54, 31744
  s_add_u32 s62, s62, s63
  buffer_load_dwordx4 v3, s[36:39], s62 offen lds
  s_add_u32 m0, s54, 32768
  s_add_u32 s62, s62, s63
  buffer_load_dwordx4 v3, s[36:39], s62 offen lds
  s_add_u32 m0, s54, 33792
  s_add_u32 s62, s62, s63
  buffer_load_dwordx4 v3, s[36:39], s62 offen lds
  s_add_u32 m0, s54, 34816
  s_add_u32 s62, s62, s63
  buffer_load_dwordx4 v3, s[36:39], s62 offen lds
  s_add_u32 m0, s54, 35840
  s_add_u32 s62, s62, s63
  buffer_load_dwordx4 v3, s[36:39], s62 offen lds
  s_waitcnt vmcnt(27)
  ds_read_b64_tr_b16 a[0:1], v4 offset:0
  ds_read_b64_tr_b16 a[2:3], v4 offset:256
  ds_read_b64_tr_b16 a[4:5], v4 offset:1024
  ds_read_b64_tr_b16 a[6:7], v4 offset:1280
  ds_read_b64_tr_b16 a[8:9], v4 offset:2048
  ds_read_b64_tr_b16 a[10:11], v4 offset:2304
  ds_read_b64_tr_b16 a[12:13], v4 offset:3072
  ds_read_b64_tr_b16 a[14:15], v4 offset:3328
  ds_read_b64_tr_b16 a[16:17], v4 offset:4096
  ds_read_b64_tr_b16 a[18:19], v4 offset:4352
  ds_read_b64_tr_b16 a[20:21], v4 offset:5120
  ds_read_b64_tr_b16 a[22:23], v4 offset:5376
  ds_read_b64_tr_b16 a[24:25], v4 offset:6144
  ds_read_b64_tr_b16 a[26:27], v4 offset:6400
  ds_read_b64_tr_b16 a[28:29], v4 offset:7168
  ds_read_b64_tr_b16 a[30:31], v4 offset:7424
  ds_read_b64_tr_b16 a[32:33], v4 offset:8192
  ds_read_b64_tr_b16 a[34:35], v4 offset:8448
  s_waitcnt lgkmcnt(0)
  s_mul_i32 s62, s59, 0
  s_add_u32 s62, s62, s58
  s_add_u32 m0, s54, 0
  s_nop 0
  buffer_load_dwordx4 v3, s[40:43], s62 offen lds
  s_add_u32 m0, s54, 1024
  s_add_u32 s62, s62, s63
  buffer_load_dwordx4 v3, s[40:43], s62 offen lds
  s_add_u32 m0, s54, 2048
  s_add_u32 s62, s62, s63
  buffer_load_dwordx4 v3, s[40:43], s62 offen lds
  s_add_u32 m0, s54, 3072
  s_add_u32 s62, s62, s63
  buffer_load_dwordx4 v3, s[40:43], s62 offen lds
  s_add_u32 m0, s54, 4096
  s_add_u32 s62, s62, s63
  buffer_load_dwordx4 v3, s[40:43], s62 offen lds
  s_add_u32 m0, s54, 5120
  s_add_u32 s62, s62, s63
  buffer_load_dwordx4 v3, s[40:43], s62 offen lds
  s_add_u32 m0, s54, 6144
  s_add_u32 s62, s62, s63
  buffer_load_dwordx4 v3, s[40:43], s62 offen lds
  s_add_u32 m0, s54, 7168
  s_add_u32 s62, s62, s63
  buffer_load_dwordx4 v3, s[40:43], s62 offen lds
  s_add_u32 m0, s54, 8192
  s_add_u32 s62, s62, s63
  buffer_load_dwordx4 v3, s[40:43], s62 offen lds
  s_waitcnt vmcnt(27)
  ds_read_b64_tr_b16 a[36:37], v4 offset:9216
  ds_read_b64_tr_b16 a[38:39], v4 offset:9472
  ds_read_b64_tr_b16 a[40:41], v4 offset:10240
  ds_read_b64_tr_b16 a[42:43], v4 offset:10496
  ds_read_b64_tr_b16 a[44:45], v4 offset:11264
  ds_read_b64_tr_b16 a[46:47], v4 offset:11520
  ds_read_b64_tr_b16 a[48:49], v4 offset:12288
  ds_read_b64_tr_b16 a[50:51], v4 offset:12544
  ds_read_b64_tr_b16 a[52:53], v4 offset:13312
  ds_read_b64_tr_b16 a[54:55], v4 offset:13568
  ds_read_b64_tr_b16 a[56:57], v4 offset:14336
  ds_read_b64_tr_b16 a[58:59], v4 offset:14592
  ds_read_b64_tr_b16 a[60:61], v4 offset:15360
  ds_read_b64_tr_b16 a[62:63], v4 offset:15616
  ds_read_b64_tr_b16 a[64:65], v4 offset:16384
  ds_read_b64_tr_b16 a[66:67], v4 offset:16640
  ds_read_b64_tr_b16 a[68:69], v4 offset:17408
  ds_read_b64_tr_b16 a[70:71], v4 offset:17664
  s_waitcnt lgkmcnt(0)
  s_mul_i32 s62, s59, 144
  s_add_u32 s62, s62, s58
  s_add_u32 m0, s54, 9216
  s_nop 0
  buffer_load_dwordx4 v3, s[40:43], s62 offen lds
  s_add_u32 m0, s54, 10240
  s_add_u32 s62, s62, s63
  buffer_load_dwordx4 v3, s[40:43], s62 offen lds
  s_add_u32 m0, s54, 11264
  s_add_u32 s62, s62, s63
  buffer_load_dwordx4 v3, s[40:43], s62 offen lds
  s_add_u32 m0, s54, 12288
  s_add_u32 s62, s62, s63
  buffer_load_dwordx4 v3, s[40:43], s62 offen lds
  s_add_u32 m0, s54, 13312
  s_add_u32 s62, s62, s63
  buffer_load_dwordx4 v3, s[40:43], s62 offen lds
  s_add_u32 m0, s54, 14336
  s_add_u32 s62, s62, s63
  buffer_load_dwordx4 v3, s[40:43], s62 offen lds
  s_add_u32 m0, s54, 15360
  s_add_u32 s62, s62, s63
  buffer_load_dwordx4 v3, s[40:43], s62 offen lds
  s_add_u32 m0, s54, 16384
  s_add_u32 s62, s62, s63
  buffer_load_dwordx4 v3, s[40:43], s62 offen lds
  s_add_u32 m0, s54, 17408
  s_add_u32 s62, s62, s63
  buffer_load_dwordx4 v3, s[40:43], s62 offen lds
  s_waitcnt vmcnt(27)
  ds_read_b64_tr_b16 a[72:73], v4 offset:18432
  ds_read_b64_tr_b16 a[74:75], v4 offset:18688
  ds_read_b64_tr_b16 a[76:77], v4 offset:19456
  ds_read_b64_tr_b16 a[78:79], v4 offset:19712
  ds_read_b64_tr_b16 a[80:81], v4 offset:20480
  ds_read_b64_tr_b16 a[82:83], v4 offset:20736
  ds_read_b64_tr_b16 a[84:85], v4 offset:21504
  ds_read_b64_tr_b16 a[86:87], v4 offset:21760
  ds_read_b64_tr_b16 a[88:89], v4 offset:22528
  ds_read_b64_tr_b16 a[90:91], v4 offset:22784
  ds_read_b64_tr_b16 a[92:93], v4 offset:23552
  ds_read_b64_tr_b16 a[94:95], v4 offset:23808
  ds_read_b64_tr_b16 a[96:97], v4 offset:24576
  ds_read_b64_tr_b16 a[98:99], v4 offset:24832
  ds_read_b64_tr_b16 a[100:101], v4 offset:25600
  ds_read_b64_tr_b16 a[102:103], v4 offset:25856
  ds_read_b64_tr_b16 a[104:105], v4 offset:26624
  ds_read_b64_tr_b16 a[106:107], v4 offset:26880
  s_waitcnt lgkmcnt(0)
  s_mul_i32 s62, s59, 288
  s_add_u32 s62, s62, s58
  s_add_u32 m0, s54, 18432
  s_nop 0
  buffer_load_dwordx4 v3, s[40:43], s62 offen lds
  s_add_u32 m0, s54, 19456
  s_add_u32 s62, s62, s63
  buffer_load_dwordx4 v3, s[40:43], s62 offen lds
  s_add_u32 m0, s54, 20480
  s_add_u32 s62, s62, s63
  buffer_load_dwordx4 v3, s[40:43], s62 offen lds
  s_add_u32 m0, s54, 21504
  s_add_u32 s62, s62, s63
  buffer_load_dwordx4 v3, s[40:43], s62 offen lds
  s_add_u32 m0, s54, 22528
  s_add_u32 s62, s62, s63
  buffer_load_dwordx4 v3, s[40:43], s62 offen lds
  s_add_u32 m0, s54, 23552
  s_add_u32 s62, s62, s63
  buffer_load_dwordx4 v3, s[40:43], s62 offen lds
  s_add_u32 m0, s54, 24576
  s_add_u32 s62, s62, s63
  buffer_load_dwordx4 v3, s[40:43], s62 offen lds
  s_add_u32 m0, s54, 25600
  s_add_u32 s62, s62, s63
  buffer_load_dwordx4 v3, s[40:43], s62 offen lds
  s_add_u32 m0, s54, 26624
  s_add_u32 s62, s62, s63
  buffer_load_dwordx4 v3, s[40:43], s62 offen lds
  s_waitcnt vmcnt(27)
  ds_read_b64_tr_b16 a[108:109], v4 offset:27648
  ds_read_b64_tr_b16 a[110:111], v4 offset:27904
  ds_read_b64_tr_b16 a[112:113], v4 offset:28672
  ds_read_b64_tr_b16 a[114:115], v4 offset:28928
  ds_read_b64_tr_b16 a[116:117], v4 offset:29696
  ds_read_b64_tr_b16 a[118:119], v4 offset:29952
  ds_read_b64_tr_b16 a[120:121], v4 offset:30720
  ds_read_b64_tr_b16 a[122:123], v4 offset:30976
  ds_read_b64_tr_b16 a[124:125], v4 offset:31744
  ds_read_b64_tr_b16 a[126:127], v4 offset:32000
  ds_read_b64_tr_b16 a[128:129], v4 offset:32768
  ds_read_b64_tr_b16 a[130:131], v4 offset:33024
  ds_read_b64_tr_b16 a[132:133], v4 offset:33792
  ds_read_b64_tr_b16 a[134:135], v4 offset:34048
  ds_read_b64_tr_b16 a[136:137], v4 offset:34816
  ds_read_b64_tr_b16 a[138:139], v4 offset:35072
  ds_read_b64_tr_b16 a[140:141], v4 offset:35840
  ds_read_b64_tr_b16 a[142:143], v4 offset:36096
  s_waitcnt lgkmcnt(0)
  s_mul_i32 s62, s59, 432
  s_add_u32 s62, s62, s58
  s_add_u32 m0, s54, 27648
  s_nop 0
  buffer_load_dwordx4 v3, s[40:43], s62 offen lds
  s_add_u32 m0, s54, 28672
  s_add_u32 s62, s62, s63
  buffer_load_dwordx4 v3, s[40:43], s62 offen lds
  s_add_u32 m0, s54, 29696
  s_add_u32 s62, s62, s63
  buffer_load_dwordx4 v3, s[40:43], s62 offen lds
  s_add_u32 m0, s54, 30720
  s_add_u32 s62, s62, s63
  buffer_load_dwordx4 v3, s[40:43], s62 offen lds
  s_add_u32 m0, s54, 31744
  s_add_u32 s62, s62, s63
  buffer_load_dwordx4 v3, s[40:43], s62 offen lds
  s_add_u32 m0, s54, 32768
  s_add_u32 s62, s62, s63
  buffer_load_dwordx4 v3, s[40:43], s62 offen lds
  s_add_u32 m0, s54, 33792
  s_add_u32 s62, s62, s63
  buffer_load_dwordx4 v3, s[40:43], s62 offen lds
  s_add_u32 m0, s54, 34816
  s_add_u32 s62, s62, s63
  buffer_load_dwordx4 v3, s[40:43], s62 offen lds
  s_add_u32 m0, s54, 35840
  s_add_u32 s62, s62, s63
  buffer_load_dwordx4 v3, s[40:43], s62 offen lds
  s_waitcnt vmcnt(27)
  ds_read_b64_tr_b16 a[144:145], v4 offset:0
  ds_read_b64_tr_b16 a[146:147], v4 offset:256
  ds_read_b64_tr_b16 a[148:149], v4 offset:1024
  ds_read_b64_tr_b16 a[150:151], v4 offset:1280
  ds_read_b64_tr_b16 a[152:153], v4 offset:2048
  ds_read_b64_tr_b16 a[154:155], v4 offset:2304
  ds_read_b64_tr_b16 a[156:157], v4 offset:3072
  ds_read_b64_tr_b16 a[158:159], v4 offset:3328
  ds_read_b64_tr_b16 a[160:161], v4 offset:4096
  ds_read_b64_tr_b16 a[162:163], v4 offset:4352
  ds_read_b64_tr_b16 a[164:165], v4 offset:5120
  ds_read_b64_tr_b16 a[166:167], v4 offset:5376
  ds_read_b64_tr_b16 a[168:169], v4 offset:6144
  ds_read_b64_tr_b16 a[170:171], v4 offset:6400
  ds_read_b64_tr_b16 a[172:173], v4 offset:7168
  ds_read_b64_tr_b16 a[174:175], v4 offset:7424
  ds_read_b64_tr_b16 a[176:177], v4 offset:8192
  ds_read_b64_tr_b16 a[178:179], v4 offset:8448
  s_waitcnt lgkmcnt(0)
  s_add_u32 m0, s55, 0
  s_nop 0
  buffer_load_dwordx4 v2, s[32:35], s48 offen offset:0 lds
  s_add_u32 m0, s55, 896
  s_nop 0
  buffer_load_dwordx4 v2, s[32:35], s48 offen offset:128 lds
  s_add_u32 m0, s55, 1792
  s_nop 0
  buffer_load_dwordx4 v2, s[32:35], s48 offen offset:256 lds
  s_add_u32 m0, s55, 2688
  s_nop 0
  buffer_load_dwordx4 v2, s[32:35], s48 offen offset:384 lds
  s_add_u32 m0, s55, 3584
  s_nop 0
  buffer_load_dwordx4 v2, s[32:35], s48 offen offset:512 lds
  s_add_u32 m0, s55, 4480
  s_nop 0
  buffer_load_dwordx4 v2, s[32:35], s48 offen offset:640 lds
  s_add_u32 m0, s55, 5376
  s_nop 0
  buffer_load_dwordx4 v2, s[32:35], s48 offen offset:768 lds
  s_add_u32 m0, s55, 6272
  s_nop 0
  buffer_load_dwordx4 v2, s[32:35], s48 offen offset:896 lds
  s_add_u32 m0, s55, 7168
  s_nop 0
  buffer_load_dwordx4 v2, s[32:35], s48 offen offset:1024 lds
  s_add_u32 s48, s48, s49
  s_sub_u32 s64, s64, 1
  s_cmp_gt_i32 s64, 0
  s_cselect_b32 s48, s48, 1073741824
  s_add_u32 s65, s65, 9216
  s_cmp_eq_u32 s65, 36864
  s_cselect_b32 s65, 0, s65
  s_add_u32 s55, s54, s65
  s_waitcnt vmcnt(27)
  ds_read_b64_tr_b16 a[180:181], v4 offset:9216
  ds_read_b64_tr_b16 a[182:183], v4 offset:9472
  ds_read_b64_tr_b16 a[184:185], v4 offset:10240
  ds_read_b64_tr_b16 a[186:187], v4 offset:10496
  ds_read_b64_tr_b16 a[188:189], v4 offset:11264
  ds_read_b64_tr_b16 a[190:191], v4 offset:11520
  ds_read_b64_tr_b16 a[192:193], v4 offset:12288
  ds_read_b64_tr_b16 a[194:195], v4 offset:12544
  ds_read_b64_tr_b16 a[196:197], v4 offset:13312
  ds_read_b64_tr_b16 a[198:199], v4 offset:13568
  ds_read_b64_tr_b16 a[200:201], v4 offset:14336
  ds_read_b64_tr_b16 a[202:203], v4 offset:14592
  ds_read_b64_tr_b16 a[204:205], v4 offset:15360
  ds_read_b64_tr_b16 a[206:207], v4 offset:15616
  ds_read_b64_tr_b16 a[208:209], v4 offset:16384
  ds_read_b64_tr_b16 a[210:211], v4 offset:16640
  ds_read_b64_tr_b16 a[212:213], v4 offset:17408
  ds_read_b64_tr_b16 a[214:215], v4 offset:17664
  s_waitcnt lgkmcnt(0)
  s_add_u32 m0, s55, 0
  s_nop 0
  buffer_load_dwordx4 v2, s[32:35], s48 offen offset:0 lds
  s_add_u32 m0, s55, 896
  s_nop 0
  buffer_load_dwordx4 v2, s[32:35], s48 offen offset:128 lds
  s_add_u32 m0, s55, 1792
  s_nop 0
  buffer_load_dwordx4 v2, s[32:35], s48 offen offset:256 lds
  s_add_u32 m0, s55, 2688
  s_nop 0
  buffer_load_dwordx4 v2, s[32:35], s48 offen offset:384 lds
  s_add_u32 m0, s55, 3584
  s_nop 0
  buffer_load_dwordx4 v2, s[32:35], s48 offen offset:512 lds
  s_add_u32 m0, s55, 4480
  s_nop 0
  buffer_load_dwordx4 v2, s[32:35], s48 offen offset:640 lds
  s_add_u32 m0, s55, 5376
  s_nop 0
  buffer_load_dwordx4 v2, s[32:35], s48 offen offset:768 lds
  s_add_u32 m0, s55, 6272
  s_nop 0
  buffer_load_dwordx4 v2, s[32:35], s48 offen offset:896 lds
  s_add_u32 m0, s55, 7168
  s_nop 0
  buffer_load_dwordx4 v2, s[32:35], s48 offen offset:1024 lds
  s_add_u32 s48, s48, s49
  s_sub_u32 s64, s64, 1
  s_cmp_gt_i32 s64, 0
  s_cselect_b32 s48, s48, 1073741824
  s_add_u32 s65, s65, 9216
  s_cmp_eq_u32 s65, 36864
  s_cselect_b32 s65, 0, s65
  s_add_u32 s55, s54, s65
  s_waitcnt vmcnt(27)
  ds_read_b64_tr_b16 a[216:217], v4 offset:18432
  ds_read_b64_tr_b16 a[218:219], v4 offset:18688
  ds_read_b64_tr_b16 a[220:221], v4 offset:19456
  ds_read_b64_tr_b16 a[222:223], v4 offset:19712
  ds_read_b64_tr_b16 a[224:225], v4 offset:20480
  ds_read_b64_tr_b16 a[226:227], v4 offset:20736
  ds_read_b64_tr_b16 a[228:229], v4 offset:21504
  ds_read_b64_tr_b16 a[230:231], v4 offset:21760
  ds_read_b64_tr_b16 a[232:233], v4 offset:22528
  ds_read_b64_tr_b16 a[234:235], v4 offset:22784
  ds_read_b64_tr_b16 a[236:237], v4 offset:23552
  ds_read_b64_tr_b16 a[238:239], v4 offset:23808
  ds_read_b64_tr_b16 a[240:241], v4 offset:24576
  ds_read_b64_tr_b16 a[242:243], v4 offset:24832
  ds_read_b64_tr_b16 a[244:245], v4 offset:25600
  ds_read_b64_tr_b16 a[246:247], v4 offset:25856
  ds_read_b64_tr_b16 a[248:249], v4 offset:26624
  ds_read_b64_tr_b16 a[250:251], v4 offset:26880
  s_waitcnt lgkmcnt(0)
  s_add_u32 m0, s55, 0
  s_nop 0
  buffer_load_dwordx4 v2, s[32:35], s48 offen offset:0 lds
  s_add_u32 m0, s55, 896
  s_nop 0
  buffer_load_dwordx4 v2, s[32:35], s48 offen offset:128 lds
  s_add_u32 m0, s55, 1792
  s_nop 0
  buffer_load_dwordx4 v2, s[32:35], s48 offen offset:256 lds
  s_add_u32 m0, s55, 2688
  s_nop 0
  buffer_load_dwordx4 v2, s[32:35], s48 offen offset:384 lds
  s_add_u32 m0, s55, 3584
  s_nop 0
  buffer_load_dwordx4 v2, s[32:35], s48 offen offset:512 lds
  s_add_u32 m0, s55, 4480
  s_nop 0
  buffer_load_dwordx4 v2, s[32:35], s48 offen offset:640 lds
  s_add_u32 m0, s55, 5376
  s_nop 0
  buffer_load_dwordx4 v2, s[32:35], s48 offen offset:768 lds
  s_add_u32 m0, s55, 6272
  s_nop 0
  buffer_load_dwordx4 v2, s[32:35], s48 offen offset:896 lds
  s_add_u32 m0, s55, 7168
  s_nop 0
  buffer_load_dwordx4 v2, s[32:35], s48 offen offset:1024 lds
  s_add_u32 s48, s48, s49
  s_sub_u32 s64, s64, 1
  s_cmp_gt_i32 s64, 0
  s_cselect_b32 s48, s48, 1073741824
  s_add_u32 s65, s65, 9216
  s_cmp_eq_u32 s65, 36864
  s_cselect_b32 s65, 0, s65
  s_add_u32 s55, s54, s65
  s_waitcnt vmcnt(27)
  ds_read_b64_tr_b16 a[252:253], v4 offset:27648
  ds_read_b64_tr_b16 a[254:255], v4 offset:27904
  ds_read_b64_tr_b16 v[124:125], v4 offset:28672
  ds_read_b64_tr_b16 v[126:127], v4 offset:28928
  ds_read_b64_tr_b16 v[128:129], v4 offset:29696
  ds_read_b64_tr_b16 v[130:131], v4 offset:29952
  ds_read_b64_tr_b16 v[132:133], v4 offset:30720
  ds_read_b64_tr_b16 v[134:135], v4 offset:30976
  ds_read_b64_tr_b16 v[136:137], v4 offset:31744
  ds_read_b64_tr_b16 v[138:139], v4 offset:32000
  ds_read_b64_tr_b16 v[140:141], v4 offset:32768
  ds_read_b64_tr_b16 v[142:143], v4 offset:33024
  ds_read_b64_tr_b16 v[144:145], v4 offset:33792
  ds_read_b64_tr_b16 v[146:147], v4 offset:34048
  ds_read_b64_tr_b16 v[148:149], v4 offset:34816
  ds_read_b64_tr_b16 v[150:151], v4 offset:35072
  ds_read_b64_tr_b16 v[152:153], v4 offset:35840
  ds_read_b64_tr_b16 v[154:155], v4 offset:36096
  s_waitcnt lgkmcnt(0)
  v_mov_b32 v250, 72
  s_mov_b32 s95, 4000000
.ww2:
  global_load_dword v251, v250, s[24:25] sc1
  s_waitcnt vmcnt(0)
  v_readfirstlane_b32 s94, v251
  s_cmp_lg_u32 s94, 0
  s_cbranch_scc1 .ww2_ok
  s_sleep 1
  s_sub_u32 s95, s95, 1
  s_cmp_lg_u32 s95, 0
  s_cbranch_scc1 .ww2
.ww2_ok:
  s_mov_b32 s72, 1073741824
  s_mov_b32 s73, 1073741824
  s_mov_b32 s74, 1073741824
  v_mov_b32 v159, 1
  s_mov_b32 s61, s51
  s_mov_b32 s62, s52
  s_mov_b32 s51, 1073741824
  s_mov_b32 s52, 1073741824
  s_mov_b32 s56, 0
  v_mov_b32 v9, v5
  v_mov_b32 v10, v6
  v_mov_b32 v11, v7
  v_mov_b32 v12, v8
  s_waitcnt vmcnt(9)
  s_barrier
  ds_read_b128 v[20:23], v9 offset:0
  ds_read_b128 v[24:27], v10 offset:0
  ds_read_b128 v[28:31], v11 offset:0
  ds_read_b128 v[32:35], v12 offset:0
  ds_read_b128 v[36:39], v9 offset:1024
.Lconcat_heads__mha_block__memory_aug_recurrent_mem_tr__prompt_kernelqq_loop:
  ds_read_b128 v[40:43], v10 offset:1024
  s_waitcnt lgkmcnt(5)
  v_mfma_f32_32x32x16_bf16 v[60:75], a[0:3], v[20:23], 0
  s_add_u32 s56, s56, 9216
  s_cmp_eq_u32 s56, 36864
  s_cselect_b32 s56, 0, s56
  v_mfma_f32_32x32x16_bf16 v[76:91], a[144:147], v[20:23], 0
  v_add_u32 v13, s56, v5
  ds_read_b128 v[20:23], v11 offset:1024
  s_waitcnt lgkmcnt(5)
  v_mfma_f32_32x32x16_bf16 v[60:75], a[4:7], v[24:27], v[60:75]
  v_add_u32 v14, s56, v6
  v_mfma_f32_32x32x16_bf16 v[76:91], a[148:151], v[24:27], v[76:91]
  v_add_u32 v15, s56, v7
  ds_read_b128 v[24:27], v12 offset:1024
  s_waitcnt lgkmcnt(5)
  v_mfma_f32_32x32x16_bf16 v[60:75], a[8:11], v[28:31], v[60:75]
  v_add_u32 v16, s56, v8
  v_mfma_f32_32x32x16_bf16 v[76:91], a[152:155], v[28:31], v[76:91]
  v_cvt_pk_bf16_f32 v44, v92, v93
  ds_read_b128 v[28:31], v9 offset:2048
  s_waitcnt lgkmcnt(5)
  v_mfma_f32_32x32x16_bf16 v[60:75], a[12:15], v[32:35], v[60:75]
  v_cvt_pk_bf16_f32 v45, v94, v95
  v_mfma_f32_32x32x16_bf16 v[76:91], a[156:159], v[32:35], v[76:91]
  v_cvt_pk_bf16_f32 v46, v100, v101
  ds_read_b128 v[32:35], v10 offset:2048
  s_waitcnt lgkmcnt(5)
  v_mfma_f32_32x32x16_bf16 v[60:75], a[16:19], v[36:39], v[60:75]
  v_cvt_pk_bf16_f32 v47, v102, v103
  v_mfma_f32_32x32x16_bf16 v[76:91], a[160:163], v[36:39], v[76:91]
  buffer_store_dwordx4 v[44:47], v17, s[44:47], s51 offen offset:0 sc1
  ds_read_b128 v[36:39], v11 offset:2048
  s_waitcnt lgkmcnt(5)
  v_mfma_f32_32x32x16_bf16 v[60:75], a[20:23], v[40:43], v[60:75]
  v_cvt_pk_bf16_f32 v48, v96, v97
  v_mfma_f32_32x32x16_bf16 v[76:91], a[164:167], v[40:43], v[76:91]
  v_cvt_pk_bf16_f32 v49, v98, v99
  ds_read_b128 v[40:43], v12 offset:2048
  s_waitcnt lgkmcnt(5)
  v_mfma_f32_32x32x16_bf16 v[60:75], a[24:27], v[20:23], v[60:75]
  v_cvt_pk_bf16_f32 v50, v104, v105
  v_mfma_f32_32x32x16_bf16 v[76:91], a[168:171], v[20:23], v[76:91]
  v_cvt_pk_bf16_f32 v51, v106, v107
  ds_read_b128 v[20:23], v9 offset:3072
  s_waitcnt lgkmcnt(5)
  v_mfma_f32_32x32x16_bf16 v[60:75], a[28:31], v[24:27], v[60:75]
  buffer_store_dwordx4 v[48:51], v17, s[44:47], s51 offen offset:512 sc1
  v_mfma_f32_32x32x16_bf16 v[76:91], a[172:175], v[24:27], v[76:91]
  v_cvt_pk_bf16_f32 v52, v108, v109
  ds_read_b128 v[24:27], v10 offset:3072
  s_waitcnt lgkmcnt(5)
  v_mfma_f32_32x32x16_bf16 v[60:75], a[32:35], v[28:31], v[60:75]
  v_cvt_pk_bf16_f32 v53, v110, v111
  v_mfma_f32_32x32x16_bf16 v[76:91], a[176:179], v[28:31], v[76:91]
  v_cvt_pk_bf16_f32 v54, v116, v117
  ds_read_b128 v[28:31], v11 offset:3072
  s_waitcnt lgkmcnt(5)
  v_mfma_f32_32x32x16_bf16 v[60:75], a[36:39], v[32:35], v[60:75]
  v_cvt_pk_bf16_f32 v55, v118, v119
  v_mfma_f32_32x32x16_bf16 v[76:91], a[180:183], v[32:35], v[76:91]
  buffer_store_dwordx4 v[52:55], v18, s[44:47], s52 offen offset:0 sc1
  ds_read_b128 v[32:35], v12 offset:3072
  s_waitcnt lgkmcnt(5)
  v_mfma_f32_32x32x16_bf16 v[60:75], a[40:43], v[36:39], v[60:75]
  v_cvt_pk_bf16_f32 v56, v112, v113
  v_mfma_f32_32x32x16_bf16 v[76:91], a[184:187], v[36:39], v[76:91]
  v_cvt_pk_bf16_f32 v57, v114, v115
  ds_read_b128 v[36:39], v9 offset:4096
  s_waitcnt lgkmcnt(5)
  v_mfma_f32_32x32x16_bf16 v[60:75], a[44:47], v[40:43], v[60:75]
  v_cvt_pk_bf16_f32 v58, v120, v121
  v_mfma_f32_32x32x16_bf16 v[76:91], a[188:191], v[40:43], v[76:91]
  v_cvt_pk_bf16_f32 v59, v122, v123
  ds_read_b128 v[40:43], v10 offset:4096
  s_waitcnt lgkmcnt(5)
  v_mfma_f32_32x32x16_bf16 v[60:75], a[48:51], v[20:23], v[60:75]
  buffer_store_dwordx4 v[56:59], v18, s[44:47], s52 offen offset:512 sc1
  v_mfma_f32_32x32x16_bf16 v[76:91], a[192:195], v[20:23], v[76:91]
  ds_read_b128 v[20:23], v11 offset:4096
  s_waitcnt lgkmcnt(5)
  v_mfma_f32_32x32x16_bf16 v[60:75], a[52:55], v[24:27], v[60:75]
  v_mfma_f32_32x32x16_bf16 v[76:91], a[196:199], v[24:27], v[76:91]
  ds_read_b128 v[24:27], v12 offset:4096
  s_waitcnt lgkmcnt(5)
  v_mfma_f32_32x32x16_bf16 v[60:75], a[56:59], v[28:31], v[60:75]
  v_mfma_f32_32x32x16_bf16 v[76:91], a[200:203], v[28:31], v[76:91]
  ds_read_b128 v[28:31], v9 offset:5120
  s_waitcnt lgkmcnt(5)
  v_mfma_f32_32x32x16_bf16 v[60:75], a[60:63], v[32:35], v[60:75]
  v_mfma_f32_32x32x16_bf16 v[76:91], a[204:207], v[32:35], v[76:91]
  ds_read_b128 v[32:35], v10 offset:5120
  s_waitcnt lgkmcnt(5)
  v_mfma_f32_32x32x16_bf16 v[60:75], a[64:67], v[36:39], v[60:75]
  v_mfma_f32_32x32x16_bf16 v[76:91], a[208:211], v[36:39], v[76:91]
  ds_read_b128 v[36:39], v11 offset:5120
  s_waitcnt lgkmcnt(5)
  v_mfma_f32_32x32x16_bf16 v[60:75], a[68:71], v[40:43], v[60:75]
  v_mfma_f32_32x32x16_bf16 v[76:91], a[212:215], v[40:43], v[76:91]
  ds_read_b128 v[40:43], v12 offset:5120
  s_waitcnt lgkmcnt(5)
  v_mfma_f32_32x32x16_bf16 v[60:75], a[72:75], v[20:23], v[60:75]
  v_mfma_f32_32x32x16_bf16 v[76:91], a[216:219], v[20:23], v[76:91]
  ds_read_b128 v[20:23], v9 offset:6144
  s_waitcnt lgkmcnt(5)
  v_mfma_f32_32x32x16_bf16 v[60:75], a[76:79], v[24:27], v[60:75]
  v_mfma_f32_32x32x16_bf16 v[76:91], a[220:223], v[24:27], v[76:91]
  ds_read_b128 v[24:27], v10 offset:6144
  s_waitcnt lgkmcnt(5)
  v_mfma_f32_32x32x16_bf16 v[60:75], a[80:83], v[28:31], v[60:75]
  v_mfma_f32_32x32x16_bf16 v[76:91], a[224:227], v[28:31], v[76:91]
  ds_read_b128 v[28:31], v11 offset:6144
  s_waitcnt lgkmcnt(5)
  v_mfma_f32_32x32x16_bf16 v[60:75], a[84:87], v[32:35], v[60:75]
  v_mfma_f32_32x32x16_bf16 v[76:91], a[228:231], v[32:35], v[76:91]
  ds_read_b128 v[32:35], v12 offset:6144
  s_waitcnt lgkmcnt(5)
  v_mfma_f32_32x32x16_bf16 v[60:75], a[88:91], v[36:39], v[60:75]
  s_mov_b32 s51, s61
  s_mov_b32 s52, s62
  s_add_u32 s61, s61, s53
  s_add_u32 s62, s62, s71
  v_mfma_f32_32x32x16_bf16 v[76:91], a[232:235], v[36:39], v[76:91]
  s_waitcnt vmcnt(18)
  s_barrier
  ds_read_b128 v[36:39], v9 offset:7168
  s_waitcnt lgkmcnt(5)
  v_mfma_f32_32x32x16_bf16 v[60:75], a[92:95], v[40:43], v[60:75]
  s_mov_b64 exec, 1
  buffer_store_dword v159, off, s[44:47], s72 sc1
  s_mov_b64 exec, -1
  s_mov_b32 s72, s73
  s_mov_b32 s73, s74
  s_mov_b32 s74, s75
  s_add_u32 s75, s75, s76
  v_mfma_f32_32x32x16_bf16 v[76:91], a[236:239], v[40:43], v[76:91]
  s_add_u32 m0, s55, 0
  ds_read_b128 v[40:43], v10 offset:7168
  s_waitcnt lgkmcnt(5)
  v_mfma_f32_32x32x16_bf16 v[60:75], a[96:99], v[20:23], v[60:75]
  buffer_load_dwordx4 v2, s[32:35], s48 offen offset:0 lds
  v_mfma_f32_32x32x16_bf16 v[76:91], a[240:243], v[20:23], v[76:91]
  s_add_u32 m0, s55, 896
  ds_read_b128 v[20:23], v11 offset:7168
  s_waitcnt lgkmcnt(5)
  v_mfma_f32_32x32x16_bf16 v[60:75], a[100:103], v[24:27], v[60:75]
  buffer_load_dwordx4 v2, s[32:35], s48 offen offset:128 lds
  v_mfma_f32_32x32x16_bf16 v[76:91], a[244:247], v[24:27], v[76:91]
  s_add_u32 m0, s55, 1792
  ds_read_b128 v[24:27], v12 offset:7168
  s_waitcnt lgkmcnt(5)
  v_mfma_f32_32x32x16_bf16 v[60:75], a[104:107], v[28:31], v[60:75]
  buffer_load_dwordx4 v2, s[32:35], s48 offen offset:256 lds
  v_mfma_f32_32x32x16_bf16 v[76:91], a[248:251], v[28:31], v[76:91]
  s_add_u32 m0, s55, 2688
  ds_read_b128 v[28:31], v9 offset:8192
  s_waitcnt lgkmcnt(5)
  v_mfma_f32_32x32x16_bf16 v[60:75], a[108:111], v[32:35], v[60:75]
  buffer_load_dwordx4 v2, s[32:35], s48 offen offset:384 lds
  v_mfma_f32_32x32x16_bf16 v[76:91], a[252:255], v[32:35], v[76:91]
  s_add_u32 m0, s55, 3584
  ds_read_b128 v[32:35], v10 offset:8192
  s_waitcnt lgkmcnt(5)
  v_mfma_f32_32x32x16_bf16 v[60:75], a[112:115], v[36:39], v[60:75]
  buffer_load_dwordx4 v2, s[32:35], s48 offen offset:512 lds
  v_mfma_f32_32x32x16_bf16 v[76:91], v[124:127], v[36:39], v[76:91]
  s_add_u32 m0, s55, 4480
  ds_read_b128 v[36:39], v11 offset:8192
  s_waitcnt lgkmcnt(5)
  v_mfma_f32_32x32x16_bf16 v[60:75], a[116:119], v[40:43], v[60:75]
  buffer_load_dwordx4 v2, s[32:35], s48 offen offset:640 lds
  v_mfma_f32_32x32x16_bf16 v[76:91], v[128:131], v[40:43], v[76:91]
  s_add_u32 m0, s55, 5376
  ds_read_b128 v[40:43], v12 offset:8192
  s_waitcnt lgkmcnt(5)
  v_mfma_f32_32x32x16_bf16 v[60:75], a[120:123], v[20:23], v[60:75]
  buffer_load_dwordx4 v2, s[32:35], s48 offen offset:768 lds
  v_mfma_f32_32x32x16_bf16 v[76:91], v[132:135], v[20:23], v[76:91]
  s_add_u32 m0, s55, 6272
  ds_read_b128 v[20:23], v13 offset:0
  s_waitcnt lgkmcnt(5)
  v_mfma_f32_32x32x16_bf16 v[60:75], a[124:127], v[24:27], v[60:75]
  buffer_load_dwordx4 v2, s[32:35], s48 offen offset:896 lds
  v_mfma_f32_32x32x16_bf16 v[76:91], v[136:139], v[24:27], v[76:91]
  s_add_u32 m0, s55, 7168
  ds_read_b128 v[24:27], v14 offset:0
  s_waitcnt lgkmcnt(5)
  v_mfma_f32_32x32x16_bf16 v[60:75], a[128:131], v[28:31], v[60:75]
  buffer_load_dwordx4 v2, s[32:35], s48 offen offset:1024 lds
  v_mfma_f32_32x32x16_bf16 v[76:91], v[140:143], v[28:31], v[76:91]
  ds_read_b128 v[28:31], v15 offset:0
  s_waitcnt lgkmcnt(5)
  v_mfma_f32_32x32x16_bf16 v[60:75], a[132:135], v[32:35], v[60:75]
  s_add_u32 s48, s48, s49
  s_sub_u32 s64, s64, 1
  s_cmp_gt_i32 s64, 0
  s_cselect_b32 s48, s48, 1073741824
  s_add_u32 s65, s65, 9216
  s_cmp_eq_u32 s65, 36864
  s_cselect_b32 s65, 0, s65
  s_add_u32 s55, s54, s65
  v_mfma_f32_32x32x16_bf16 v[76:91], v[144:147], v[32:35], v[76:91]
  ds_read_b128 v[32:35], v16 offset:0
  s_waitcnt lgkmcnt(5)
  v_mfma_f32_32x32x16_bf16 v[60:75], a[136:139], v[36:39], v[60:75]
  v_mfma_f32_32x32x16_bf16 v[76:91], v[148:151], v[36:39], v[76:91]
  ds_read_b128 v[36:39], v13 offset:1024
  s_waitcnt lgkmcnt(5)
  v_mfma_f32_32x32x16_bf16 v[60:75], a[140:143], v[40:43], v[60:75]
  v_mfma_f32_32x32x16_bf16 v[76:91], v[152:155], v[40:43], v[76:91]
  s_sub_u32 s50, s50, 1
  s_cmp_eq_u32 s50, 0
  s_cbranch_scc1 .Lconcat_heads__mha_block__memory_aug_recurrent_mem_tr__prompt_kernelqq_tail0
  ds_read_b128 v[40:43], v14 offset:1024
  s_waitcnt lgkmcnt(5)
  v_mfma_f32_32x32x16_bf16 v[92:107], a[0:3], v[20:23], 0
  s_add_u32 s56, s56, 9216
  s_cmp_eq_u32 s56, 36864
  s_cselect_b32 s56, 0, s56
  v_mfma_f32_32x32x16_bf16 v[108:123], a[144:147], v[20:23], 0
  v_add_u32 v9, s56, v5
  ds_read_b128 v[20:23], v15 offset:1024
  s_waitcnt lgkmcnt(5)
  v_mfma_f32_32x32x16_bf16 v[92:107], a[4:7], v[24:27], v[92:107]
  v_add_u32 v10, s56, v6
  v_mfma_f32_32x32x16_bf16 v[108:123], a[148:151], v[24:27], v[108:123]
  v_add_u32 v11, s56, v7
  ds_read_b128 v[24:27], v16 offset:1024
  s_waitcnt lgkmcnt(5)
  v_mfma_f32_32x32x16_bf16 v[92:107], a[8:11], v[28:31], v[92:107]
  v_add_u32 v12, s56, v8
  v_mfma_f32_32x32x16_bf16 v[108:123], a[152:155], v[28:31], v[108:123]
  v_cvt_pk_bf16_f32 v44, v60, v61
  ds_read_b128 v[28:31], v13 offset:2048
  s_waitcnt lgkmcnt(5)
  v_mfma_f32_32x32x16_bf16 v[92:107], a[12:15], v[32:35], v[92:107]
  v_cvt_pk_bf16_f32 v45, v62, v63
  v_mfma_f32_32x32x16_bf16 v[108:123], a[156:159], v[32:35], v[108:123]
  v_cvt_pk_bf16_f32 v46, v68, v69
  ds_read_b128 v[32:35], v14 offset:2048
  s_waitcnt lgkmcnt(5)
  v_mfma_f32_32x32x16_bf16 v[92:107], a[16:19], v[36:39], v[92:107]
  v_cvt_pk_bf16_f32 v47, v70, v71
  v_mfma_f32_32x32x16_bf16 v[108:123], a[160:163], v[36:39], v[108:123]
  buffer_store_dwordx4 v[44:47], v17, s[44:47], s51 offen offset:0 sc1
  ds_read_b128 v[36:39], v15 offset:2048
  s_waitcnt lgkmcnt(5)
  v_mfma_f32_32x32x16_bf16 v[92:107], a[20:23], v[40:43], v[92:107]
  v_cvt_pk_bf16_f32 v48, v64, v65
  v_mfma_f32_32x32x16_bf16 v[108:123], a[164:167], v[40:43], v[108:123]
  v_cvt_pk_bf16_f32 v49, v66, v67
  ds_read_b128 v[40:43], v16 offset:2048
  s_waitcnt lgkmcnt(5)
  v_mfma_f32_32x32x16_bf16 v[92:107], a[24:27], v[20:23], v[92:107]
  v_cvt_pk_bf16_f32 v50, v72, v73
  v_mfma_f32_32x32x16_bf16 v[108:123], a[168:171], v[20:23], v[108:123]
  v_cvt_pk_bf16_f32 v51, v74, v75
  ds_read_b128 v[20:23], v13 offset:3072
  s_waitcnt lgkmcnt(5)
  v_mfma_f32_32x32x16_bf16 v[92:107], a[28:31], v[24:27], v[92:107]
  buffer_store_dwordx4 v[48:51], v17, s[44:47], s51 offen offset:512 sc1
  v_mfma_f32_32x32x16_bf16 v[108:123], a[172:175], v[24:27], v[108:123]
  v_cvt_pk_bf16_f32 v52, v76, v77
  ds_read_b128 v[24:27], v14 offset:3072
  s_waitcnt lgkmcnt(5)
  v_mfma_f32_32x32x16_bf16 v[92:107], a[32:35], v[28:31], v[92:107]
  v_cvt_pk_bf16_f32 v53, v78, v79
  v_mfma_f32_32x32x16_bf16 v[108:123], a[176:179], v[28:31], v[108:123]
  v_cvt_pk_bf16_f32 v54, v84, v85
  ds_read_b128 v[28:31], v15 offset:3072
  s_waitcnt lgkmcnt(5)
  v_mfma_f32_32x32x16_bf16 v[92:107], a[36:39], v[32:35], v[92:107]
  v_cvt_pk_bf16_f32 v55, v86, v87
  v_mfma_f32_32x32x16_bf16 v[108:123], a[180:183], v[32:35], v[108:123]
  buffer_store_dwordx4 v[52:55], v18, s[44:47], s52 offen offset:0 sc1
  ds_read_b128 v[32:35], v16 offset:3072
  s_waitcnt lgkmcnt(5)
  v_mfma_f32_32x32x16_bf16 v[92:107], a[40:43], v[36:39], v[92:107]
  v_cvt_pk_bf16_f32 v56, v80, v81
  v_mfma_f32_32x32x16_bf16 v[108:123], a[184:187], v[36:39], v[108:123]
  v_cvt_pk_bf16_f32 v57, v82, v83
  ds_read_b128 v[36:39], v13 offset:4096
  s_waitcnt lgkmcnt(5)
  v_mfma_f32_32x32x16_bf16 v[92:107], a[44:47], v[40:43], v[92:107]
  v_cvt_pk_bf16_f32 v58, v88, v89
  v_mfma_f32_32x32x16_bf16 v[108:123], a[188:191], v[40:43], v[108:123]
  v_cvt_pk_bf16_f32 v59, v90, v91
  ds_read_b128 v[40:43], v14 offset:4096
  s_waitcnt lgkmcnt(5)
  v_mfma_f32_32x32x16_bf16 v[92:107], a[48:51], v[20:23], v[92:107]
  buffer_store_dwordx4 v[56:59], v18, s[44:47], s52 offen offset:512 sc1
  v_mfma_f32_32x32x16_bf16 v[108:123], a[192:195], v[20:23], v[108:123]
  ds_read_b128 v[20:23], v15 offset:4096
  s_waitcnt lgkmcnt(5)
  v_mfma_f32_32x32x16_bf16 v[92:107], a[52:55], v[24:27], v[92:107]
  v_mfma_f32_32x32x16_bf16 v[108:123], a[196:199], v[24:27], v[108:123]
  ds_read_b128 v[24:27], v16 offset:4096
  s_waitcnt lgkmcnt(5)
  v_mfma_f32_32x32x16_bf16 v[92:107], a[56:59], v[28:31], v[92:107]
  v_mfma_f32_32x32x16_bf16 v[108:123], a[200:203], v[28:31], v[108:123]
  ds_read_b128 v[28:31], v13 offset:5120
  s_waitcnt lgkmcnt(5)
  v_mfma_f32_32x32x16_bf16 v[92:107], a[60:63], v[32:35], v[92:107]
  v_mfma_f32_32x32x16_bf16 v[108:123], a[204:207], v[32:35], v[108:123]
  ds_read_b128 v[32:35], v14 offset:5120
  s_waitcnt lgkmcnt(5)
  v_mfma_f32_32x32x16_bf16 v[92:107], a[64:67], v[36:39], v[92:107]
  v_mfma_f32_32x32x16_bf16 v[108:123], a[208:211], v[36:39], v[108:123]
  ds_read_b128 v[36:39], v15 offset:5120
  s_waitcnt lgkmcnt(5)
  v_mfma_f32_32x32x16_bf16 v[92:107], a[68:71], v[40:43], v[92:107]
  v_mfma_f32_32x32x16_bf16 v[108:123], a[212:215], v[40:43], v[108:123]
  ds_read_b128 v[40:43], v16 offset:5120
  s_waitcnt lgkmcnt(5)
  v_mfma_f32_32x32x16_bf16 v[92:107], a[72:75], v[20:23], v[92:107]
  v_mfma_f32_32x32x16_bf16 v[108:123], a[216:219], v[20:23], v[108:123]
  ds_read_b128 v[20:23], v13 offset:6144
  s_waitcnt lgkmcnt(5)
  v_mfma_f32_32x32x16_bf16 v[92:107], a[76:79], v[24:27], v[92:107]
  v_mfma_f32_32x32x16_bf16 v[108:123], a[220:223], v[24:27], v[108:123]
  ds_read_b128 v[24:27], v14 offset:6144
  s_waitcnt lgkmcnt(5)
  v_mfma_f32_32x32x16_bf16 v[92:107], a[80:83], v[28:31], v[92:107]
  v_mfma_f32_32x32x16_bf16 v[108:123], a[224:227], v[28:31], v[108:123]
  ds_read_b128 v[28:31], v15 offset:6144
  s_waitcnt lgkmcnt(5)
  v_mfma_f32_32x32x16_bf16 v[92:107], a[84:87], v[32:35], v[92:107]
  v_mfma_f32_32x32x16_bf16 v[108:123], a[228:231], v[32:35], v[108:123]
  ds_read_b128 v[32:35], v16 offset:6144
  s_waitcnt lgkmcnt(5)
  v_mfma_f32_32x32x16_bf16 v[92:107], a[88:91], v[36:39], v[92:107]
  s_mov_b32 s51, s61
  s_mov_b32 s52, s62
  s_add_u32 s61, s61, s53
  s_add_u32 s62, s62, s71
  v_mfma_f32_32x32x16_bf16 v[108:123], a[232:235], v[36:39], v[108:123]
  s_waitcnt vmcnt(18)
  s_barrier
  ds_read_b128 v[36:39], v13 offset:7168
  s_waitcnt lgkmcnt(5)
  v_mfma_f32_32x32x16_bf16 v[92:107], a[92:95], v[40:43], v[92:107]
  s_mov_b64 exec, 1
  buffer_store_dword v159, off, s[44:47], s72 sc1
  s_mov_b64 exec, -1
  s_mov_b32 s72, s73
  s_mov_b32 s73, s74
  s_mov_b32 s74, s75
  s_add_u32 s75, s75, s76
  v_mfma_f32_32x32x16_bf16 v[108:123], a[236:239], v[40:43], v[108:123]
  s_add_u32 m0, s55, 0
  ds_read_b128 v[40:43], v14 offset:7168
  s_waitcnt lgkmcnt(5)
  v_mfma_f32_32x32x16_bf16 v[92:107], a[96:99], v[20:23], v[92:107]
  buffer_load_dwordx4 v2, s[32:35], s48 offen offset:0 lds
  v_mfma_f32_32x32x16_bf16 v[108:123], a[240:243], v[20:23], v[108:123]
  s_add_u32 m0, s55, 896
  ds_read_b128 v[20:23], v15 offset:7168
  s_waitcnt lgkmcnt(5)
  v_mfma_f32_32x32x16_bf16 v[92:107], a[100:103], v[24:27], v[92:107]
  buffer_load_dwordx4 v2, s[32:35], s48 offen offset:128 lds
  v_mfma_f32_32x32x16_bf16 v[108:123], a[244:247], v[24:27], v[108:123]
  s_add_u32 m0, s55, 1792
  ds_read_b128 v[24:27], v16 offset:7168
  s_waitcnt lgkmcnt(5)
  v_mfma_f32_32x32x16_bf16 v[92:107], a[104:107], v[28:31], v[92:107]
  buffer_load_dwordx4 v2, s[32:35], s48 offen offset:256 lds
  v_mfma_f32_32x32x16_bf16 v[108:123], a[248:251], v[28:31], v[108:123]
  s_add_u32 m0, s55, 2688
  ds_read_b128 v[28:31], v13 offset:8192
  s_waitcnt lgkmcnt(5)
  v_mfma_f32_32x32x16_bf16 v[92:107], a[108:111], v[32:35], v[92:107]
  buffer_load_dwordx4 v2, s[32:35], s48 offen offset:384 lds
  v_mfma_f32_32x32x16_bf16 v[108:123], a[252:255], v[32:35], v[108:123]
  s_add_u32 m0, s55, 3584
  ds_read_b128 v[32:35], v14 offset:8192
  s_waitcnt lgkmcnt(5)
  v_mfma_f32_32x32x16_bf16 v[92:107], a[112:115], v[36:39], v[92:107]
  buffer_load_dwordx4 v2, s[32:35], s48 offen offset:512 lds
  v_mfma_f32_32x32x16_bf16 v[108:123], v[124:127], v[36:39], v[108:123]
  s_add_u32 m0, s55, 4480
  ds_read_b128 v[36:39], v15 offset:8192
  s_waitcnt lgkmcnt(5)
  v_mfma_f32_32x32x16_bf16 v[92:107], a[116:119], v[40:43], v[92:107]
  buffer_load_dwordx4 v2, s[32:35], s48 offen offset:640 lds
  v_mfma_f32_32x32x16_bf16 v[108:123], v[128:131], v[40:43], v[108:123]
  s_add_u32 m0, s55, 5376
  ds_read_b128 v[40:43], v16 offset:8192
  s_waitcnt lgkmcnt(5)
  v_mfma_f32_32x32x16_bf16 v[92:107], a[120:123], v[20:23], v[92:107]
  buffer_load_dwordx4 v2, s[32:35], s48 offen offset:768 lds
  v_mfma_f32_32x32x16_bf16 v[108:123], v[132:135], v[20:23], v[108:123]
  s_add_u32 m0, s55, 6272
  ds_read_b128 v[20:23], v9 offset:0
  s_waitcnt lgkmcnt(5)
  v_mfma_f32_32x32x16_bf16 v[92:107], a[124:127], v[24:27], v[92:107]
  buffer_load_dwordx4 v2, s[32:35], s48 offen offset:896 lds
  v_mfma_f32_32x32x16_bf16 v[108:123], v[136:139], v[24:27], v[108:123]
  s_add_u32 m0, s55, 7168
  ds_read_b128 v[24:27], v10 offset:0
  s_waitcnt lgkmcnt(5)
  v_mfma_f32_32x32x16_bf16 v[92:107], a[128:131], v[28:31], v[92:107]
  buffer_load_dwordx4 v2, s[32:35], s48 offen offset:1024 lds
  v_mfma_f32_32x32x16_bf16 v[108:123], v[140:143], v[28:31], v[108:123]
  ds_read_b128 v[28:31], v11 offset:0
  s_waitcnt lgkmcnt(5)
  v_mfma_f32_32x32x16_bf16 v[92:107], a[132:135], v[32:35], v[92:107]
  s_add_u32 s48, s48, s49
  s_sub_u32 s64, s64, 1
  s_cmp_gt_i32 s64, 0
  s_cselect_b32 s48, s48, 1073741824
  s_add_u32 s65, s65, 9216
  s_cmp_eq_u32 s65, 36864
  s_cselect_b32 s65, 0, s65
  s_add_u32 s55, s54, s65
  v_mfma_f32_32x32x16_bf16 v[108:123], v[144:147], v[32:35], v[108:123]
  ds_read_b128 v[32:35], v12 offset:0
  s_waitcnt lgkmcnt(5)
  v_mfma_f32_32x32x16_bf16 v[92:107], a[136:139], v[36:39], v[92:107]
  v_mfma_f32_32x32x16_bf16 v[108:123], v[148:151], v[36:39], v[108:123]
  ds_read_b128 v[36:39], v9 offset:1024
  s_waitcnt lgkmcnt(5)
  v_mfma_f32_32x32x16_bf16 v[92:107], a[140:143], v[40:43], v[92:107]
  v_mfma_f32_32x32x16_bf16 v[108:123], v[152:155], v[40:43], v[108:123]
  s_sub_u32 s50, s50, 1
  s_cmp_lg_u32 s50, 0
  s_cbranch_scc1 .Lconcat_heads__mha_block__memory_aug_recurrent_mem_tr__prompt_kernelqq_loop
.Lconcat_heads__mha_block__memory_aug_recurrent_mem_tr__prompt_kernelqq_tail1:
  s_nop 7
  s_nop 7
  v_cvt_pk_bf16_f32 v44, v92, v93
  v_cvt_pk_bf16_f32 v45, v94, v95
  v_cvt_pk_bf16_f32 v46, v100, v101
  v_cvt_pk_bf16_f32 v47, v102, v103
  buffer_store_dwordx4 v[44:47], v17, s[44:47], s51 offen offset:0 sc1
  v_cvt_pk_bf16_f32 v48, v96, v97
  v_cvt_pk_bf16_f32 v49, v98, v99
  v_cvt_pk_bf16_f32 v50, v104, v105
  v_cvt_pk_bf16_f32 v51, v106, v107
  buffer_store_dwordx4 v[48:51], v17, s[44:47], s51 offen offset:512 sc1
  v_cvt_pk_bf16_f32 v52, v108, v109
  v_cvt_pk_bf16_f32 v53, v110, v111
  v_cvt_pk_bf16_f32 v54, v116, v117
  v_cvt_pk_bf16_f32 v55, v118, v119
  buffer_store_dwordx4 v[52:55], v18, s[44:47], s52 offen offset:0 sc1
  v_cvt_pk_bf16_f32 v56, v112, v113
  v_cvt_pk_bf16_f32 v57, v114, v115
  v_cvt_pk_bf16_f32 v58, v120, v121
  v_cvt_pk_bf16_f32 v59, v122, v123
  buffer_store_dwordx4 v[56:59], v18, s[44:47], s52 offen offset:512 sc1
  s_branch .Lconcat_heads__mha_block__memory_aug_recurrent_mem_tr__prompt_kernelqq_done
.Lconcat_heads__mha_block__memory_aug_recurrent_mem_tr__prompt_kernelqq_tail0:
  s_nop 7
  s_nop 7
  v_cvt_pk_bf16_f32 v44, v60, v61
  v_cvt_pk_bf16_f32 v45, v62, v63
  v_cvt_pk_bf16_f32 v46, v68, v69
  v_cvt_pk_bf16_f32 v47, v70, v71
  buffer_store_dwordx4 v[44:47], v17, s[44:47], s51 offen offset:0 sc1
  v_cvt_pk_bf16_f32 v48, v64, v65
  v_cvt_pk_bf16_f32 v49, v66, v67
  v_cvt_pk_bf16_f32 v50, v72, v73
  v_cvt_pk_bf16_f32 v51, v74, v75
  buffer_store_dwordx4 v[48:51], v17, s[44:47], s51 offen offset:512 sc1
  v_cvt_pk_bf16_f32 v52, v76, v77
  v_cvt_pk_bf16_f32 v53, v78, v79
  v_cvt_pk_bf16_f32 v54, v84, v85
  v_cvt_pk_bf16_f32 v55, v86, v87
  buffer_store_dwordx4 v[52:55], v18, s[44:47], s52 offen offset:0 sc1
  v_cvt_pk_bf16_f32 v56, v80, v81
  v_cvt_pk_bf16_f32 v57, v82, v83
  v_cvt_pk_bf16_f32 v58, v88, v89
  v_cvt_pk_bf16_f32 v59, v90, v91
  buffer_store_dwordx4 v[56:59], v18, s[44:47], s52 offen offset:512 sc1
.Lconcat_heads__mha_block__memory_aug_recurrent_mem_tr__prompt_kernelqq_done:
  s_waitcnt vmcnt(0) lgkmcnt(0)
  s_barrier
  s_mov_b64 exec, 1
  buffer_store_dword v159, off, s[44:47], s72 sc1
  s_mov_b64 exec, -1
  s_mov_b64 exec, 1
  buffer_store_dword v159, off, s[44:47], s73 sc1
  s_mov_b64 exec, -1
  s_mov_b64 exec, 1
  buffer_store_dword v159, off, s[44:47], s74 sc1
  s_mov_b64 exec, -1
.Lconcat_heads__mha_block__memory_aug_recurrent_mem_tr__prompt_kernel_qx:
  s_cmp_ge_u32 s90, 54
  s_cbranch_scc1 .Lconcat_heads__mha_block__memory_aug_recurrent_mem_tr__prompt_kernel_xa
  s_mov_b32 s29, s90
  v_mov_b32 v250, 72
  s_mov_b32 s95, 4000000
.ww3:
  global_load_dword v251, v250, s[24:25] sc1
  s_waitcnt vmcnt(0)
  v_readfirstlane_b32 s94, v251
  s_cmp_lg_u32 s94, 0
  s_cbranch_scc1 .ww3_ok
  s_sleep 1
  s_sub_u32 s95, s95, 1
  s_cmp_lg_u32 s95, 0
  s_cbranch_scc1 .ww3
.ww3_ok:
  s_mul_i32 s61, s29, 3641
  s_lshr_b32 s61, s61, 16
  s_mul_i32 s60, s61, 18
  s_sub_u32 s60, s29, s60
  s_mov_b32 s32, s26
  s_mov_b32 s33, s27
  s_mov_b32 s34, 268435456
  s_mov_b32 s35, 0x00020000
  s_mov_b32 s36, s20
  s_mov_b32 s37, s21
  s_mov_b32 s38, 4718592
  s_mov_b32 s39, 0x00020000
  s_mov_b32 s44, s22
  s_mov_b32 s45, s23
  s_mov_b32 s46, 4718592
  s_mov_b32 s47, 0x00020000
  s_mul_i32 s54, s28, 36864
  v_lshlrev_b32 v2, 4, v1
  v_lshrrev_b32 v5, 2, v1
  v_mul_u32_u24 v5, 1152, v5
  v_and_b32 v3, 3, v1
  v_lshlrev_b32 v3, 4, v3
  v_add_u32 v3, v3, v5
  v_lshrrev_b32 v5, 5, v1
  v_lshlrev_b32 v4, 8, v5
  v_bfe_u32 v5, v1, 2, 2
  v_lshlrev_b32 v5, 6, v5
  v_add_u32 v4, v4, v5
  v_bfe_u32 v5, v1, 4, 1
  v_lshlrev_b32 v5, 5, v5
  v_add_u32 v4, v4, v5
  v_and_b32 v5, 3, v1
  v_lshlrev_b32 v5, 3, v5
  v_add_u32 v4, v4, v5
  v_add_u32 v4, s54, v4
  s_mul_i32 s55, s28, 1179648
  s_lshl_b32 s56, s60, 6
  s_add_u32 s55, s55, s56
  v_and_b32 v5, 31, v1
  v_mul_u32_u24 v5, 2304, v5
  v_lshrrev_b32 v6, 5, v1
  v_lshlrev_b32 v6, 3, v6
  v_add_u32 v5, v5, v6
  s_lshl_b32 s57, s28, 4
  s_add_u32 s57, s57, 1152
  v_add_u32 v5, s57, v5
  s_lshl_b32 s57, s28, 12
  v_add_u32 v6, s57, v2
  s_lshl_b32 s57, s28, 10
  v_add_u32 v7, s57, v2
  s_add_u32 m0, s54, 0
  s_add_u32 s58, s55, 0
  buffer_load_dwordx4 v3, s[36:39], s58 offen lds
  s_add_u32 m0, s54, 1024
  s_add_u32 s58, s55, 18432
  buffer_load_dwordx4 v3, s[36:39], s58 offen lds
  s_add_u32 m0, s54, 2048
  s_add_u32 s58, s55, 36864
  buffer_load_dwordx4 v3, s[36:39], s58 offen lds
  s_add_u32 m0, s54, 3072
  s_add_u32 s58, s55, 55296
  buffer_load_dwordx4 v3, s[36:39], s58 offen lds
  s_add_u32 m0, s54, 4096
  s_add_u32 s58, s55, 73728
  buffer_load_dwordx4 v3, s[36:39], s58 offen lds
  s_add_u32 m0, s54, 5120
  s_add_u32 s58, s55, 92160
  buffer_load_dwordx4 v3, s[36:39], s58 offen lds
  s_add_u32 m0, s54, 6144
  s_add_u32 s58, s55, 110592
  buffer_load_dwordx4 v3, s[36:39], s58 offen lds
  s_add_u32 m0, s54, 7168
  s_add_u32 s58, s55, 129024
  buffer_load_dwordx4 v3, s[36:39], s58 offen lds
  s_add_u32 m0, s54, 8192
  s_add_u32 s58, s55, 147456
  buffer_load_dwordx4 v3, s[36:39], s58 offen lds
  s_add_u32 m0, s54, 9216
  s_add_u32 s58, s55, 165888
  buffer_load_dwordx4 v3, s[36:39], s58 offen lds
  s_add_u32 m0, s54, 10240
  s_add_u32 s58, s55, 184320
  buffer_load_dwordx4 v3, s[36:39], s58 offen lds
  s_add_u32 m0, s54, 11264
  s_add_u32 s58, s55, 202752
  buffer_load_dwordx4 v3, s[36:39], s58 offen lds
  s_add_u32 m0, s54, 12288
  s_add_u32 s58, s55, 221184
  buffer_load_dwordx4 v3, s[36:39], s58 offen lds
  s_add_u32 m0, s54, 13312
  s_add_u32 s58, s55, 239616
  buffer_load_dwordx4 v3, s[36:39], s58 offen lds
  s_add_u32 m0, s54, 14336
  s_add_u32 s58, s55, 258048
  buffer_load_dwordx4 v3, s[36:39], s58 offen lds
  s_add_u32 m0, s54, 15360
  s_add_u32 s58, s55, 276480
  buffer_load_dwordx4 v3, s[36:39], s58 offen lds
  s_add_u32 m0, s54, 16384
  s_add_u32 s58, s55, 294912
  buffer_load_dwordx4 v3, s[36:39], s58 offen lds
  s_add_u32 m0, s54, 17408
  s_add_u32 s58, s55, 313344
  buffer_load_dwordx4 v3, s[36:39], s58 offen lds
  s_add_u32 m0, s54, 18432
  s_add_u32 s58, s55, 331776
  buffer_load_dwordx4 v3, s[36:39], s58 offen lds
  s_add_u32 m0, s54, 19456
  s_add_u32 s58, s55, 350208
  buffer_load_dwordx4 v3, s[36:39], s58 offen lds
  s_add_u32 m0, s54, 20480
  s_add_u32 s58, s55, 368640
  buffer_load_dwordx4 v3, s[36:39], s58 offen lds
  s_add_u32 m0, s54, 21504
  s_add_u32 s58, s55, 387072
  buffer_load_dwordx4 v3, s[36:39], s58 offen lds
  s_add_u32 m0, s54, 22528
  s_add_u32 s58, s55, 405504
  buffer_load_dwordx4 v3, s[36:39], s58 offen lds
  s_add_u32 m0, s54, 23552
  s_add_u32 s58, s55, 423936
  buffer_load_dwordx4 v3, s[36:39], s58 offen lds
  s_add_u32 m0, s54, 24576
  s_add_u32 s58, s55, 442368
  buffer_load_dwordx4 v3, s[36:39], s58 offen lds
  s_add_u32 m0, s54, 25600
  s_add_u32 s58, s55, 460800
  buffer_load_dwordx4 v3, s[36:39], s58 offen lds
  s_add_u32 m0, s54, 26624
  s_add_u32 s58, s55, 479232
  buffer_load_dwordx4 v3, s[36:39], s58 offen lds
  s_add_u32 m0, s54, 27648
  s_add_u32 s58, s55, 497664
  buffer_load_dwordx4 v3, s[36:39], s58 offen lds
  s_add_u32 m0, s54, 28672
  s_add_u32 s58, s55, 516096
  buffer_load_dwordx4 v3, s[36:39], s58 offen lds
  s_add_u32 m0, s54, 29696
  s_add_u32 s58, s55, 534528
  buffer_load_dwordx4 v3, s[36:39], s58 offen lds
  s_add_u32 m0, s54, 30720
  s_add_u32 s58, s55, 552960
  buffer_load_dwordx4 v3, s[36:39], s58 offen lds
  s_add_u32 m0, s54, 31744
  s_add_u32 s58, s55, 571392
  buffer_load_dwordx4 v3, s[36:39], s58 offen lds
  s_waitcnt vmcnt(24)
  ds_read_b64_tr_b16 a[0:1], v4 offset:0
  ds_read_b64_tr_b16 a[2:3], v4 offset:1024
  ds_read_b64_tr_b16 a[4:5], v4 offset:512
  ds_read_b64_tr_b16 a[6:7], v4 offset:1536
  ds_read_b64_tr_b16 a[8:9], v4 offset:2048
  ds_read_b64_tr_b16 a[10:11], v4 offset:3072
  ds_read_b64_tr_b16 a[12:13], v4 offset:2560
  ds_read_b64_tr_b16 a[14:15], v4 offset:3584
  ds_read_b64_tr_b16 a[16:17], v4 offset:4096
  ds_read_b64_tr_b16 a[18:19], v4 offset:5120
  ds_read_b64_tr_b16 a[20:21], v4 offset:4608
  ds_read_b64_tr_b16 a[22:23], v4 offset:5632
  ds_read_b64_tr_b16 a[24:25], v4 offset:6144
  ds_read_b64_tr_b16 a[26:27], v4 offset:7168
  ds_read_b64_tr_b16 a[28:29], v4 offset:6656
  ds_read_b64_tr_b16 a[30:31], v4 offset:7680
  s_waitcnt lgkmcnt(0)
  s_add_u32 m0, s54, 0
  s_add_u32 s58, s55, 589824
  buffer_load_dwordx4 v3, s[36:39], s58 offen lds
  s_add_u32 m0, s54, 1024
  s_add_u32 s58, s55, 608256
  buffer_load_dwordx4 v3, s[36:39], s58 offen lds
  s_add_u32 m0, s54, 2048
  s_add_u32 s58, s55, 626688
  buffer_load_dwordx4 v3, s[36:39], s58 offen lds
  s_add_u32 m0, s54, 3072
  s_add_u32 s58, s55, 645120
  buffer_load_dwordx4 v3, s[36:39], s58 offen lds
  s_add_u32 m0, s54, 4096
  s_add_u32 s58, s55, 663552
  buffer_load_dwordx4 v3, s[36:39], s58 offen lds
  s_add_u32 m0, s54, 5120
  s_add_u32 s58, s55, 681984
  buffer_load_dwordx4 v3, s[36:39], s58 offen lds
  s_add_u32 m0, s54, 6144
  s_add_u32 s58, s55, 700416
  buffer_load_dwordx4 v3, s[36:39], s58 offen lds
  s_add_u32 m0, s54, 7168
  s_add_u32 s58, s55, 718848
  buffer_load_dwordx4 v3, s[36:39], s58 offen lds
  s_waitcnt vmcnt(24)
  ds_read_b64_tr_b16 a[32:33], v4 offset:8192
  ds_read_b64_tr_b16 a[34:35], v4 offset:9216
  ds_read_b64_tr_b16 a[36:37], v4 offset:8704
  ds_read_b64_tr_b16 a[38:39], v4 offset:9728
  ds_read_b64_tr_b16 a[40:41], v4 offset:10240
  ds_read_b64_tr_b16 a[42:43], v4 offset:11264
  ds_read_b64_tr_b16 a[44:45], v4 offset:10752
  ds_read_b64_tr_b16 a[46:47], v4 offset:11776
  ds_read_b64_tr_b16 a[48:49], v4 offset:12288
  ds_read_b64_tr_b16 a[50:51], v4 offset:13312
  ds_read_b64_tr_b16 a[52:53], v4 offset:12800
  ds_read_b64_tr_b16 a[54:55], v4 offset:13824
  ds_read_b64_tr_b16 a[56:57], v4 offset:14336
  ds_read_b64_tr_b16 a[58:59], v4 offset:15360
  ds_read_b64_tr_b16 a[60:61], v4 offset:14848
  ds_read_b64_tr_b16 a[62:63], v4 offset:15872
  s_waitcnt lgkmcnt(0)
  s_add_u32 m0, s54, 8192
  s_add_u32 s58, s55, 737280
  buffer_load_dwordx4 v3, s[36:39], s58 offen lds
  s_add_u32 m0, s54, 9216
  s_add_u32 s58, s55, 755712
  buffer_load_dwordx4 v3, s[36:39], s58 offen lds
  s_add_u32 m0, s54, 10240
  s_add_u32 s58, s55, 774144
  buffer_load_dwordx4 v3, s[36:39], s58 offen lds
  s_add_u32 m0, s54, 11264
  s_add_u32 s58, s55, 792576
  buffer_load_dwordx4 v3, s[36:39], s58 offen lds
  s_add_u32 m0, s54, 12288
  s_add_u32 s58, s55, 811008
  buffer_load_dwordx4 v3, s[36:39], s58 offen lds
  s_add_u32 m0, s54, 13312
  s_add_u32 s58, s55, 829440
  buffer_load_dwordx4 v3, s[36:39], s58 offen lds
  s_add_u32 m0, s54, 14336
  s_add_u32 s58, s55, 847872
  buffer_load_dwordx4 v3, s[36:39], s58 offen lds
  s_add_u32 m0, s54, 15360
  s_add_u32 s58, s55, 866304
  buffer_load_dwordx4 v3, s[36:39], s58 offen lds
  s_waitcnt vmcnt(24)
  ds_read_b64_tr_b16 a[64:65], v4 offset:16384
  ds_read_b64_tr_b16 a[66:67], v4 offset:17408
  ds_read_b64_tr_b16 a[68:69], v4 offset:16896
  ds_read_b64_tr_b16 a[70:71], v4 offset:17920
  ds_read_b64_tr_b16 a[72:73], v4 offset:18432
  ds_read_b64_tr_b16 a[74:75], v4 offset:19456
  ds_read_b64_tr_b16 a[76:77], v4 offset:18944
  ds_read_b64_tr_b16 a[78:79], v4 offset:19968
  ds_read_b64_tr_b16 a[80:81], v4 offset:20480
  ds_read_b64_tr_b16 a[82:83], v4 offset:21504
  ds_read_b64_tr_b16 a[84:85], v4 offset:20992
  ds_read_b64_tr_b16 a[86:87], v4 offset:22016
  ds_read_b64_tr_b16 a[88:89], v4 offset:22528
  ds_read_b64_tr_b16 a[90:91], v4 offset:23552
  ds_read_b64_tr_b16 a[92:93], v4 offset:23040
  ds_read_b64_tr_b16 a[94:95], v4 offset:24064
  s_waitcnt lgkmcnt(0)
  s_add_u32 m0, s54, 16384
  s_add_u32 s58, s55, 884736
  buffer_load_dwordx4 v3, s[36:39], s58 offen lds
  s_add_u32 m0, s54, 17408
  s_add_u32 s58, s55, 903168
  buffer_load_dwordx4 v3, s[36:39], s58 offen lds
  s_add_u32 m0, s54, 18432
  s_add_u32 s58, s55, 921600
  buffer_load_dwordx4 v3, s[36:39], s58 offen lds
  s_add_u32 m0, s54, 19456
  s_add_u32 s58, s55, 940032
  buffer_load_dwordx4 v3, s[36:39], s58 offen lds
  s_add_u32 m0, s54, 20480
  s_add_u32 s58, s55, 958464
  buffer_load_dwordx4 v3, s[36:39], s58 offen lds
  s_add_u32 m0, s54, 21504
  s_add_u32 s58, s55, 976896
  buffer_load_dwordx4 v3, s[36:39], s58 offen lds
  s_add_u32 m0, s54, 22528
  s_add_u32 s58, s55, 995328
  buffer_load_dwordx4 v3, s[36:39], s58 offen lds
  s_add_u32 m0, s54, 23552
  s_add_u32 s58, s55, 1013760
  buffer_load_dwordx4 v3, s[36:39], s58 offen lds
  s_waitcnt vmcnt(24)
  ds_read_b64_tr_b16 a[96:97], v4 offset:24576
  ds_read_b64_tr_b16 a[98:99], v4 offset:25600
  ds_read_b64_tr_b16 a[100:101], v4 offset:25088
  ds_read_b64_tr_b16 a[102:103], v4 offset:26112
  ds_read_b64_tr_b16 a[104:105], v4 offset:26624
  ds_read_b64_tr_b16 a[106:107], v4 offset:27648
  ds_read_b64_tr_b16 a[108:109], v4 offset:27136
  ds_read_b64_tr_b16 a[110:111], v4 offset:28160
  ds_read_b64_tr_b16 a[112:113], v4 offset:28672
  ds_read_b64_tr_b16 a[114:115], v4 offset:29696
  ds_read_b64_tr_b16 a[116:117], v4 offset:29184
  ds_read_b64_tr_b16 a[118:119], v4 offset:30208
  ds_read_b64_tr_b16 a[120:121], v4 offset:30720
  ds_read_b64_tr_b16 a[122:123], v4 offset:31744
  ds_read_b64_tr_b16 a[124:125], v4 offset:31232
  ds_read_b64_tr_b16 a[126:127], v4 offset:32256
  s_waitcnt lgkmcnt(0)
  s_add_u32 m0, s54, 24576
  s_add_u32 s58, s55, 1032192
  buffer_load_dwordx4 v3, s[36:39], s58 offen lds
  s_add_u32 m0, s54, 25600
  s_add_u32 s58, s55, 1050624
  buffer_load_dwordx4 v3, s[36:39], s58 offen lds
  s_add_u32 m0, s54, 26624
  s_add_u32 s58, s55, 1069056
  buffer_load_dwordx4 v3, s[36:39], s58 offen lds
  s_add_u32 m0, s54, 27648
  s_add_u32 s58, s55, 1087488
  buffer_load_dwordx4 v3, s[36:39], s58 offen lds
  s_add_u32 m0, s54, 28672
  s_add_u32 s58, s55, 1105920
  buffer_load_dwordx4 v3, s[36:39], s58 offen lds
  s_add_u32 m0, s54, 29696
  s_add_u32 s58, s55, 1124352
  buffer_load_dwordx4 v3, s[36:39], s58 offen lds
  s_add_u32 m0, s54, 30720
  s_add_u32 s58, s55, 1142784
  buffer_load_dwordx4 v3, s[36:39], s58 offen lds
  s_add_u32 m0, s54, 31744
  s_add_u32 s58, s55, 1161216
  buffer_load_dwordx4 v3, s[36:39], s58 offen lds
  s_waitcnt vmcnt(24)
  ds_read_b64_tr_b16 a[128:129], v4 offset:0
  ds_read_b64_tr_b16 a[130:131], v4 offset:1024
  ds_read_b64_tr_b16 a[132:133], v4 offset:512
  ds_read_b64_tr_b16 a[134:135], v4 offset:1536
  ds_read_b64_tr_b16 a[136:137], v4 offset:2048
  ds_read_b64_tr_b16 a[138:139], v4 offset:3072
  ds_read_b64_tr_b16 a[140:141], v4 offset:2560
  ds_read_b64_tr_b16 a[142:143], v4 offset:3584
  ds_read_b64_tr_b16 a[144:145], v4 offset:4096
  ds_read_b64_tr_b16 a[146:147], v4 offset:5120
  ds_read_b64_tr_b16 a[148:149], v4 offset:4608
  ds_read_b64_tr_b16 a[150:151], v4 offset:5632
  ds_read_b64_tr_b16 a[152:153], v4 offset:6144
  ds_read_b64_tr_b16 a[154:155], v4 offset:7168
  ds_read_b64_tr_b16 a[156:157], v4 offset:6656
  ds_read_b64_tr_b16 a[158:159], v4 offset:7680
  s_waitcnt lgkmcnt(0)
  s_waitcnt vmcnt(16)
  ds_read_b64_tr_b16 a[160:161], v4 offset:8192
  ds_read_b64_tr_b16 a[162:163], v4 offset:9216
  ds_read_b64_tr_b16 a[164:165], v4 offset:8704
  ds_read_b64_tr_b16 a[166:167], v4 offset:9728
  ds_read_b64_tr_b16 a[168:169], v4 offset:10240
  ds_read_b64_tr_b16 a[170:171], v4 offset:11264
  ds_read_b64_tr_b16 a[172:173], v4 offset:10752
  ds_read_b64_tr_b16 a[174:175], v4 offset:11776
  ds_read_b64_tr_b16 a[176:177], v4 offset:12288
  ds_read_b64_tr_b16 a[178:179], v4 offset:13312
  ds_read_b64_tr_b16 a[180:181], v4 offset:12800
  ds_read_b64_tr_b16 a[182:183], v4 offset:13824
  ds_read_b64_tr_b16 a[184:185], v4 offset:14336
  ds_read_b64_tr_b16 a[186:187], v4 offset:15360
  ds_read_b64_tr_b16 a[188:189], v4 offset:14848
  ds_read_b64_tr_b16 a[190:191], v4 offset:15872
  s_waitcnt lgkmcnt(0)
  s_waitcnt vmcnt(8)
  ds_read_b64_tr_b16 a[192:193], v4 offset:16384
  ds_read_b64_tr_b16 a[194:195], v4 offset:17408
  ds_read_b64_tr_b16 a[196:197], v4 offset:16896
  ds_read_b64_tr_b16 a[198:199], v4 offset:17920
  ds_read_b64_tr_b16 a[200:201], v4 offset:18432
  ds_read_b64_tr_b16 a[202:203], v4 offset:19456
  ds_read_b64_tr_b16 a[204:205], v4 offset:18944
  ds_read_b64_tr_b16 a[206:207], v4 offset:19968
  ds_read_b64_tr_b16 a[208:209], v4 offset:20480
  ds_read_b64_tr_b16 a[210:211], v4 offset:21504
  ds_read_b64_tr_b16 a[212:213], v4 offset:20992
  ds_read_b64_tr_b16 a[214:215], v4 offset:22016
  ds_read_b64_tr_b16 a[216:217], v4 offset:22528
  ds_read_b64_tr_b16 a[218:219], v4 offset:23552
  ds_read_b64_tr_b16 a[220:221], v4 offset:23040
  ds_read_b64_tr_b16 a[222:223], v4 offset:24064
  s_waitcnt lgkmcnt(0)
  s_waitcnt vmcnt(0)
  ds_read_b64_tr_b16 a[224:225], v4 offset:24576
  ds_read_b64_tr_b16 a[226:227], v4 offset:25600
  ds_read_b64_tr_b16 a[228:229], v4 offset:25088
  ds_read_b64_tr_b16 a[230:231], v4 offset:26112
  ds_read_b64_tr_b16 a[232:233], v4 offset:26624
  ds_read_b64_tr_b16 a[234:235], v4 offset:27648
  ds_read_b64_tr_b16 a[236:237], v4 offset:27136
  ds_read_b64_tr_b16 a[238:239], v4 offset:28160
  ds_read_b64_tr_b16 a[240:241], v4 offset:28672
  ds_read_b64_tr_b16 a[242:243], v4 offset:29696
  ds_read_b64_tr_b16 a[244:245], v4 offset:29184
  ds_read_b64_tr_b16 a[246:247], v4 offset:30208
  ds_read_b64_tr_b16 a[248:249], v4 offset:30720
  ds_read_b64_tr_b16 a[250:251], v4 offset:31744
  ds_read_b64_tr_b16 a[252:253], v4 offset:31232
  ds_read_b64_tr_b16 a[254:255], v4 offset:32256
  s_waitcnt lgkmcnt(0)
  s_barrier
  s_mov_b32 s62, s61
  v_lshlrev_b32 v8, 2, v1
  s_lshl_b32 s57, s28, 5
  s_add_u32 s57, s57, 70017024
  v_add_u32 v8, s57, v8
.Lconcat_heads__mha_block__memory_aug_recurrent_mem_tr__prompt_kernelbo_loop:
  s_mov_b32 s68, s62
  s_lshl_b32 s57, s68, 7
  v_add_u32 v9, s57, v8
  s_mov_b32 s95, 4000000
  s_mov_b32 exec_lo, 0xff
  s_mov_b32 exec_hi, 0x0
.wm4:
  global_load_dword v251, v9, s[26:27] sc1
  s_waitcnt vmcnt(0)
  v_cmp_eq_u32 vcc, 0, v251
  s_cbranch_vccz .wm4_ok
  s_sleep 2
  s_sub_u32 s95, s95, 1
  s_cmp_lg_u32 s95, 0
  s_cbranch_scc1 .wm4
.wm4_ok:
  s_mov_b64 exec, -1
  s_lshl_b32 s63, s68, 18
  s_lshl_b32 s57, s28, 16
  s_add_u32 s63, s63, s57
  s_add_u32 s63, s63, 71303168
  s_mul_i32 s67, s68, 73728
  s_lshl_b32 s57, s60, 6
  s_add_u32 s67, s67, s57
  s_add_u32 s59, s63, 0
  buffer_load_dwordx4 v[64:67], v2, s[32:35], s59 offen offset:0 sc1
  s_add_u32 s59, s63, 0
  buffer_load_dwordx4 v[68:71], v2, s[32:35], s59 offen offset:1024 sc1
  s_add_u32 s59, s63, 0
  buffer_load_dwordx4 v[72:75], v2, s[32:35], s59 offen offset:2048 sc1
  s_add_u32 s59, s63, 0
  buffer_load_dwordx4 v[76:79], v2, s[32:35], s59 offen offset:3072 sc1
  s_add_u32 s59, s63, 4096
  buffer_load_dwordx4 v[80:83], v2, s[32:35], s59 offen offset:0 sc1
  s_add_u32 s59, s63, 4096
  buffer_load_dwordx4 v[84:87], v2, s[32:35], s59 offen offset:1024 sc1
  s_add_u32 s59, s63, 4096
  buffer_load_dwordx4 v[88:91], v2, s[32:35], s59 offen offset:2048 sc1
  s_add_u32 s59, s63, 4096
  buffer_load_dwordx4 v[92:95], v2, s[32:35], s59 offen offset:3072 sc1
  s_add_u32 s59, s63, 8192
  buffer_load_dwordx4 v[96:99], v2, s[32:35], s59 offen offset:0 sc1
  s_add_u32 s59, s63, 8192
  buffer_load_dwordx4 v[100:103], v2, s[32:35], s59 offen offset:1024 sc1
  s_add_u32 s59, s63, 8192
  buffer_load_dwordx4 v[104:107], v2, s[32:35], s59 offen offset:2048 sc1
  s_add_u32 s59, s63, 8192
  buffer_load_dwordx4 v[108:111], v2, s[32:35], s59 offen offset:3072 sc1
  s_add_u32 s59, s63, 12288
  buffer_load_dwordx4 v[112:115], v2, s[32:35], s59 offen offset:0 sc1
  s_add_u32 s59, s63, 12288
  buffer_load_dwordx4 v[116:119], v2, s[32:35], s59 offen offset:1024 sc1
  s_add_u32 s59, s63, 12288
  buffer_load_dwordx4 v[120:123], v2, s[32:35], s59 offen offset:2048 sc1
  s_add_u32 s59, s63, 12288
  buffer_load_dwordx4 v[124:127], v2, s[32:35], s59 offen offset:3072 sc1
  s_add_u32 s59, s63, 16384
  buffer_load_dwordx4 v[128:131], v2, s[32:35], s59 offen offset:0 sc1
  s_add_u32 s59, s63, 16384
  buffer_load_dwordx4 v[132:135], v2, s[32:35], s59 offen offset:1024 sc1
  s_add_u32 s59, s63, 16384
  buffer_load_dwordx4 v[136:139], v2, s[32:35], s59 offen offset:2048 sc1
  s_add_u32 s59, s63, 16384
  buffer_load_dwordx4 v[140:143], v2, s[32:35], s59 offen offset:3072 sc1
  s_add_u32 s59, s63, 20480
  buffer_load_dwordx4 v[144:147], v2, s[32:35], s59 offen offset:0 sc1
  s_add_u32 s59, s63, 20480
  buffer_load_dwordx4 v[148:151], v2, s[32:35], s59 offen offset:1024 sc1
  s_add_u32 s59, s63, 20480
  buffer_load_dwordx4 v[152:155], v2, s[32:35], s59 offen offset:2048 sc1
  s_add_u32 s59, s63, 20480
  buffer_load_dwordx4 v[156:159], v2, s[32:35], s59 offen offset:3072 sc1
  s_add_u32 s59, s63, 24576
  buffer_load_dwordx4 v[160:163], v2, s[32:35], s59 offen offset:0 sc1
  s_add_u32 s59, s63, 24576
  buffer_load_dwordx4 v[164:167], v2, s[32:35], s59 offen offset:1024 sc1
  s_add_u32 s59, s63, 24576
  buffer_load_dwordx4 v[168:171], v2, s[32:35], s59 offen offset:2048 sc1
  s_add_u32 s59, s63, 24576
  buffer_load_dwordx4 v[172:175], v2, s[32:35], s59 offen offset:3072 sc1
  s_add_u32 s59, s63, 28672
  buffer_load_dwordx4 v[176:179], v2, s[32:35], s59 offen offset:0 sc1
  s_add_u32 s59, s63, 28672
  buffer_load_dwordx4 v[180:183], v2, s[32:35], s59 offen offset:1024 sc1
  s_add_u32 s59, s63, 28672
  buffer_load_dwordx4 v[184:187], v2, s[32:35], s59 offen offset:2048 sc1
  s_add_u32 s59, s63, 28672
  buffer_load_dwordx4 v[188:191], v2, s[32:35], s59 offen offset:3072 sc1
  s_add_u32 s59, s63, 32768
  buffer_load_dwordx4 v[192:195], v2, s[32:35], s59 offen offset:0 sc1
  s_add_u32 s59, s63, 32768
  buffer_load_dwordx4 v[196:199], v2, s[32:35], s59 offen offset:1024 sc1
  s_add_u32 s59, s63, 32768
  buffer_load_dwordx4 v[200:203], v2, s[32:35], s59 offen offset:2048 sc1
  s_add_u32 s59, s63, 32768
  buffer_load_dwordx4 v[204:207], v2, s[32:35], s59 offen offset:3072 sc1
  s_add_u32 s59, s63, 36864
  buffer_load_dwordx4 v[208:211], v2, s[32:35], s59 offen offset:0 sc1
  s_add_u32 s59, s63, 36864
  buffer_load_dwordx4 v[212:215], v2, s[32:35], s59 offen offset:1024 sc1
  s_add_u32 s59, s63, 36864
  buffer_load_dwordx4 v[216:219], v2, s[32:35], s59 offen offset:2048 sc1
  s_add_u32 s59, s63, 36864
  buffer_load_dwordx4 v[220:223], v2, s[32:35], s59 offen offset:3072 sc1
  s_add_u32 s59, s63, 40960
  buffer_load_dwordx4 v[224:227], v2, s[32:35], s59 offen offset:0 sc1
  s_add_u32 s59, s63, 40960
  buffer_load_dwordx4 v[228:231], v2, s[32:35], s59 offen offset:1024 sc1
  s_add_u32 s59, s63, 40960
  buffer_load_dwordx4 v[232:235], v2, s[32:35], s59 offen offset:2048 sc1
  s_add_u32 s59, s63, 40960
  buffer_load_dwordx4 v[236:239], v2, s[32:35], s59 offen offset:3072 sc1
  s_add_u32 s59, s63, 45056
  buffer_load_dwordx4 v[240:243], v2, s[32:35], s59 offen offset:0 sc1
  s_add_u32 s59, s63, 45056
  buffer_load_dwordx4 v[244:247], v2, s[32:35], s59 offen offset:1024 sc1
  s_add_u32 s59, s63, 45056
  buffer_load_dwordx4 v[248:251], v2, s[32:35], s59 offen offset:2048 sc1
  s_add_u32 s59, s63, 45056
  buffer_load_dwordx4 v[252:255], v2, s[32:35], s59 offen offset:3072 sc1
  s_waitcnt vmcnt(47)
  v_mfma_f32_32x32x16_bf16 v[16:31], a[0:3], v[64:67], 0
  s_add_u32 s59, s63, 49152
  buffer_load_dwordx4 v[64:67], v2, s[32:35], s59 offen offset:0 sc1
  s_waitcnt vmcnt(47)
  v_mfma_f32_32x32x16_bf16 v[32:47], a[4:7], v[68:71], 0
  s_add_u32 s59, s63, 49152
  buffer_load_dwordx4 v[68:71], v2, s[32:35], s59 offen offset:1024 sc1
  s_waitcnt vmcnt(47)
  v_mfma_f32_32x32x16_bf16 v[16:31], a[8:11], v[72:75], v[16:31]
  s_add_u32 s59, s63, 49152
  buffer_load_dwordx4 v[72:75], v2, s[32:35], s59 offen offset:2048 sc1
  s_waitcnt vmcnt(47)
  v_mfma_f32_32x32x16_bf16 v[32:47], a[12:15], v[76:79], v[32:47]
  s_add_u32 s59, s63, 49152
  buffer_load_dwordx4 v[76:79], v2, s[32:35], s59 offen offset:3072 sc1
  s_waitcnt vmcnt(47)
  v_mfma_f32_32x32x16_bf16 v[16:31], a[16:19], v[80:83], v[16:31]
  s_add_u32 s59, s63, 53248
  buffer_load_dwordx4 v[80:83], v2, s[32:35], s59 offen offset:0 sc1
  s_waitcnt vmcnt(47)
  v_mfma_f32_32x32x16_bf16 v[32:47], a[20:23], v[84:87], v[32:47]
  s_add_u32 s59, s63, 53248
  buffer_load_dwordx4 v[84:87], v2, s[32:35], s59 offen offset:1024 sc1
  s_waitcnt vmcnt(47)
  v_mfma_f32_32x32x16_bf16 v[16:31], a[24:27], v[88:91], v[16:31]
  s_add_u32 s59, s63, 53248
  buffer_load_dwordx4 v[88:91], v2, s[32:35], s59 offen offset:2048 sc1
  s_waitcnt vmcnt(47)
  v_mfma_f32_32x32x16_bf16 v[32:47], a[28:31], v[92:95], v[32:47]
  s_add_u32 s59, s63, 53248
  buffer_load_dwordx4 v[92:95], v2, s[32:35], s59 offen offset:3072 sc1
  s_waitcnt vmcnt(47)
  v_mfma_f32_32x32x16_bf16 v[16:31], a[32:35], v[96:99], v[16:31]
  s_add_u32 s59, s63, 57344
  buffer_load_dwordx4 v[96:99], v2, s[32:35], s59 offen offset:0 sc1
  s_waitcnt vmcnt(47)
  v_mfma_f32_32x32x16_bf16 v[32:47], a[36:39], v[100:103], v[32:47]
  s_add_u32 s59, s63, 57344
  buffer_load_dwordx4 v[100:103], v2, s[32:35], s59 offen offset:1024 sc1
  s_waitcnt vmcnt(47)
  v_mfma_f32_32x32x16_bf16 v[16:31], a[40:43], v[104:107], v[16:31]
  s_add_u32 s59, s63, 57344
  buffer_load_dwordx4 v[104:107], v2, s[32:35], s59 offen offset:2048 sc1
  s_waitcnt vmcnt(47)
  v_mfma_f32_32x32x16_bf16 v[32:47], a[44:47], v[108:111], v[32:47]
  s_add_u32 s59, s63, 57344
  buffer_load_dwordx4 v[108:111], v2, s[32:35], s59 offen offset:3072 sc1
  s_waitcnt vmcnt(47)
  v_mfma_f32_32x32x16_bf16 v[16:31], a[48:51], v[112:115], v[16:31]
  s_add_u32 s59, s63, 61440
  buffer_load_dwordx4 v[112:115], v2, s[32:35], s59 offen offset:0 sc1
  s_waitcnt vmcnt(47)
  v_mfma_f32_32x32x16_bf16 v[32:47], a[52:55], v[116:119], v[32:47]
  s_add_u32 s59, s63, 61440
  buffer_load_dwordx4 v[116:119], v2, s[32:35], s59 offen offset:1024 sc1
  s_waitcnt vmcnt(47)
  v_mfma_f32_32x32x16_bf16 v[16:31], a[56:59], v[120:123], v[16:31]
  s_add_u32 s59, s63, 61440
  buffer_load_dwordx4 v[120:123], v2, s[32:35], s59 offen offset:2048 sc1
  s_waitcnt vmcnt(47)
  v_mfma_f32_32x32x16_bf16 v[32:47], a[60:63], v[124:127], v[32:47]
  s_add_u32 s59, s63, 61440
  buffer_load_dwordx4 v[124:127], v2, s[32:35], s59 offen offset:3072 sc1
  s_waitcnt vmcnt(47)
  v_mfma_f32_32x32x16_bf16 v[16:31], a[64:67], v[128:131], v[16:31]
  s_waitcnt vmcnt(46)
  v_mfma_f32_32x32x16_bf16 v[32:47], a[68:71], v[132:135], v[32:47]
  s_waitcnt vmcnt(45)
  v_mfma_f32_32x32x16_bf16 v[16:31], a[72:75], v[136:139], v[16:31]
  s_waitcnt vmcnt(44)
  v_mfma_f32_32x32x16_bf16 v[32:47], a[76:79], v[140:143], v[32:47]
  s_waitcnt vmcnt(43)
  v_mfma_f32_32x32x16_bf16 v[16:31], a[80:83], v[144:147], v[16:31]
  s_waitcnt vmcnt(42)
  v_mfma_f32_32x32x16_bf16 v[32:47], a[84:87], v[148:151], v[32:47]
  s_waitcnt vmcnt(41)
  v_mfma_f32_32x32x16_bf16 v[16:31], a[88:91], v[152:155], v[16:31]
  s_waitcnt vmcnt(40)
  v_mfma_f32_32x32x16_bf16 v[32:47], a[92:95], v[156:159], v[32:47]
  s_waitcnt vmcnt(39)
  v_mfma_f32_32x32x16_bf16 v[16:31], a[96:99], v[160:163], v[16:31]
  s_waitcnt vmcnt(38)
  v_mfma_f32_32x32x16_bf16 v[32:47], a[100:103], v[164:167], v[32:47]
  s_waitcnt vmcnt(37)
  v_mfma_f32_32x32x16_bf16 v[16:31], a[104:107], v[168:171], v[16:31]
  s_waitcnt vmcnt(36)
  v_mfma_f32_32x32x16_bf16 v[32:47], a[108:111], v[172:175], v[32:47]
  s_waitcnt vmcnt(35)
  v_mfma_f32_32x32x16_bf16 v[16:31], a[112:115], v[176:179], v[16:31]
  s_waitcnt vmcnt(34)
  v_mfma_f32_32x32x16_bf16 v[32:47], a[116:119], v[180:183], v[32:47]
  s_waitcnt vmcnt(33)
  v_mfma_f32_32x32x16_bf16 v[16:31], a[120:123], v[184:187], v[16:31]
  s_waitcnt vmcnt(32)
  v_mfma_f32_32x32x16_bf16 v[32:47], a[124:127], v[188:191], v[32:47]
  s_waitcnt vmcnt(31)
  v_mfma_f32_32x32x16_bf16 v[16:31], a[128:131], v[192:195], v[16:31]
  s_waitcnt vmcnt(30)
  v_mfma_f32_32x32x16_bf16 v[32:47], a[132:135], v[196:199], v[32:47]
  s_waitcnt vmcnt(29)
  v_mfma_f32_32x32x16_bf16 v[16:31], a[136:139], v[200:203], v[16:31]
  s_waitcnt vmcnt(28)
  v_mfma_f32_32x32x16_bf16 v[32:47], a[140:143], v[204:207], v[32:47]
  s_waitcnt vmcnt(27)
  v_mfma_f32_32x32x16_bf16 v[16:31], a[144:147], v[208:211], v[16:31]
  s_waitcnt vmcnt(26)
  v_mfma_f32_32x32x16_bf16 v[32:47], a[148:151], v[212:215], v[32:47]
  s_waitcnt vmcnt(25)
  v_mfma_f32_32x32x16_bf16 v[16:31], a[152:155], v[216:219], v[16:31]
  s_waitcnt vmcnt(24)
  v_mfma_f32_32x32x16_bf16 v[32:47], a[156:159], v[220:223], v[32:47]
  s_waitcnt vmcnt(23)
  v_mfma_f32_32x32x16_bf16 v[16:31], a[160:163], v[224:227], v[16:31]
  s_waitcnt vmcnt(22)
  v_mfma_f32_32x32x16_bf16 v[32:47], a[164:167], v[228:231], v[32:47]
  s_waitcnt vmcnt(21)
  v_mfma_f32_32x32x16_bf16 v[16:31], a[168:171], v[232:235], v[16:31]
  s_waitcnt vmcnt(20)
  v_mfma_f32_32x32x16_bf16 v[32:47], a[172:175], v[236:239], v[32:47]
  s_waitcnt vmcnt(19)
  v_mfma_f32_32x32x16_bf16 v[16:31], a[176:179], v[240:243], v[16:31]
  s_waitcnt vmcnt(18)
  v_mfma_f32_32x32x16_bf16 v[32:47], a[180:183], v[244:247], v[32:47]
  s_waitcnt vmcnt(17)
  v_mfma_f32_32x32x16_bf16 v[16:31], a[184:187], v[248:251], v[16:31]
  s_waitcnt vmcnt(16)
  v_mfma_f32_32x32x16_bf16 v[32:47], a[188:191], v[252:255], v[32:47]
  s_waitcnt vmcnt(15)
  v_mfma_f32_32x32x16_bf16 v[16:31], a[192:195], v[64:67], v[16:31]
  s_waitcnt vmcnt(14)
  v_mfma_f32_32x32x16_bf16 v[32:47], a[196:199], v[68:71], v[32:47]
  s_waitcnt vmcnt(13)
  v_mfma_f32_32x32x16_bf16 v[16:31], a[200:203], v[72:75], v[16:31]
  s_waitcnt vmcnt(12)
  v_mfma_f32_32x32x16_bf16 v[32:47], a[204:207], v[76:79], v[32:47]
  s_waitcnt vmcnt(11)
  v_mfma_f32_32x32x16_bf16 v[16:31], a[208:211], v[80:83], v[16:31]
  s_waitcnt vmcnt(10)
  v_mfma_f32_32x32x16_bf16 v[32:47], a[212:215], v[84:87], v[32:47]
  s_waitcnt vmcnt(9)
  v_mfma_f32_32x32x16_bf16 v[16:31], a[216:219], v[88:91], v[16:31]
  s_waitcnt vmcnt(8)
  v_mfma_f32_32x32x16_bf16 v[32:47], a[220:223], v[92:95], v[32:47]
  s_waitcnt vmcnt(7)
  v_mfma_f32_32x32x16_bf16 v[16:31], a[224:227], v[96:99], v[16:31]
  s_waitcnt vmcnt(6)
  v_mfma_f32_32x32x16_bf16 v[32:47], a[228:231], v[100:103], v[32:47]
  s_waitcnt vmcnt(5)
  v_mfma_f32_32x32x16_bf16 v[16:31], a[232:235], v[104:107], v[16:31]
  s_waitcnt vmcnt(4)
  v_mfma_f32_32x32x16_bf16 v[32:47], a[236:239], v[108:111], v[32:47]
  s_waitcnt vmcnt(3)
  v_mfma_f32_32x32x16_bf16 v[16:31], a[240:243], v[112:115], v[16:31]
  s_waitcnt vmcnt(2)
  v_mfma_f32_32x32x16_bf16 v[32:47], a[244:247], v[116:119], v[32:47]
  s_waitcnt vmcnt(1)
  v_mfma_f32_32x32x16_bf16 v[16:31], a[248:251], v[120:123], v[16:31]
  s_waitcnt vmcnt(0)
  v_mfma_f32_32x32x16_bf16 v[32:47], a[252:255], v[124:127], v[32:47]
  s_nop 7
  s_nop 3
  v_add_f32 v16, v16, v32
  v_add_f32 v17, v17, v33
  v_add_f32 v18, v18, v34
  v_add_f32 v19, v19, v35
  v_add_f32 v20, v20, v36
  v_add_f32 v21, v21, v37
  v_add_f32 v22, v22, v38
  v_add_f32 v23, v23, v39
  v_add_f32 v24, v24, v40
  v_add_f32 v25, v25, v41
  v_add_f32 v26, v26, v42
  v_add_f32 v27, v27, v43
  v_add_f32 v28, v28, v44
  v_add_f32 v29, v29, v45
  v_add_f32 v30, v30, v46
  v_add_f32 v31, v31, v47
  ds_write_b128 v6, v[16:19] offset:0
  ds_write_b128 v6, v[20:23] offset:1024
  ds_write_b128 v6, v[24:27] offset:2048
  ds_write_b128 v6, v[28:31] offset:3072
  s_waitcnt lgkmcnt(0)
  s_barrier
  ds_read_b128 v[48:51], v7 offset:0
  ds_read_b128 v[52:55], v7 offset:4096
  ds_read_b128 v[56:59], v7 offset:8192
  ds_read_b128 v[60:63], v7 offset:12288
  s_waitcnt lgkmcnt(0)
  s_barrier
  v_add_f32 v48, v48, v52
  v_add_f32 v56, v56, v60
  v_add_f32 v49, v49, v53
  v_add_f32 v57, v57, v61
  v_add_f32 v50, v50, v54
  v_add_f32 v58, v58, v62
  v_add_f32 v51, v51, v55
  v_add_f32 v59, v59, v63
  v_add_f32 v48, v48, v56
  v_add_f32 v49, v49, v57
  v_add_f32 v50, v50, v58
  v_add_f32 v51, v51, v59
  v_cvt_pk_bf16_f32 v48, v48, v49
  v_cvt_pk_bf16_f32 v49, v50, v51
  buffer_store_dwordx2 v[48:49], v5, s[44:47], s67 offen
  s_mov_b64 exec, -1
  s_add_u32 s62, s62, 3
  s_cmp_lt_u32 s62, 64
  s_cbranch_scc1 .Lconcat_heads__mha_block__memory_aug_recurrent_mem_tr__prompt_kernelbo_loop
  s_branch .Lconcat_heads__mha_block__memory_aug_recurrent_mem_tr__prompt_kernel_end
.Lconcat_heads__mha_block__memory_aug_recurrent_mem_tr__prompt_kernel_xa:
  s_cmp_ge_u32 s90, 86
  s_cbranch_scc1 .Lconcat_heads__mha_block__memory_aug_recurrent_mem_tr__prompt_kernel_end
  s_sub_u32 s29, s90, 54
  v_mov_b32 v250, 72
  s_mov_b32 s95, 4000000
.ww5:
  global_load_dword v251, v250, s[24:25] sc1
  s_waitcnt vmcnt(0)
  v_readfirstlane_b32 s94, v251
  s_cmp_lg_u32 s94, 0
  s_cbranch_scc1 .ww5_ok
  s_sleep 1
  s_sub_u32 s95, s95, 1
  s_cmp_lg_u32 s95, 0
  s_cbranch_scc1 .ww5
.ww5_ok:
  s_mov_b32 s32, s26
  s_mov_b32 s33, s27
  s_mov_b32 s34, 268435456
  s_mov_b32 s35, 0x00020000
  v_lshlrev_b32 v2, 4, v1
  v_and_b32 v3, 15, v1
  v_lshrrev_b32 v4, 4, v1
  v_lshrrev_b32 v5, 1, v4
  v_lshlrev_b32 v5, 10, v5
  v_and_b32 v6, 1, v4
  v_lshlrev_b32 v6, 9, v6
  v_add_u32 v5, v5, v6
  v_lshlrev_b32 v6, 4, v3
  v_add_u32 v5, v5, v6
  v_lshlrev_b32 v6, 2, v4
  v_add_u32 v7, 0, v6
  v_cmp_le_u32 s[40:41], v7, v3
  v_add_u32 v7, 1, v6
  v_cmp_le_u32 s[42:43], v7, v3
  v_add_u32 v7, 2, v6
  v_cmp_le_u32 s[44:45], v7, v3
  v_add_u32 v7, 3, v6
  v_cmp_le_u32 s[46:47], v7, v3
  s_mov_b32 s48, 0x3e0293ee
  v_mov_b32 v6, 0xff800000
  v_cmp_gt_u32 s[50:51], 32, v1
  s_lshl_b32 s60, s29, 2
  s_add_u32 s60, s60, s28
  s_and_b32 s61, s60, 31
  s_lshr_b32 s62, s60, 5
  v_mov_b32 v249, 1
.Lconcat_heads__mha_block__memory_aug_recurrent_mem_tr__prompt_kernelxat_loop:
  s_lshl_b32 s63, s62, 7
  s_lshl_b32 s64, s61, 2
  s_add_u32 s64, s64, s63
  s_add_u32 s64, s64, 70008832
  s_lshr_b32 s65, s61, 1
  s_lshl_b32 s65, s65, 2
  s_add_u32 s65, s65, s63
  s_add_u32 s65, s65, 70000640
  v_mov_b32 v248, s64
  v_mov_b32 v250, s65
  v_cmp_eq_u32 vcc, 0, v1
  s_nop 1
  v_cndmask_b32 v248, v250, v248, vcc
  v_mov_b32 v250, -16384
  v_cndmask_b32 v250, 0, v250, vcc
  v_add_u32 v247, v248, v250
  s_mov_b32 s95, 4000000
  s_mov_b32 exec_lo, 0x3
  s_mov_b32 exec_hi, 0x0
.wm6:
  global_load_dword v251, v247, s[26:27] sc1
  s_waitcnt vmcnt(0)
  v_cmp_eq_u32 vcc, 0, v251
  s_cbranch_vccz .wm6_ok
  s_sleep 2
  s_sub_u32 s95, s95, 1
  s_cmp_lg_u32 s95, 0
  s_cbranch_scc1 .wm6
.wm6_ok:
  s_mov_b64 exec, -1
  s_lshl_b32 s60, s62, 5
  s_add_u32 s60, s60, s61
  s_lshl_b32 s52, s60, 13
  s_add_u32 s53, s52, 33554432
  s_add_u32 s54, s52, 50331648
  s_lshl_b32 s55, s60, 14
  s_add_u32 s55, s55, 0
  buffer_load_dwordx4 v[8:11], v2, s[32:35], s53 offen offset:0 sc1
  buffer_load_dwordx4 v[12:15], v2, s[32:35], s53 offen offset:1024 sc1
  buffer_load_dwordx4 v[16:19], v2, s[32:35], s53 offen offset:2048 sc1
  buffer_load_dwordx4 v[20:23], v2, s[32:35], s53 offen offset:3072 sc1
  s_add_u32 s56, s53, 4096
  buffer_load_dwordx4 v[24:27], v2, s[32:35], s56 offen offset:0 sc1
  s_add_u32 s56, s53, 4096
  buffer_load_dwordx4 v[28:31], v2, s[32:35], s56 offen offset:1024 sc1
  s_add_u32 s56, s53, 4096
  buffer_load_dwordx4 v[32:35], v2, s[32:35], s56 offen offset:2048 sc1
  s_add_u32 s56, s53, 4096
  buffer_load_dwordx4 v[36:39], v2, s[32:35], s56 offen offset:3072 sc1
  buffer_load_dwordx4 v[40:43], v2, s[32:35], s55 offen offset:0 sc1
  buffer_load_dwordx4 v[44:47], v2, s[32:35], s55 offen offset:1024 sc1
  buffer_load_dwordx4 v[48:51], v2, s[32:35], s55 offen offset:2048 sc1
  buffer_load_dwordx4 v[52:55], v2, s[32:35], s55 offen offset:3072 sc1
  s_add_u32 s56, s55, 4096
  buffer_load_dwordx4 v[56:59], v2, s[32:35], s56 offen offset:0 sc1
  s_add_u32 s56, s55, 4096
  buffer_load_dwordx4 v[60:63], v2, s[32:35], s56 offen offset:1024 sc1
  s_add_u32 s56, s55, 4096
  buffer_load_dwordx4 v[64:67], v2, s[32:35], s56 offen offset:2048 sc1
  s_add_u32 s56, s55, 4096
  buffer_load_dwordx4 v[68:71], v2, s[32:35], s56 offen offset:3072 sc1
  s_add_u32 s56, s55, 8192
  buffer_load_dwordx4 v[72:75], v2, s[32:35], s56 offen offset:0 sc1
  s_add_u32 s56, s55, 8192
  buffer_load_dwordx4 v[76:79], v2, s[32:35], s56 offen offset:1024 sc1
  s_add_u32 s56, s55, 8192
  buffer_load_dwordx4 v[80:83], v2, s[32:35], s56 offen offset:2048 sc1
  s_add_u32 s56, s55, 8192
  buffer_load_dwordx4 v[84:87], v2, s[32:35], s56 offen offset:3072 sc1
  s_add_u32 s56, s55, 12288
  buffer_load_dwordx4 v[88:91], v2, s[32:35], s56 offen offset:0 sc1
  s_add_u32 s56, s55, 12288
  buffer_load_dwordx4 v[92:95], v2, s[32:35], s56 offen offset:1024 sc1
  s_add_u32 s56, s55, 12288
  buffer_load_dwordx4 v[96:99], v2, s[32:35], s56 offen offset:2048 sc1
  s_add_u32 s56, s55, 12288
  buffer_load_dwordx4 v[100:103], v2, s[32:35], s56 offen offset:3072 sc1
  s_mov_b32 s95, 4000000
  s_mov_b32 exec_lo, 0x1
  s_mov_b32 exec_hi, 0x0
.wm7:
  global_load_dword v251, v248, s[26:27] sc1
  s_waitcnt vmcnt(0)
  v_cmp_eq_u32 vcc, 0, v251
  s_cbranch_vccz .wm7_ok
  s_sleep 1
  s_sub_u32 s95, s95, 1
  s_cmp_lg_u32 s95, 0
  s_cbranch_scc1 .wm7
.wm7_ok:
  s_mov_b64 exec, -1
  s_lshl_b32 s52, s60, 13
  s_add_u32 s53, s52, 33554432
  s_add_u32 s54, s52, 50331648
  s_lshl_b32 s55, s60, 14
  s_add_u32 s55, s55, 0
  s_add_u32 s56, s54, 0
  buffer_load_dwordx4 v[104:107], v2, s[32:35], s56 offen sc1
  buffer_load_dwordx4 v[120:123], v2, s[32:35], s56 offen offset:1024 sc1
  s_add_u32 s56, s54, 2048
  buffer_load_dwordx4 v[108:111], v2, s[32:35], s56 offen sc1
  buffer_load_dwordx4 v[124:127], v2, s[32:35], s56 offen offset:1024 sc1
  s_add_u32 s56, s54, 4096
  buffer_load_dwordx4 v[112:115], v2, s[32:35], s56 offen sc1
  buffer_load_dwordx4 v[128:131], v2, s[32:35], s56 offen offset:1024 sc1
  s_add_u32 s56, s54, 6144
  buffer_load_dwordx4 v[116:119], v2, s[32:35], s56 offen sc1
  buffer_load_dwordx4 v[132:135], v2, s[32:35], s56 offen offset:1024 sc1
  s_waitcnt vmcnt(16)
  v_mfma_f32_16x16x32_bf16 v[136:139], v[40:43], v[8:11], 0
  v_mfma_f32_16x16x32_bf16 v[140:143], v[40:43], v[12:15], 0
  v_mfma_f32_16x16x32_bf16 v[144:147], v[44:47], v[12:15], 0
  v_mfma_f32_16x16x32_bf16 v[136:139], v[48:51], v[16:19], v[136:139]
  v_mfma_f32_16x16x32_bf16 v[140:143], v[48:51], v[20:23], v[140:143]
  v_mfma_f32_16x16x32_bf16 v[144:147], v[52:55], v[20:23], v[144:147]
  v_mfma_f32_16x16x32_bf16 v[136:139], v[56:59], v[24:27], v[136:139]
  v_mfma_f32_16x16x32_bf16 v[140:143], v[56:59], v[28:31], v[140:143]
  v_mfma_f32_16x16x32_bf16 v[144:147], v[60:63], v[28:31], v[144:147]
  v_mfma_f32_16x16x32_bf16 v[136:139], v[64:67], v[32:35], v[136:139]
  v_mfma_f32_16x16x32_bf16 v[140:143], v[64:67], v[36:39], v[140:143]
  v_mfma_f32_16x16x32_bf16 v[144:147], v[68:71], v[36:39], v[144:147]
  s_waitcnt vmcnt(0)
  v_mfma_f32_16x16x32_bf16 v[148:151], v[104:107], v[8:11], 0
  v_mfma_f32_16x16x32_bf16 v[152:155], v[104:107], v[12:15], 0
  v_mfma_f32_16x16x32_bf16 v[148:151], v[108:111], v[16:19], v[148:151]
  v_mfma_f32_16x16x32_bf16 v[152:155], v[108:111], v[20:23], v[152:155]
  v_mfma_f32_16x16x32_bf16 v[148:151], v[112:115], v[24:27], v[148:151]
  v_mfma_f32_16x16x32_bf16 v[152:155], v[112:115], v[28:31], v[152:155]
  v_mfma_f32_16x16x32_bf16 v[148:151], v[116:119], v[32:35], v[148:151]
  v_mfma_f32_16x16x32_bf16 v[152:155], v[116:119], v[36:39], v[152:155]
  s_nop 7
  v_cndmask_b32 v136, v6, v136, s[40:41]
  v_cndmask_b32 v137, v6, v137, s[42:43]
  v_cndmask_b32 v138, v6, v138, s[44:45]
  v_cndmask_b32 v139, v6, v139, s[46:47]
  v_cndmask_b32 v144, v6, v144, s[40:41]
  v_cndmask_b32 v145, v6, v145, s[42:43]
  v_cndmask_b32 v146, v6, v146, s[44:45]
  v_cndmask_b32 v147, v6, v147, s[46:47]
  v_max3_f32 v232, v148, v149, v150
  v_max3_f32 v232, v232, v151, v136
  v_max3_f32 v232, v232, v137, v138
  v_max_f32 v232, v232, v139
  v_mov_b32 v234, v232
  s_nop 1
  v_permlane16_swap_b32 v232, v234
  v_max_f32 v232, v232, v234
  v_mov_b32 v234, v232
  s_nop 1
  v_permlane32_swap_b32 v232, v234
  v_max_f32 v232, v232, v234
  v_mul_f32 v232, s48, v232
  v_fma_f32 v148, v148, s48, -v232
  v_fma_f32 v149, v149, s48, -v232
  v_fma_f32 v150, v150, s48, -v232
  v_fma_f32 v151, v151, s48, -v232
  v_fma_f32 v136, v136, s48, -v232
  v_fma_f32 v137, v137, s48, -v232
  v_fma_f32 v138, v138, s48, -v232
  v_fma_f32 v139, v139, s48, -v232
  v_exp_f32 v148, v148
  v_exp_f32 v149, v149
  v_exp_f32 v150, v150
  v_exp_f32 v151, v151
  v_exp_f32 v136, v136
  v_exp_f32 v137, v137
  v_exp_f32 v138, v138
  v_exp_f32 v139, v139
  v_add_f32 v236, v148, v150
  v_add_f32 v236, v236, v136
  v_add_f32 v236, v236, v137
  v_add_f32 v236, v236, v138
  v_add_f32 v236, v236, v139
  v_mov_b32 v234, v236
  s_nop 1
  v_permlane16_swap_b32 v236, v234
  v_add_f32 v236, v236, v234
  v_mov_b32 v234, v236
  s_nop 1
  v_permlane32_swap_b32 v236, v234
  v_add_f32 v236, v236, v234
  v_rcp_f32 v236, v236
  v_cvt_pk_bf16_f32 v164, v148, v149
  v_cvt_pk_bf16_f32 v165, v150, v151
  v_cvt_pk_bf16_f32 v156, v136, v137
  v_cvt_pk_bf16_f32 v157, v138, v139
  v_mov_b32 v158, 0
  v_mov_b32 v159, 0
  v_max3_f32 v233, v152, v153, v154
  v_max3_f32 v233, v233, v155, v140
  v_max3_f32 v233, v233, v141, v142
  v_max3_f32 v233, v233, v143, v144
  v_max3_f32 v233, v233, v145, v146
  v_max_f32 v233, v233, v147
  v_mov_b32 v235, v233
  s_nop 1
  v_permlane16_swap_b32 v233, v235
  v_max_f32 v233, v233, v235
  v_mov_b32 v235, v233
  s_nop 1
  v_permlane32_swap_b32 v233, v235
  v_max_f32 v233, v233, v235
  v_mul_f32 v233, s48, v233
  v_fma_f32 v152, v152, s48, -v233
  v_fma_f32 v153, v153, s48, -v233
  v_fma_f32 v154, v154, s48, -v233
  v_fma_f32 v155, v155, s48, -v233
  v_fma_f32 v140, v140, s48, -v233
  v_fma_f32 v141, v141, s48, -v233
  v_fma_f32 v142, v142, s48, -v233
  v_fma_f32 v143, v143, s48, -v233
  v_fma_f32 v144, v144, s48, -v233
  v_fma_f32 v145, v145, s48, -v233
  v_fma_f32 v146, v146, s48, -v233
  v_fma_f32 v147, v147, s48, -v233
  v_exp_f32 v152, v152
  v_exp_f32 v153, v153
  v_exp_f32 v154, v154
  v_exp_f32 v155, v155
  v_exp_f32 v140, v140
  v_exp_f32 v141, v141
  v_exp_f32 v142, v142
  v_exp_f32 v143, v143
  v_exp_f32 v144, v144
  v_exp_f32 v145, v145
  v_exp_f32 v146, v146
  v_exp_f32 v147, v147
  v_add_f32 v237, v152, v154
  v_add_f32 v237, v237, v140
  v_add_f32 v237, v237, v141
  v_add_f32 v237, v237, v142
  v_add_f32 v237, v237, v143
  v_add_f32 v237, v237, v144
  v_add_f32 v237, v237, v145
  v_add_f32 v237, v237, v146
  v_add_f32 v237, v237, v147
  v_mov_b32 v235, v237
  s_nop 1
  v_permlane16_swap_b32 v237, v235
  v_add_f32 v237, v237, v235
  v_mov_b32 v235, v237
  s_nop 1
  v_permlane32_swap_b32 v237, v235
  v_add_f32 v237, v237, v235
  v_rcp_f32 v237, v237
  v_cvt_pk_bf16_f32 v166, v152, v153
  v_cvt_pk_bf16_f32 v167, v154, v155
  v_cvt_pk_bf16_f32 v160, v140, v141
  v_cvt_pk_bf16_f32 v161, v142, v143
  v_cvt_pk_bf16_f32 v162, v144, v145
  v_cvt_pk_bf16_f32 v163, v146, v147
  s_nop 1
  v_mfma_f32_16x16x32_bf16 v[168:171], v[72:75], v[156:159], 0
  v_mfma_f32_16x16x32_bf16 v[172:175], v[76:79], v[156:159], 0
  v_mfma_f32_16x16x32_bf16 v[176:179], v[80:83], v[156:159], 0
  v_mfma_f32_16x16x32_bf16 v[180:183], v[84:87], v[156:159], 0
  v_mfma_f32_16x16x32_bf16 v[184:187], v[88:91], v[156:159], 0
  v_mfma_f32_16x16x32_bf16 v[188:191], v[92:95], v[156:159], 0
  v_mfma_f32_16x16x32_bf16 v[192:195], v[96:99], v[156:159], 0
  v_mfma_f32_16x16x32_bf16 v[196:199], v[100:103], v[156:159], 0
  v_mfma_f32_16x16x16_bf16 v[168:171], v[120:121], v[164:165], v[168:171]
  v_mfma_f32_16x16x16_bf16 v[172:175], v[122:123], v[164:165], v[172:175]
  v_mfma_f32_16x16x16_bf16 v[176:179], v[124:125], v[164:165], v[176:179]
  v_mfma_f32_16x16x16_bf16 v[180:183], v[126:127], v[164:165], v[180:183]
  v_mfma_f32_16x16x16_bf16 v[184:187], v[128:129], v[164:165], v[184:187]
  v_mfma_f32_16x16x16_bf16 v[188:191], v[130:131], v[164:165], v[188:191]
  v_mfma_f32_16x16x16_bf16 v[192:195], v[132:133], v[164:165], v[192:195]
  v_mfma_f32_16x16x16_bf16 v[196:199], v[134:135], v[164:165], v[196:199]
  v_mfma_f32_16x16x32_bf16 v[200:203], v[72:75], v[160:163], 0
  v_mfma_f32_16x16x32_bf16 v[204:207], v[76:79], v[160:163], 0
  v_mfma_f32_16x16x32_bf16 v[208:211], v[80:83], v[160:163], 0
  v_mfma_f32_16x16x32_bf16 v[212:215], v[84:87], v[160:163], 0
  v_mfma_f32_16x16x32_bf16 v[216:219], v[88:91], v[160:163], 0
  v_mfma_f32_16x16x32_bf16 v[220:223], v[92:95], v[160:163], 0
  v_mfma_f32_16x16x32_bf16 v[224:227], v[96:99], v[160:163], 0
  v_mfma_f32_16x16x32_bf16 v[228:231], v[100:103], v[160:163], 0
  v_mfma_f32_16x16x16_bf16 v[200:203], v[120:121], v[166:167], v[200:203]
  v_mfma_f32_16x16x16_bf16 v[204:207], v[122:123], v[166:167], v[204:207]
  v_mfma_f32_16x16x16_bf16 v[208:211], v[124:125], v[166:167], v[208:211]
  v_mfma_f32_16x16x16_bf16 v[212:215], v[126:127], v[166:167], v[212:215]
  v_mfma_f32_16x16x16_bf16 v[216:219], v[128:129], v[166:167], v[216:219]
  v_mfma_f32_16x16x16_bf16 v[220:223], v[130:131], v[166:167], v[220:223]
  v_mfma_f32_16x16x16_bf16 v[224:227], v[132:133], v[166:167], v[224:227]
  v_mfma_f32_16x16x16_bf16 v[228:231], v[134:135], v[166:167], v[228:231]
  s_lshl_b32 s52, s60, 13
  s_add_u32 s52, s52, 71303168
  s_nop 6
  v_mul_f32 v168, v168, v236
  v_mul_f32 v169, v169, v236
  v_mul_f32 v170, v170, v236
  v_mul_f32 v171, v171, v236
  v_mul_f32 v172, v172, v236
  v_mul_f32 v173, v173, v236
  v_mul_f32 v174, v174, v236
  v_mul_f32 v175, v175, v236
  v_cvt_pk_bf16_f32 v240, v168, v169
  v_cvt_pk_bf16_f32 v241, v170, v171
  v_cvt_pk_bf16_f32 v242, v172, v173
  v_cvt_pk_bf16_f32 v243, v174, v175
  buffer_store_dwordx4 v[240:243], v5, s[32:35], s52 offen offset:0 sc1
  v_mul_f32 v176, v176, v236
  v_mul_f32 v177, v177, v236
  v_mul_f32 v178, v178, v236
  v_mul_f32 v179, v179, v236
  v_mul_f32 v180, v180, v236
  v_mul_f32 v181, v181, v236
  v_mul_f32 v182, v182, v236
  v_mul_f32 v183, v183, v236
  v_cvt_pk_bf16_f32 v244, v176, v177
  v_cvt_pk_bf16_f32 v245, v178, v179
  v_cvt_pk_bf16_f32 v246, v180, v181
  v_cvt_pk_bf16_f32 v247, v182, v183
  buffer_store_dwordx4 v[244:247], v5, s[32:35], s52 offen offset:2048 sc1
  v_mul_f32 v184, v184, v236
  v_mul_f32 v185, v185, v236
  v_mul_f32 v186, v186, v236
  v_mul_f32 v187, v187, v236
  v_mul_f32 v188, v188, v236
  v_mul_f32 v189, v189, v236
  v_mul_f32 v190, v190, v236
  v_mul_f32 v191, v191, v236
  v_cvt_pk_bf16_f32 v240, v184, v185
  v_cvt_pk_bf16_f32 v241, v186, v187
  v_cvt_pk_bf16_f32 v242, v188, v189
  v_cvt_pk_bf16_f32 v243, v190, v191
  s_add_u32 s56, s52, 4096
  buffer_store_dwordx4 v[240:243], v5, s[32:35], s56 offen offset:0 sc1
  v_mul_f32 v192, v192, v236
  v_mul_f32 v193, v193, v236
  v_mul_f32 v194, v194, v236
  v_mul_f32 v195, v195, v236
  v_mul_f32 v196, v196, v236
  v_mul_f32 v197, v197, v236
  v_mul_f32 v198, v198, v236
  v_mul_f32 v199, v199, v236
  v_cvt_pk_bf16_f32 v244, v192, v193
  v_cvt_pk_bf16_f32 v245, v194, v195
  v_cvt_pk_bf16_f32 v246, v196, v197
  v_cvt_pk_bf16_f32 v247, v198, v199
  s_add_u32 s56, s52, 4096
  buffer_store_dwordx4 v[244:247], v5, s[32:35], s56 offen offset:2048 sc1
  v_mul_f32 v200, v200, v237
  v_mul_f32 v201, v201, v237
  v_mul_f32 v202, v202, v237
  v_mul_f32 v203, v203, v237
  v_mul_f32 v204, v204, v237
  v_mul_f32 v205, v205, v237
  v_mul_f32 v206, v206, v237
  v_mul_f32 v207, v207, v237
  v_cvt_pk_bf16_f32 v240, v200, v201
  v_cvt_pk_bf16_f32 v241, v202, v203
  v_cvt_pk_bf16_f32 v242, v204, v205
  v_cvt_pk_bf16_f32 v243, v206, v207
  buffer_store_dwordx4 v[240:243], v5, s[32:35], s52 offen offset:256 sc1
  v_mul_f32 v208, v208, v237
  v_mul_f32 v209, v209, v237
  v_mul_f32 v210, v210, v237
  v_mul_f32 v211, v211, v237
  v_mul_f32 v212, v212, v237
  v_mul_f32 v213, v213, v237
  v_mul_f32 v214, v214, v237
  v_mul_f32 v215, v215, v237
  v_cvt_pk_bf16_f32 v244, v208, v209
  v_cvt_pk_bf16_f32 v245, v210, v211
  v_cvt_pk_bf16_f32 v246, v212, v213
  v_cvt_pk_bf16_f32 v247, v214, v215
  buffer_store_dwordx4 v[244:247], v5, s[32:35], s52 offen offset:2304 sc1
  v_mul_f32 v216, v216, v237
  v_mul_f32 v217, v217, v237
  v_mul_f32 v218, v218, v237
  v_mul_f32 v219, v219, v237
  v_mul_f32 v220, v220, v237
  v_mul_f32 v221, v221, v237
  v_mul_f32 v222, v222, v237
  v_mul_f32 v223, v223, v237
  v_cvt_pk_bf16_f32 v240, v216, v217
  v_cvt_pk_bf16_f32 v241, v218, v219
  v_cvt_pk_bf16_f32 v242, v220, v221
  v_cvt_pk_bf16_f32 v243, v222, v223
  s_add_u32 s56, s52, 4096
  buffer_store_dwordx4 v[240:243], v5, s[32:35], s56 offen offset:256 sc1
  v_mul_f32 v224, v224, v237
  v_mul_f32 v225, v225, v237
  v_mul_f32 v226, v226, v237
  v_mul_f32 v227, v227, v237
  v_mul_f32 v228, v228, v237
  v_mul_f32 v229, v229, v237
  v_mul_f32 v230, v230, v237
  v_mul_f32 v231, v231, v237
  v_cvt_pk_bf16_f32 v244, v224, v225
  v_cvt_pk_bf16_f32 v245, v226, v227
  v_cvt_pk_bf16_f32 v246, v228, v229
  v_cvt_pk_bf16_f32 v247, v230, v231
  s_add_u32 s56, s52, 4096
  buffer_store_dwordx4 v[244:247], v5, s[32:35], s56 offen offset:2304 sc1
  s_add_u32 s64, s64, 8192
  s_waitcnt vmcnt(0)
  s_mov_b64 exec, 1
  buffer_store_dword v249, off, s[32:35], s64 sc1
  s_mov_b64 exec, -1
  s_add_u32 s62, s62, 4
  s_cmp_lt_u32 s62, 64
  s_cbranch_scc1 .Lconcat_heads__mha_block__memory_aug_recurrent_mem_tr__prompt_kernelxat_loop
  s_branch .Lconcat_heads__mha_block__memory_aug_recurrent_mem_tr__prompt_kernel_end
.Lconcat_heads__mha_block__memory_aug_recurrent_mem_tr__prompt_kernel_A:
  s_sub_u32 s91, s90, 96
  s_cmp_ge_u32 s91, 64
  s_cbranch_scc1 .Lconcat_heads__mha_block__memory_aug_recurrent_mem_tr__prompt_kernel_avv
  s_mov_b32 s29, s91
  s_mov_b32 s32, s4
  s_mov_b32 s33, s5
  s_mov_b32 s34, 2359296
  s_mov_b32 s35, 0x00020000
  s_mov_b32 s36, s6
  s_mov_b32 s37, s7
  s_mov_b32 s38, 1990656
  s_mov_b32 s39, 0x00020000
  s_mov_b32 s40, s6
  s_mov_b32 s41, s7
  s_mov_b32 s42, 1990656
  s_mov_b32 s43, 0x00020000
  s_mov_b32 s44, s26
  s_mov_b32 s45, s27
  s_mov_b32 s46, 268435456
  s_mov_b32 s47, 0x00020000
  s_and_b32 s60, s29, 7
  s_lshl_b32 s60, s60, 2
  s_add_u32 s60, s60, s28
  s_lshr_b32 s61, s29, 3
  s_mov_b32 s59, 3456
  s_mul_i32 s57, s60, 36
  s_add_u32 s58, s57, 1152
  s_mul_i32 s48, s61, 36864
  s_mov_b32 s49, 294912
  s_mov_b32 s50, 8
  s_lshl_b32 s62, s60, 6
  s_add_u32 s62, s62, s61
  s_mul_i32 s51, s62, 1152
  s_add_u32 s51, s51, 88080384
  s_mul_i32 s52, s62, 2496
  s_add_u32 s52, s52, 92274688
  s_mov_b32 s53, 9216
  s_mov_b32 s71, 19968
  s_mul_i32 s54, s28, 36864
  v_lshrrev_b32 v19, 3, v1
  s_lshl_b32 s60, s28, 3
  v_add_u32 v19, s60, v19
  v_lshrrev_b32 v2, 1, v19
  v_and_b32 v2, 7, v2
  v_and_b32 v3, 7, v1
  v_xor_b32 v2, v2, v3
  v_lshlrev_b32 v2, 4, v2
  v_mul_u32_u24 v19, 1152, v19
  v_add_u32 v2, v2, v19
  v_lshrrev_b32 v19, 2, v1
  v_mul_lo_u32 v19, v19, s59
  v_and_b32 v3, 3, v1
  v_lshlrev_b32 v3, 4, v3
  v_add_u32 v3, v3, v19
  v_lshrrev_b32 v19, 5, v1
  v_lshlrev_b32 v4, 9, v19
  v_bfe_u32 v5, v1, 2, 2
  v_lshlrev_b32 v5, 6, v5
  v_add_u32 v4, v4, v5
  v_bfe_u32 v5, v1, 4, 1
  v_lshlrev_b32 v5, 5, v5
  v_add_u32 v4, v4, v5
  v_and_b32 v5, 3, v1
  v_lshlrev_b32 v5, 3, v5
  v_add_u32 v4, v4, v5
  v_add_u32 v4, s54, v4
  v_and_b32 v9, 31, v1
  v_lshrrev_b32 v10, 3, v9
  v_mul_u32_u24 v10, 36864, v10
  v_and_b32 v11, 7, v9
  v_lshlrev_b32 v11, 7, v11
  v_add_u32 v10, v10, v11
  v_lshrrev_b32 v11, 1, v9
  v_and_b32 v11, 7, v11
  v_add_u32 v12, 0, v19
  v_xor_b32 v12, v12, v11
  v_lshlrev_b32 v12, 4, v12
  v_add_u32 v5, v10, v12
  v_add_u32 v12, 2, v19
  v_xor_b32 v12, v12, v11
  v_lshlrev_b32 v12, 4, v12
  v_add_u32 v6, v10, v12
  v_add_u32 v12, 4, v19
  v_xor_b32 v12, v12, v11
  v_lshlrev_b32 v12, 4, v12
  v_add_u32 v7, v10, v12
  v_add_u32 v12, 6, v19
  v_xor_b32 v12, v12, v11
  v_lshlrev_b32 v12, 4, v12
  v_add_u32 v8, v10, v12
  v_lshlrev_b32 v17, 4, v1
  v_lshlrev_b32 v18, 4, v1
  s_mov_b32 s70, 0x3eae1a93
  v_lshlrev_b32 v157, 3, v1
  v_lshlrev_b32 v158, 2, v1
  s_mov_b32 s64, s50
  s_mov_b32 s65, 0
  s_mov_b32 s55, s54
  s_mul_i32 s63, s59, 16
  s_mul_i32 s62, s59, 0
  s_add_u32 s62, s62, s57
  s_add_u32 m0, s54, 0
  s_nop 0
  buffer_load_dwordx4 v3, s[36:39], s62 offen lds
  s_add_u32 m0, s54, 1024
  s_add_u32 s62, s62, s63
  buffer_load_dwordx4 v3, s[36:39], s62 offen lds
  s_add_u32 m0, s54, 2048
  s_add_u32 s62, s62, s63
  buffer_load_dwordx4 v3, s[36:39], s62 offen lds
  s_add_u32 m0, s54, 3072
  s_add_u32 s62, s62, s63
  buffer_load_dwordx4 v3, s[36:39], s62 offen lds
  s_add_u32 m0, s54, 4096
  s_add_u32 s62, s62, s63
  buffer_load_dwordx4 v3, s[36:39], s62 offen lds
  s_add_u32 m0, s54, 5120
  s_add_u32 s62, s62, s63
  buffer_load_dwordx4 v3, s[36:39], s62 offen lds
  s_add_u32 m0, s54, 6144
  s_add_u32 s62, s62, s63
  buffer_load_dwordx4 v3, s[36:39], s62 offen lds
  s_add_u32 m0, s54, 7168
  s_add_u32 s62, s62, s63
  buffer_load_dwordx4 v3, s[36:39], s62 offen lds
  s_add_u32 m0, s54, 8192
  s_add_u32 s62, s62, s63
  buffer_load_dwordx4 v3, s[36:39], s62 offen lds
  s_mul_i32 s62, s59, 144
  s_add_u32 s62, s62, s57
  s_add_u32 m0, s54, 9216
  s_nop 0
  buffer_load_dwordx4 v3, s[36:39], s62 offen lds
  s_add_u32 m0, s54, 10240
  s_add_u32 s62, s62, s63
  buffer_load_dwordx4 v3, s[36:39], s62 offen lds
  s_add_u32 m0, s54, 11264
  s_add_u32 s62, s62, s63
  buffer_load_dwordx4 v3, s[36:39], s62 offen lds
  s_add_u32 m0, s54, 12288
  s_add_u32 s62, s62, s63
  buffer_load_dwordx4 v3, s[36:39], s62 offen lds
  s_add_u32 m0, s54, 13312
  s_add_u32 s62, s62, s63
  buffer_load_dwordx4 v3, s[36:39], s62 offen lds
  s_add_u32 m0, s54, 14336
  s_add_u32 s62, s62, s63
  buffer_load_dwordx4 v3, s[36:39], s62 offen lds
  s_add_u32 m0, s54, 15360
  s_add_u32 s62, s62, s63
  buffer_load_dwordx4 v3, s[36:39], s62 offen lds
  s_add_u32 m0, s54, 16384
  s_add_u32 s62, s62, s63
  buffer_load_dwordx4 v3, s[36:39], s62 offen lds
  s_add_u32 m0, s54, 17408
  s_add_u32 s62, s62, s63
  buffer_load_dwordx4 v3, s[36:39], s62 offen lds
  s_mul_i32 s62, s59, 288
  s_add_u32 s62, s62, s57
  s_add_u32 m0, s54, 18432
  s_nop 0
  buffer_load_dwordx4 v3, s[36:39], s62 offen lds
  s_add_u32 m0, s54, 19456
  s_add_u32 s62, s62, s63
  buffer_load_dwordx4 v3, s[36:39], s62 offen lds
  s_add_u32 m0, s54, 20480
  s_add_u32 s62, s62, s63
  buffer_load_dwordx4 v3, s[36:39], s62 offen lds
  s_add_u32 m0, s54, 21504
  s_add_u32 s62, s62, s63
  buffer_load_dwordx4 v3, s[36:39], s62 offen lds
  s_add_u32 m0, s54, 22528
  s_add_u32 s62, s62, s63
  buffer_load_dwordx4 v3, s[36:39], s62 offen lds
  s_add_u32 m0, s54, 23552
  s_add_u32 s62, s62, s63
  buffer_load_dwordx4 v3, s[36:39], s62 offen lds
  s_add_u32 m0, s54, 24576
  s_add_u32 s62, s62, s63
  buffer_load_dwordx4 v3, s[36:39], s62 offen lds
  s_add_u32 m0, s54, 25600
  s_add_u32 s62, s62, s63
  buffer_load_dwordx4 v3, s[36:39], s62 offen lds
  s_add_u32 m0, s54, 26624
  s_add_u32 s62, s62, s63
  buffer_load_dwordx4 v3, s[36:39], s62 offen lds
  s_mul_i32 s62, s59, 432
  s_add_u32 s62, s62, s57
  s_add_u32 m0, s54, 27648
  s_nop 0
  buffer_load_dwordx4 v3, s[36:39], s62 offen lds
  s_add_u32 m0, s54, 28672
  s_add_u32 s62, s62, s63
  buffer_load_dwordx4 v3, s[36:39], s62 offen lds
  s_add_u32 m0, s54, 29696
  s_add_u32 s62, s62, s63
  buffer_load_dwordx4 v3, s[36:39], s62 offen lds
  s_add_u32 m0, s54, 30720
  s_add_u32 s62, s62, s63
  buffer_load_dwordx4 v3, s[36:39], s62 offen lds
  s_add_u32 m0, s54, 31744
  s_add_u32 s62, s62, s63
  buffer_load_dwordx4 v3, s[36:39], s62 offen lds
  s_add_u32 m0, s54, 32768
  s_add_u32 s62, s62, s63
  buffer_load_dwordx4 v3, s[36:39], s62 offen lds
  s_add_u32 m0, s54, 33792
  s_add_u32 s62, s62, s63
  buffer_load_dwordx4 v3, s[36:39], s62 offen lds
  s_add_u32 m0, s54, 34816
  s_add_u32 s62, s62, s63
  buffer_load_dwordx4 v3, s[36:39], s62 offen lds
  s_add_u32 m0, s54, 35840
  s_add_u32 s62, s62, s63
  buffer_load_dwordx4 v3, s[36:39], s62 offen lds
  s_waitcnt vmcnt(27)
  ds_read_b64_tr_b16 a[0:1], v4 offset:0
  ds_read_b64_tr_b16 a[2:3], v4 offset:256
  ds_read_b64_tr_b16 a[4:5], v4 offset:1024
  ds_read_b64_tr_b16 a[6:7], v4 offset:1280
  ds_read_b64_tr_b16 a[8:9], v4 offset:2048
  ds_read_b64_tr_b16 a[10:11], v4 offset:2304
  ds_read_b64_tr_b16 a[12:13], v4 offset:3072
  ds_read_b64_tr_b16 a[14:15], v4 offset:3328
  ds_read_b64_tr_b16 a[16:17], v4 offset:4096
  ds_read_b64_tr_b16 a[18:19], v4 offset:4352
  ds_read_b64_tr_b16 a[20:21], v4 offset:5120
  ds_read_b64_tr_b16 a[22:23], v4 offset:5376
  ds_read_b64_tr_b16 a[24:25], v4 offset:6144
  ds_read_b64_tr_b16 a[26:27], v4 offset:6400
  ds_read_b64_tr_b16 a[28:29], v4 offset:7168
  ds_read_b64_tr_b16 a[30:31], v4 offset:7424
  ds_read_b64_tr_b16 a[32:33], v4 offset:8192
  ds_read_b64_tr_b16 a[34:35], v4 offset:8448
  s_waitcnt lgkmcnt(0)
  s_mul_i32 s62, s59, 0
  s_add_u32 s62, s62, s58
  s_add_u32 m0, s54, 0
  s_nop 0
  buffer_load_dwordx4 v3, s[40:43], s62 offen lds
  s_add_u32 m0, s54, 1024
  s_add_u32 s62, s62, s63
  buffer_load_dwordx4 v3, s[40:43], s62 offen lds
  s_add_u32 m0, s54, 2048
  s_add_u32 s62, s62, s63
  buffer_load_dwordx4 v3, s[40:43], s62 offen lds
  s_add_u32 m0, s54, 3072
  s_add_u32 s62, s62, s63
  buffer_load_dwordx4 v3, s[40:43], s62 offen lds
  s_add_u32 m0, s54, 4096
  s_add_u32 s62, s62, s63
  buffer_load_dwordx4 v3, s[40:43], s62 offen lds
  s_add_u32 m0, s54, 5120
  s_add_u32 s62, s62, s63
  buffer_load_dwordx4 v3, s[40:43], s62 offen lds
  s_add_u32 m0, s54, 6144
  s_add_u32 s62, s62, s63
  buffer_load_dwordx4 v3, s[40:43], s62 offen lds
  s_add_u32 m0, s54, 7168
  s_add_u32 s62, s62, s63
  buffer_load_dwordx4 v3, s[40:43], s62 offen lds
  s_add_u32 m0, s54, 8192
  s_add_u32 s62, s62, s63
  buffer_load_dwordx4 v3, s[40:43], s62 offen lds
  s_waitcnt vmcnt(27)
  ds_read_b64_tr_b16 a[36:37], v4 offset:9216
  ds_read_b64_tr_b16 a[38:39], v4 offset:9472
  ds_read_b64_tr_b16 a[40:41], v4 offset:10240
  ds_read_b64_tr_b16 a[42:43], v4 offset:10496
  ds_read_b64_tr_b16 a[44:45], v4 offset:11264
  ds_read_b64_tr_b16 a[46:47], v4 offset:11520
  ds_read_b64_tr_b16 a[48:49], v4 offset:12288
  ds_read_b64_tr_b16 a[50:51], v4 offset:12544
  ds_read_b64_tr_b16 a[52:53], v4 offset:13312
  ds_read_b64_tr_b16 a[54:55], v4 offset:13568
  ds_read_b64_tr_b16 a[56:57], v4 offset:14336
  ds_read_b64_tr_b16 a[58:59], v4 offset:14592
  ds_read_b64_tr_b16 a[60:61], v4 offset:15360
  ds_read_b64_tr_b16 a[62:63], v4 offset:15616
  ds_read_b64_tr_b16 a[64:65], v4 offset:16384
  ds_read_b64_tr_b16 a[66:67], v4 offset:16640
  ds_read_b64_tr_b16 a[68:69], v4 offset:17408
  ds_read_b64_tr_b16 a[70:71], v4 offset:17664
  s_waitcnt lgkmcnt(0)
  s_mul_i32 s62, s59, 144
  s_add_u32 s62, s62, s58
  s_add_u32 m0, s54, 9216
  s_nop 0
  buffer_load_dwordx4 v3, s[40:43], s62 offen lds
  s_add_u32 m0, s54, 10240
  s_add_u32 s62, s62, s63
  buffer_load_dwordx4 v3, s[40:43], s62 offen lds
  s_add_u32 m0, s54, 11264
  s_add_u32 s62, s62, s63
  buffer_load_dwordx4 v3, s[40:43], s62 offen lds
  s_add_u32 m0, s54, 12288
  s_add_u32 s62, s62, s63
  buffer_load_dwordx4 v3, s[40:43], s62 offen lds
  s_add_u32 m0, s54, 13312
  s_add_u32 s62, s62, s63
  buffer_load_dwordx4 v3, s[40:43], s62 offen lds
  s_add_u32 m0, s54, 14336
  s_add_u32 s62, s62, s63
  buffer_load_dwordx4 v3, s[40:43], s62 offen lds
  s_add_u32 m0, s54, 15360
  s_add_u32 s62, s62, s63
  buffer_load_dwordx4 v3, s[40:43], s62 offen lds
  s_add_u32 m0, s54, 16384
  s_add_u32 s62, s62, s63
  buffer_load_dwordx4 v3, s[40:43], s62 offen lds
  s_add_u32 m0, s54, 17408
  s_add_u32 s62, s62, s63
  buffer_load_dwordx4 v3, s[40:43], s62 offen lds
  s_waitcnt vmcnt(27)
  ds_read_b64_tr_b16 a[72:73], v4 offset:18432
  ds_read_b64_tr_b16 a[74:75], v4 offset:18688
  ds_read_b64_tr_b16 a[76:77], v4 offset:19456
  ds_read_b64_tr_b16 a[78:79], v4 offset:19712
  ds_read_b64_tr_b16 a[80:81], v4 offset:20480
  ds_read_b64_tr_b16 a[82:83], v4 offset:20736
  ds_read_b64_tr_b16 a[84:85], v4 offset:21504
  ds_read_b64_tr_b16 a[86:87], v4 offset:21760
  ds_read_b64_tr_b16 a[88:89], v4 offset:22528
  ds_read_b64_tr_b16 a[90:91], v4 offset:22784
  ds_read_b64_tr_b16 a[92:93], v4 offset:23552
  ds_read_b64_tr_b16 a[94:95], v4 offset:23808
  ds_read_b64_tr_b16 a[96:97], v4 offset:24576
  ds_read_b64_tr_b16 a[98:99], v4 offset:24832
  ds_read_b64_tr_b16 a[100:101], v4 offset:25600
  ds_read_b64_tr_b16 a[102:103], v4 offset:25856
  ds_read_b64_tr_b16 a[104:105], v4 offset:26624
  ds_read_b64_tr_b16 a[106:107], v4 offset:26880
  s_waitcnt lgkmcnt(0)
  s_mul_i32 s62, s59, 288
  s_add_u32 s62, s62, s58
  s_add_u32 m0, s54, 18432
  s_nop 0
  buffer_load_dwordx4 v3, s[40:43], s62 offen lds
  s_add_u32 m0, s54, 19456
  s_add_u32 s62, s62, s63
  buffer_load_dwordx4 v3, s[40:43], s62 offen lds
  s_add_u32 m0, s54, 20480
  s_add_u32 s62, s62, s63
  buffer_load_dwordx4 v3, s[40:43], s62 offen lds
  s_add_u32 m0, s54, 21504
  s_add_u32 s62, s62, s63
  buffer_load_dwordx4 v3, s[40:43], s62 offen lds
  s_add_u32 m0, s54, 22528
  s_add_u32 s62, s62, s63
  buffer_load_dwordx4 v3, s[40:43], s62 offen lds
  s_add_u32 m0, s54, 23552
  s_add_u32 s62, s62, s63
  buffer_load_dwordx4 v3, s[40:43], s62 offen lds
  s_add_u32 m0, s54, 24576
  s_add_u32 s62, s62, s63
  buffer_load_dwordx4 v3, s[40:43], s62 offen lds
  s_add_u32 m0, s54, 25600
  s_add_u32 s62, s62, s63
  buffer_load_dwordx4 v3, s[40:43], s62 offen lds
  s_add_u32 m0, s54, 26624
  s_add_u32 s62, s62, s63
  buffer_load_dwordx4 v3, s[40:43], s62 offen lds
  s_waitcnt vmcnt(27)
  ds_read_b64_tr_b16 a[108:109], v4 offset:27648
  ds_read_b64_tr_b16 a[110:111], v4 offset:27904
  ds_read_b64_tr_b16 a[112:113], v4 offset:28672
  ds_read_b64_tr_b16 a[114:115], v4 offset:28928
  ds_read_b64_tr_b16 a[116:117], v4 offset:29696
  ds_read_b64_tr_b16 a[118:119], v4 offset:29952
  ds_read_b64_tr_b16 a[120:121], v4 offset:30720
  ds_read_b64_tr_b16 a[122:123], v4 offset:30976
  ds_read_b64_tr_b16 a[124:125], v4 offset:31744
  ds_read_b64_tr_b16 a[126:127], v4 offset:32000
  ds_read_b64_tr_b16 a[128:129], v4 offset:32768
  ds_read_b64_tr_b16 a[130:131], v4 offset:33024
  ds_read_b64_tr_b16 a[132:133], v4 offset:33792
  ds_read_b64_tr_b16 a[134:135], v4 offset:34048
  ds_read_b64_tr_b16 a[136:137], v4 offset:34816
  ds_read_b64_tr_b16 a[138:139], v4 offset:35072
  ds_read_b64_tr_b16 a[140:141], v4 offset:35840
  ds_read_b64_tr_b16 a[142:143], v4 offset:36096
  s_waitcnt lgkmcnt(0)
  s_mul_i32 s62, s59, 432
  s_add_u32 s62, s62, s58
  s_add_u32 m0, s54, 27648
  s_nop 0
  buffer_load_dwordx4 v3, s[40:43], s62 offen lds
  s_add_u32 m0, s54, 28672
  s_add_u32 s62, s62, s63
  buffer_load_dwordx4 v3, s[40:43], s62 offen lds
  s_add_u32 m0, s54, 29696
  s_add_u32 s62, s62, s63
  buffer_load_dwordx4 v3, s[40:43], s62 offen lds
  s_add_u32 m0, s54, 30720
  s_add_u32 s62, s62, s63
  buffer_load_dwordx4 v3, s[40:43], s62 offen lds
  s_add_u32 m0, s54, 31744
  s_add_u32 s62, s62, s63
  buffer_load_dwordx4 v3, s[40:43], s62 offen lds
  s_add_u32 m0, s54, 32768
  s_add_u32 s62, s62, s63
  buffer_load_dwordx4 v3, s[40:43], s62 offen lds
  s_add_u32 m0, s54, 33792
  s_add_u32 s62, s62, s63
  buffer_load_dwordx4 v3, s[40:43], s62 offen lds
  s_add_u32 m0, s54, 34816
  s_add_u32 s62, s62, s63
  buffer_load_dwordx4 v3, s[40:43], s62 offen lds
  s_add_u32 m0, s54, 35840
  s_add_u32 s62, s62, s63
  buffer_load_dwordx4 v3, s[40:43], s62 offen lds
  s_waitcnt vmcnt(27)
  ds_read_b64_tr_b16 a[144:145], v4 offset:0
  ds_read_b64_tr_b16 a[146:147], v4 offset:256
  ds_read_b64_tr_b16 a[148:149], v4 offset:1024
  ds_read_b64_tr_b16 a[150:151], v4 offset:1280
  ds_read_b64_tr_b16 a[152:153], v4 offset:2048
  ds_read_b64_tr_b16 a[154:155], v4 offset:2304
  ds_read_b64_tr_b16 a[156:157], v4 offset:3072
  ds_read_b64_tr_b16 a[158:159], v4 offset:3328
  ds_read_b64_tr_b16 a[160:161], v4 offset:4096
  ds_read_b64_tr_b16 a[162:163], v4 offset:4352
  ds_read_b64_tr_b16 a[164:165], v4 offset:5120
  ds_read_b64_tr_b16 a[166:167], v4 offset:5376
  ds_read_b64_tr_b16 a[168:169], v4 offset:6144
  ds_read_b64_tr_b16 a[170:171], v4 offset:6400
  ds_read_b64_tr_b16 a[172:173], v4 offset:7168
  ds_read_b64_tr_b16 a[174:175], v4 offset:7424
  ds_read_b64_tr_b16 a[176:177], v4 offset:8192
  ds_read_b64_tr_b16 a[178:179], v4 offset:8448
  s_waitcnt lgkmcnt(0)
  s_add_u32 m0, s55, 0
  s_nop 0
  buffer_load_dwordx4 v2, s[32:35], s48 offen offset:0 lds
  s_add_u32 m0, s55, 896
  s_nop 0
  buffer_load_dwordx4 v2, s[32:35], s48 offen offset:128 lds
  s_add_u32 m0, s55, 1792
  s_nop 0
  buffer_load_dwordx4 v2, s[32:35], s48 offen offset:256 lds
  s_add_u32 m0, s55, 2688
  s_nop 0
  buffer_load_dwordx4 v2, s[32:35], s48 offen offset:384 lds
  s_add_u32 m0, s55, 3584
  s_nop 0
  buffer_load_dwordx4 v2, s[32:35], s48 offen offset:512 lds
  s_add_u32 m0, s55, 4480
  s_nop 0
  buffer_load_dwordx4 v2, s[32:35], s48 offen offset:640 lds
  s_add_u32 m0, s55, 5376
  s_nop 0
  buffer_load_dwordx4 v2, s[32:35], s48 offen offset:768 lds
  s_add_u32 m0, s55, 6272
  s_nop 0
  buffer_load_dwordx4 v2, s[32:35], s48 offen offset:896 lds
  s_add_u32 m0, s55, 7168
  s_nop 0
  buffer_load_dwordx4 v2, s[32:35], s48 offen offset:1024 lds
  s_add_u32 s48, s48, s49
  s_sub_u32 s64, s64, 1
  s_cmp_gt_i32 s64, 0
  s_cselect_b32 s48, s48, 1073741824
  s_add_u32 s65, s65, 9216
  s_cmp_eq_u32 s65, 36864
  s_cselect_b32 s65, 0, s65
  s_add_u32 s55, s54, s65
  s_waitcnt vmcnt(27)
  ds_read_b64_tr_b16 a[180:181], v4 offset:9216
  ds_read_b64_tr_b16 a[182:183], v4 offset:9472
  ds_read_b64_tr_b16 a[184:185], v4 offset:10240
  ds_read_b64_tr_b16 a[186:187], v4 offset:10496
  ds_read_b64_tr_b16 a[188:189], v4 offset:11264
  ds_read_b64_tr_b16 a[190:191], v4 offset:11520
  ds_read_b64_tr_b16 a[192:193], v4 offset:12288
  ds_read_b64_tr_b16 a[194:195], v4 offset:12544
  ds_read_b64_tr_b16 a[196:197], v4 offset:13312
  ds_read_b64_tr_b16 a[198:199], v4 offset:13568
  ds_read_b64_tr_b16 a[200:201], v4 offset:14336
  ds_read_b64_tr_b16 a[202:203], v4 offset:14592
  ds_read_b64_tr_b16 a[204:205], v4 offset:15360
  ds_read_b64_tr_b16 a[206:207], v4 offset:15616
  ds_read_b64_tr_b16 a[208:209], v4 offset:16384
  ds_read_b64_tr_b16 a[210:211], v4 offset:16640
  ds_read_b64_tr_b16 a[212:213], v4 offset:17408
  ds_read_b64_tr_b16 a[214:215], v4 offset:17664
  s_waitcnt lgkmcnt(0)
  s_add_u32 m0, s55, 0
  s_nop 0
  buffer_load_dwordx4 v2, s[32:35], s48 offen offset:0 lds
  s_add_u32 m0, s55, 896
  s_nop 0
  buffer_load_dwordx4 v2, s[32:35], s48 offen offset:128 lds
  s_add_u32 m0, s55, 1792
  s_nop 0
  buffer_load_dwordx4 v2, s[32:35], s48 offen offset:256 lds
  s_add_u32 m0, s55, 2688
  s_nop 0
  buffer_load_dwordx4 v2, s[32:35], s48 offen offset:384 lds
  s_add_u32 m0, s55, 3584
  s_nop 0
  buffer_load_dwordx4 v2, s[32:35], s48 offen offset:512 lds
  s_add_u32 m0, s55, 4480
  s_nop 0
  buffer_load_dwordx4 v2, s[32:35], s48 offen offset:640 lds
  s_add_u32 m0, s55, 5376
  s_nop 0
  buffer_load_dwordx4 v2, s[32:35], s48 offen offset:768 lds
  s_add_u32 m0, s55, 6272
  s_nop 0
  buffer_load_dwordx4 v2, s[32:35], s48 offen offset:896 lds
  s_add_u32 m0, s55, 7168
  s_nop 0
  buffer_load_dwordx4 v2, s[32:35], s48 offen offset:1024 lds
  s_add_u32 s48, s48, s49
  s_sub_u32 s64, s64, 1
  s_cmp_gt_i32 s64, 0
  s_cselect_b32 s48, s48, 1073741824
  s_add_u32 s65, s65, 9216
  s_cmp_eq_u32 s65, 36864
  s_cselect_b32 s65, 0, s65
  s_add_u32 s55, s54, s65
  s_waitcnt vmcnt(27)
  ds_read_b64_tr_b16 a[216:217], v4 offset:18432
  ds_read_b64_tr_b16 a[218:219], v4 offset:18688
  ds_read_b64_tr_b16 a[220:221], v4 offset:19456
  ds_read_b64_tr_b16 a[222:223], v4 offset:19712
  ds_read_b64_tr_b16 a[224:225], v4 offset:20480
  ds_read_b64_tr_b16 a[226:227], v4 offset:20736
  ds_read_b64_tr_b16 a[228:229], v4 offset:21504
  ds_read_b64_tr_b16 a[230:231], v4 offset:21760
  ds_read_b64_tr_b16 a[232:233], v4 offset:22528
  ds_read_b64_tr_b16 a[234:235], v4 offset:22784
  ds_read_b64_tr_b16 a[236:237], v4 offset:23552
  ds_read_b64_tr_b16 a[238:239], v4 offset:23808
  ds_read_b64_tr_b16 a[240:241], v4 offset:24576
  ds_read_b64_tr_b16 a[242:243], v4 offset:24832
  ds_read_b64_tr_b16 a[244:245], v4 offset:25600
  ds_read_b64_tr_b16 a[246:247], v4 offset:25856
  ds_read_b64_tr_b16 a[248:249], v4 offset:26624
  ds_read_b64_tr_b16 a[250:251], v4 offset:26880
  s_waitcnt lgkmcnt(0)
  s_add_u32 m0, s55, 0
  s_nop 0
  buffer_load_dwordx4 v2, s[32:35], s48 offen offset:0 lds
  s_add_u32 m0, s55, 896
  s_nop 0
  buffer_load_dwordx4 v2, s[32:35], s48 offen offset:128 lds
  s_add_u32 m0, s55, 1792
  s_nop 0
  buffer_load_dwordx4 v2, s[32:35], s48 offen offset:256 lds
  s_add_u32 m0, s55, 2688
  s_nop 0
  buffer_load_dwordx4 v2, s[32:35], s48 offen offset:384 lds
  s_add_u32 m0, s55, 3584
  s_nop 0
  buffer_load_dwordx4 v2, s[32:35], s48 offen offset:512 lds
  s_add_u32 m0, s55, 4480
  s_nop 0
  buffer_load_dwordx4 v2, s[32:35], s48 offen offset:640 lds
  s_add_u32 m0, s55, 5376
  s_nop 0
  buffer_load_dwordx4 v2, s[32:35], s48 offen offset:768 lds
  s_add_u32 m0, s55, 6272
  s_nop 0
  buffer_load_dwordx4 v2, s[32:35], s48 offen offset:896 lds
  s_add_u32 m0, s55, 7168
  s_nop 0
  buffer_load_dwordx4 v2, s[32:35], s48 offen offset:1024 lds
  s_add_u32 s48, s48, s49
  s_sub_u32 s64, s64, 1
  s_cmp_gt_i32 s64, 0
  s_cselect_b32 s48, s48, 1073741824
  s_add_u32 s65, s65, 9216
  s_cmp_eq_u32 s65, 36864
  s_cselect_b32 s65, 0, s65
  s_add_u32 s55, s54, s65
  s_waitcnt vmcnt(27)
  ds_read_b64_tr_b16 a[252:253], v4 offset:27648
  ds_read_b64_tr_b16 a[254:255], v4 offset:27904
  ds_read_b64_tr_b16 v[124:125], v4 offset:28672
  ds_read_b64_tr_b16 v[126:127], v4 offset:28928
  ds_read_b64_tr_b16 v[128:129], v4 offset:29696
  ds_read_b64_tr_b16 v[130:131], v4 offset:29952
  ds_read_b64_tr_b16 v[132:133], v4 offset:30720
  ds_read_b64_tr_b16 v[134:135], v4 offset:30976
  ds_read_b64_tr_b16 v[136:137], v4 offset:31744
  ds_read_b64_tr_b16 v[138:139], v4 offset:32000
  ds_read_b64_tr_b16 v[140:141], v4 offset:32768
  ds_read_b64_tr_b16 v[142:143], v4 offset:33024
  ds_read_b64_tr_b16 v[144:145], v4 offset:33792
  ds_read_b64_tr_b16 v[146:147], v4 offset:34048
  ds_read_b64_tr_b16 v[148:149], v4 offset:34816
  ds_read_b64_tr_b16 v[150:151], v4 offset:35072
  ds_read_b64_tr_b16 v[152:153], v4 offset:35840
  ds_read_b64_tr_b16 v[154:155], v4 offset:36096
  s_waitcnt lgkmcnt(0)
  v_mov_b32 v250, 72
  s_mov_b32 s95, 4000000
.ww8:
  global_load_dword v251, v250, s[24:25] sc1
  s_waitcnt vmcnt(0)
  v_readfirstlane_b32 s94, v251
  s_cmp_lg_u32 s94, 0
  s_cbranch_scc1 .ww8_ok
  s_sleep 1
  s_sub_u32 s95, s95, 1
  s_cmp_lg_u32 s95, 0
  s_cbranch_scc1 .ww8
.ww8_ok:
  s_mov_b32 s61, s51
  s_mov_b32 s62, s52
  s_mov_b32 s51, 1073741824
  s_mov_b32 s52, 1073741824
  s_mov_b32 s56, 0
  v_mov_b32 v9, v5
  v_mov_b32 v10, v6
  v_mov_b32 v11, v7
  v_mov_b32 v12, v8
  s_waitcnt vmcnt(9)
  s_barrier
  ds_read_b128 v[20:23], v9 offset:0
  ds_read_b128 v[24:27], v10 offset:0
  ds_read_b128 v[28:31], v11 offset:0
  ds_read_b128 v[32:35], v12 offset:0
  ds_read_b128 v[36:39], v9 offset:1024
.Lconcat_heads__mha_block__memory_aug_recurrent_mem_tr__prompt_kernelaqk_loop:
  ds_read_b128 v[40:43], v10 offset:1024
  s_waitcnt lgkmcnt(5)
  v_mfma_f32_32x32x16_bf16 v[60:75], a[0:3], v[20:23], 0
  s_add_u32 s56, s56, 9216
  s_cmp_eq_u32 s56, 36864
  s_cselect_b32 s56, 0, s56
  v_mfma_f32_32x32x16_bf16 v[76:91], a[144:147], v[20:23], 0
  v_add_u32 v13, s56, v5
  ds_read_b128 v[20:23], v11 offset:1024
  s_waitcnt lgkmcnt(5)
  v_mfma_f32_32x32x16_bf16 v[60:75], a[4:7], v[24:27], v[60:75]
  v_add_u32 v14, s56, v6
  v_mfma_f32_32x32x16_bf16 v[76:91], a[148:151], v[24:27], v[76:91]
  v_add_u32 v15, s56, v7
  ds_read_b128 v[24:27], v12 offset:1024
  s_waitcnt lgkmcnt(5)
  v_mfma_f32_32x32x16_bf16 v[60:75], a[8:11], v[28:31], v[60:75]
  v_add_u32 v16, s56, v8
  v_mfma_f32_32x32x16_bf16 v[76:91], a[152:155], v[28:31], v[76:91]
  v_mul_f32 v92, s70, v92
  v_mul_f32 v93, s70, v93
  ds_read_b128 v[28:31], v9 offset:2048
  s_waitcnt lgkmcnt(5)
  v_mfma_f32_32x32x16_bf16 v[60:75], a[12:15], v[32:35], v[60:75]
  v_mul_f32 v94, s70, v94
  v_mul_f32 v95, s70, v95
  v_mfma_f32_32x32x16_bf16 v[76:91], a[156:159], v[32:35], v[76:91]
  v_mul_f32 v96, s70, v96
  v_mul_f32 v97, s70, v97
  ds_read_b128 v[32:35], v10 offset:2048
  s_waitcnt lgkmcnt(5)
  v_mfma_f32_32x32x16_bf16 v[60:75], a[16:19], v[36:39], v[60:75]
  v_mul_f32 v98, s70, v98
  v_mul_f32 v99, s70, v99
  v_mfma_f32_32x32x16_bf16 v[76:91], a[160:163], v[36:39], v[76:91]
  v_mul_f32 v100, s70, v100
  v_mul_f32 v101, s70, v101
  ds_read_b128 v[36:39], v11 offset:2048
  s_waitcnt lgkmcnt(5)
  v_mfma_f32_32x32x16_bf16 v[60:75], a[20:23], v[40:43], v[60:75]
  v_cvt_pk_bf16_f32 v44, v92, v93
  v_mfma_f32_32x32x16_bf16 v[76:91], a[164:167], v[40:43], v[76:91]
  v_cvt_pk_bf16_f32 v45, v94, v95
  ds_read_b128 v[40:43], v12 offset:2048
  s_waitcnt lgkmcnt(5)
  v_mfma_f32_32x32x16_bf16 v[60:75], a[24:27], v[20:23], v[60:75]
  v_cvt_pk_bf16_f32 v46, v96, v97
  v_mfma_f32_32x32x16_bf16 v[76:91], a[168:171], v[20:23], v[76:91]
  v_cvt_pk_bf16_f32 v47, v98, v99
  ds_read_b128 v[20:23], v9 offset:3072
  s_waitcnt lgkmcnt(5)
  v_mfma_f32_32x32x16_bf16 v[60:75], a[28:31], v[24:27], v[60:75]
  v_cvt_pk_bf16_f32 v48, v100, v101
  v_mfma_f32_32x32x16_bf16 v[76:91], a[172:175], v[24:27], v[76:91]
  buffer_store_dwordx4 v[44:47], v17, s[44:47], s51 offen offset:0 sc1
  ds_read_b128 v[24:27], v10 offset:3072
  s_waitcnt lgkmcnt(5)
  v_mfma_f32_32x32x16_bf16 v[60:75], a[32:35], v[28:31], v[60:75]
  s_mov_b64 exec, 0xffffffff
  buffer_store_dword v48, v158, s[44:47], s51 offen offset:1024 sc1
  s_mov_b64 exec, -1
  v_mfma_f32_32x32x16_bf16 v[76:91], a[176:179], v[28:31], v[76:91]
  v_cvt_pk_bf16_f32 v52, v108, v109
  ds_read_b128 v[28:31], v11 offset:3072
  s_waitcnt lgkmcnt(5)
  v_mfma_f32_32x32x16_bf16 v[60:75], a[36:39], v[32:35], v[60:75]
  v_cvt_pk_bf16_f32 v53, v110, v111
  v_mfma_f32_32x32x16_bf16 v[76:91], a[180:183], v[32:35], v[76:91]
  v_cvt_pk_bf16_f32 v54, v112, v113
  ds_read_b128 v[32:35], v12 offset:3072
  s_waitcnt lgkmcnt(5)
  v_mfma_f32_32x32x16_bf16 v[60:75], a[40:43], v[36:39], v[60:75]
  v_cvt_pk_bf16_f32 v55, v114, v115
  v_mfma_f32_32x32x16_bf16 v[76:91], a[184:187], v[36:39], v[76:91]
  v_cvt_pk_bf16_f32 v56, v116, v117
  ds_read_b128 v[36:39], v9 offset:4096
  s_waitcnt lgkmcnt(5)
  v_mfma_f32_32x32x16_bf16 v[60:75], a[44:47], v[40:43], v[60:75]
  v_mov_b32 v57, 0x3f803f80
  v_mfma_f32_32x32x16_bf16 v[76:91], a[188:191], v[40:43], v[76:91]
  buffer_store_dwordx4 v[52:55], v18, s[44:47], s52 offen offset:0 sc1
  ds_read_b128 v[40:43], v10 offset:4096
  s_waitcnt lgkmcnt(5)
  v_mfma_f32_32x32x16_bf16 v[60:75], a[48:51], v[20:23], v[60:75]
  s_mov_b64 exec, 0xffffffff
  buffer_store_dwordx2 v[56:57], v157, s[44:47], s52 offen offset:1024 sc1
  s_mov_b64 exec, -1
  v_mfma_f32_32x32x16_bf16 v[76:91], a[192:195], v[20:23], v[76:91]
  ds_read_b128 v[20:23], v11 offset:4096
  s_waitcnt lgkmcnt(5)
  v_mfma_f32_32x32x16_bf16 v[60:75], a[52:55], v[24:27], v[60:75]
  v_mfma_f32_32x32x16_bf16 v[76:91], a[196:199], v[24:27], v[76:91]
  ds_read_b128 v[24:27], v12 offset:4096
  s_waitcnt lgkmcnt(5)
  v_mfma_f32_32x32x16_bf16 v[60:75], a[56:59], v[28:31], v[60:75]
  v_mfma_f32_32x32x16_bf16 v[76:91], a[200:203], v[28:31], v[76:91]
  ds_read_b128 v[28:31], v9 offset:5120
  s_waitcnt lgkmcnt(5)
  v_mfma_f32_32x32x16_bf16 v[60:75], a[60:63], v[32:35], v[60:75]
  v_mfma_f32_32x32x16_bf16 v[76:91], a[204:207], v[32:35], v[76:91]
  ds_read_b128 v[32:35], v10 offset:5120
  s_waitcnt lgkmcnt(5)
  v_mfma_f32_32x32x16_bf16 v[60:75], a[64:67], v[36:39], v[60:75]
  v_mfma_f32_32x32x16_bf16 v[76:91], a[208:211], v[36:39], v[76:91]
  ds_read_b128 v[36:39], v11 offset:5120
  s_waitcnt lgkmcnt(5)
  v_mfma_f32_32x32x16_bf16 v[60:75], a[68:71], v[40:43], v[60:75]
  v_mfma_f32_32x32x16_bf16 v[76:91], a[212:215], v[40:43], v[76:91]
  ds_read_b128 v[40:43], v12 offset:5120
  s_waitcnt lgkmcnt(5)
  v_mfma_f32_32x32x16_bf16 v[60:75], a[72:75], v[20:23], v[60:75]
  v_mfma_f32_32x32x16_bf16 v[76:91], a[216:219], v[20:23], v[76:91]
  ds_read_b128 v[20:23], v9 offset:6144
  s_waitcnt lgkmcnt(5)
  v_mfma_f32_32x32x16_bf16 v[60:75], a[76:79], v[24:27], v[60:75]
  v_mfma_f32_32x32x16_bf16 v[76:91], a[220:223], v[24:27], v[76:91]
  ds_read_b128 v[24:27], v10 offset:6144
  s_waitcnt lgkmcnt(5)
  v_mfma_f32_32x32x16_bf16 v[60:75], a[80:83], v[28:31], v[60:75]
  v_mfma_f32_32x32x16_bf16 v[76:91], a[224:227], v[28:31], v[76:91]
  ds_read_b128 v[28:31], v11 offset:6144
  s_waitcnt lgkmcnt(5)
  v_mfma_f32_32x32x16_bf16 v[60:75], a[84:87], v[32:35], v[60:75]
  v_mfma_f32_32x32x16_bf16 v[76:91], a[228:231], v[32:35], v[76:91]
  ds_read_b128 v[32:35], v12 offset:6144
  s_waitcnt lgkmcnt(5)
  v_mfma_f32_32x32x16_bf16 v[60:75], a[88:91], v[36:39], v[60:75]
  s_mov_b32 s51, s61
  s_mov_b32 s52, s62
  s_add_u32 s61, s61, s53
  s_add_u32 s62, s62, s71
  v_mfma_f32_32x32x16_bf16 v[76:91], a[232:235], v[36:39], v[76:91]
  s_waitcnt vmcnt(17)
  s_barrier
  ds_read_b128 v[36:39], v9 offset:7168
  s_waitcnt lgkmcnt(5)
  v_mfma_f32_32x32x16_bf16 v[60:75], a[92:95], v[40:43], v[60:75]
  v_mfma_f32_32x32x16_bf16 v[76:91], a[236:239], v[40:43], v[76:91]
  s_add_u32 m0, s55, 0
  ds_read_b128 v[40:43], v10 offset:7168
  s_waitcnt lgkmcnt(5)
  v_mfma_f32_32x32x16_bf16 v[60:75], a[96:99], v[20:23], v[60:75]
  buffer_load_dwordx4 v2, s[32:35], s48 offen offset:0 lds
  v_mfma_f32_32x32x16_bf16 v[76:91], a[240:243], v[20:23], v[76:91]
  s_add_u32 m0, s55, 896
  ds_read_b128 v[20:23], v11 offset:7168
  s_waitcnt lgkmcnt(5)
  v_mfma_f32_32x32x16_bf16 v[60:75], a[100:103], v[24:27], v[60:75]
  buffer_load_dwordx4 v2, s[32:35], s48 offen offset:128 lds
  v_mfma_f32_32x32x16_bf16 v[76:91], a[244:247], v[24:27], v[76:91]
  s_add_u32 m0, s55, 1792
  ds_read_b128 v[24:27], v12 offset:7168
  s_waitcnt lgkmcnt(5)
  v_mfma_f32_32x32x16_bf16 v[60:75], a[104:107], v[28:31], v[60:75]
  buffer_load_dwordx4 v2, s[32:35], s48 offen offset:256 lds
  v_mfma_f32_32x32x16_bf16 v[76:91], a[248:251], v[28:31], v[76:91]
  s_add_u32 m0, s55, 2688
  ds_read_b128 v[28:31], v9 offset:8192
  s_waitcnt lgkmcnt(5)
  v_mfma_f32_32x32x16_bf16 v[60:75], a[108:111], v[32:35], v[60:75]
  buffer_load_dwordx4 v2, s[32:35], s48 offen offset:384 lds
  v_mfma_f32_32x32x16_bf16 v[76:91], a[252:255], v[32:35], v[76:91]
  s_add_u32 m0, s55, 3584
  ds_read_b128 v[32:35], v10 offset:8192
  s_waitcnt lgkmcnt(5)
  v_mfma_f32_32x32x16_bf16 v[60:75], a[112:115], v[36:39], v[60:75]
  buffer_load_dwordx4 v2, s[32:35], s48 offen offset:512 lds
  v_mfma_f32_32x32x16_bf16 v[76:91], v[124:127], v[36:39], v[76:91]
  s_add_u32 m0, s55, 4480
  ds_read_b128 v[36:39], v11 offset:8192
  s_waitcnt lgkmcnt(5)
  v_mfma_f32_32x32x16_bf16 v[60:75], a[116:119], v[40:43], v[60:75]
  buffer_load_dwordx4 v2, s[32:35], s48 offen offset:640 lds
  v_mfma_f32_32x32x16_bf16 v[76:91], v[128:131], v[40:43], v[76:91]
  s_add_u32 m0, s55, 5376
  ds_read_b128 v[40:43], v12 offset:8192
  s_waitcnt lgkmcnt(5)
  v_mfma_f32_32x32x16_bf16 v[60:75], a[120:123], v[20:23], v[60:75]
  buffer_load_dwordx4 v2, s[32:35], s48 offen offset:768 lds
  v_mfma_f32_32x32x16_bf16 v[76:91], v[132:135], v[20:23], v[76:91]
  s_add_u32 m0, s55, 6272
  ds_read_b128 v[20:23], v13 offset:0
  s_waitcnt lgkmcnt(5)
  v_mfma_f32_32x32x16_bf16 v[60:75], a[124:127], v[24:27], v[60:75]
  buffer_load_dwordx4 v2, s[32:35], s48 offen offset:896 lds
  v_mfma_f32_32x32x16_bf16 v[76:91], v[136:139], v[24:27], v[76:91]
  s_add_u32 m0, s55, 7168
  ds_read_b128 v[24:27], v14 offset:0
  s_waitcnt lgkmcnt(5)
  v_mfma_f32_32x32x16_bf16 v[60:75], a[128:131], v[28:31], v[60:75]
  buffer_load_dwordx4 v2, s[32:35], s48 offen offset:1024 lds
  v_mfma_f32_32x32x16_bf16 v[76:91], v[140:143], v[28:31], v[76:91]
  ds_read_b128 v[28:31], v15 offset:0
  s_waitcnt lgkmcnt(5)
  v_mfma_f32_32x32x16_bf16 v[60:75], a[132:135], v[32:35], v[60:75]
  s_add_u32 s48, s48, s49
  s_sub_u32 s64, s64, 1
  s_cmp_gt_i32 s64, 0
  s_cselect_b32 s48, s48, 1073741824
  s_add_u32 s65, s65, 9216
  s_cmp_eq_u32 s65, 36864
  s_cselect_b32 s65, 0, s65
  s_add_u32 s55, s54, s65
  v_mfma_f32_32x32x16_bf16 v[76:91], v[144:147], v[32:35], v[76:91]
  ds_read_b128 v[32:35], v16 offset:0
  s_waitcnt lgkmcnt(5)
  v_mfma_f32_32x32x16_bf16 v[60:75], a[136:139], v[36:39], v[60:75]
  v_mfma_f32_32x32x16_bf16 v[76:91], v[148:151], v[36:39], v[76:91]
  ds_read_b128 v[36:39], v13 offset:1024
  s_waitcnt lgkmcnt(5)
  v_mfma_f32_32x32x16_bf16 v[60:75], a[140:143], v[40:43], v[60:75]
  v_mfma_f32_32x32x16_bf16 v[76:91], v[152:155], v[40:43], v[76:91]
  s_sub_u32 s50, s50, 1
  s_cmp_eq_u32 s50, 0
  s_cbranch_scc1 .Lconcat_heads__mha_block__memory_aug_recurrent_mem_tr__prompt_kernelaqk_tail0
  ds_read_b128 v[40:43], v14 offset:1024
  s_waitcnt lgkmcnt(5)
  v_mfma_f32_32x32x16_bf16 v[92:107], a[0:3], v[20:23], 0
  s_add_u32 s56, s56, 9216
  s_cmp_eq_u32 s56, 36864
  s_cselect_b32 s56, 0, s56
  v_mfma_f32_32x32x16_bf16 v[108:123], a[144:147], v[20:23], 0
  v_add_u32 v9, s56, v5
  ds_read_b128 v[20:23], v15 offset:1024
  s_waitcnt lgkmcnt(5)
  v_mfma_f32_32x32x16_bf16 v[92:107], a[4:7], v[24:27], v[92:107]
  v_add_u32 v10, s56, v6
  v_mfma_f32_32x32x16_bf16 v[108:123], a[148:151], v[24:27], v[108:123]
  v_add_u32 v11, s56, v7
  ds_read_b128 v[24:27], v16 offset:1024
  s_waitcnt lgkmcnt(5)
  v_mfma_f32_32x32x16_bf16 v[92:107], a[8:11], v[28:31], v[92:107]
  v_add_u32 v12, s56, v8
  v_mfma_f32_32x32x16_bf16 v[108:123], a[152:155], v[28:31], v[108:123]
  v_mul_f32 v60, s70, v60
  v_mul_f32 v61, s70, v61
  ds_read_b128 v[28:31], v13 offset:2048
  s_waitcnt lgkmcnt(5)
  v_mfma_f32_32x32x16_bf16 v[92:107], a[12:15], v[32:35], v[92:107]
  v_mul_f32 v62, s70, v62
  v_mul_f32 v63, s70, v63
  v_mfma_f32_32x32x16_bf16 v[108:123], a[156:159], v[32:35], v[108:123]
  v_mul_f32 v64, s70, v64
  v_mul_f32 v65, s70, v65
  ds_read_b128 v[32:35], v14 offset:2048
  s_waitcnt lgkmcnt(5)
  v_mfma_f32_32x32x16_bf16 v[92:107], a[16:19], v[36:39], v[92:107]
  v_mul_f32 v66, s70, v66
  v_mul_f32 v67, s70, v67
  v_mfma_f32_32x32x16_bf16 v[108:123], a[160:163], v[36:39], v[108:123]
  v_mul_f32 v68, s70, v68
  v_mul_f32 v69, s70, v69
  ds_read_b128 v[36:39], v15 offset:2048
  s_waitcnt lgkmcnt(5)
  v_mfma_f32_32x32x16_bf16 v[92:107], a[20:23], v[40:43], v[92:107]
  v_cvt_pk_bf16_f32 v44, v60, v61
  v_mfma_f32_32x32x16_bf16 v[108:123], a[164:167], v[40:43], v[108:123]
  v_cvt_pk_bf16_f32 v45, v62, v63
  ds_read_b128 v[40:43], v16 offset:2048
  s_waitcnt lgkmcnt(5)
  v_mfma_f32_32x32x16_bf16 v[92:107], a[24:27], v[20:23], v[92:107]
  v_cvt_pk_bf16_f32 v46, v64, v65
  v_mfma_f32_32x32x16_bf16 v[108:123], a[168:171], v[20:23], v[108:123]
  v_cvt_pk_bf16_f32 v47, v66, v67
  ds_read_b128 v[20:23], v13 offset:3072
  s_waitcnt lgkmcnt(5)
  v_mfma_f32_32x32x16_bf16 v[92:107], a[28:31], v[24:27], v[92:107]
  v_cvt_pk_bf16_f32 v48, v68, v69
  v_mfma_f32_32x32x16_bf16 v[108:123], a[172:175], v[24:27], v[108:123]
  buffer_store_dwordx4 v[44:47], v17, s[44:47], s51 offen offset:0 sc1
  ds_read_b128 v[24:27], v14 offset:3072
  s_waitcnt lgkmcnt(5)
  v_mfma_f32_32x32x16_bf16 v[92:107], a[32:35], v[28:31], v[92:107]
  s_mov_b64 exec, 0xffffffff
  buffer_store_dword v48, v158, s[44:47], s51 offen offset:1024 sc1
  s_mov_b64 exec, -1
  v_mfma_f32_32x32x16_bf16 v[108:123], a[176:179], v[28:31], v[108:123]
  v_cvt_pk_bf16_f32 v52, v76, v77
  ds_read_b128 v[28:31], v15 offset:3072
  s_waitcnt lgkmcnt(5)
  v_mfma_f32_32x32x16_bf16 v[92:107], a[36:39], v[32:35], v[92:107]
  v_cvt_pk_bf16_f32 v53, v78, v79
  v_mfma_f32_32x32x16_bf16 v[108:123], a[180:183], v[32:35], v[108:123]
  v_cvt_pk_bf16_f32 v54, v80, v81
  ds_read_b128 v[32:35], v16 offset:3072
  s_waitcnt lgkmcnt(5)
  v_mfma_f32_32x32x16_bf16 v[92:107], a[40:43], v[36:39], v[92:107]
  v_cvt_pk_bf16_f32 v55, v82, v83
  v_mfma_f32_32x32x16_bf16 v[108:123], a[184:187], v[36:39], v[108:123]
  v_cvt_pk_bf16_f32 v56, v84, v85
  ds_read_b128 v[36:39], v13 offset:4096
  s_waitcnt lgkmcnt(5)
  v_mfma_f32_32x32x16_bf16 v[92:107], a[44:47], v[40:43], v[92:107]
  v_mov_b32 v57, 0x3f803f80
  v_mfma_f32_32x32x16_bf16 v[108:123], a[188:191], v[40:43], v[108:123]
  buffer_store_dwordx4 v[52:55], v18, s[44:47], s52 offen offset:0 sc1
  ds_read_b128 v[40:43], v14 offset:4096
  s_waitcnt lgkmcnt(5)
  v_mfma_f32_32x32x16_bf16 v[92:107], a[48:51], v[20:23], v[92:107]
  s_mov_b64 exec, 0xffffffff
  buffer_store_dwordx2 v[56:57], v157, s[44:47], s52 offen offset:1024 sc1
  s_mov_b64 exec, -1
  v_mfma_f32_32x32x16_bf16 v[108:123], a[192:195], v[20:23], v[108:123]
  ds_read_b128 v[20:23], v15 offset:4096
  s_waitcnt lgkmcnt(5)
  v_mfma_f32_32x32x16_bf16 v[92:107], a[52:55], v[24:27], v[92:107]
  v_mfma_f32_32x32x16_bf16 v[108:123], a[196:199], v[24:27], v[108:123]
  ds_read_b128 v[24:27], v16 offset:4096
  s_waitcnt lgkmcnt(5)
  v_mfma_f32_32x32x16_bf16 v[92:107], a[56:59], v[28:31], v[92:107]
  v_mfma_f32_32x32x16_bf16 v[108:123], a[200:203], v[28:31], v[108:123]
  ds_read_b128 v[28:31], v13 offset:5120
  s_waitcnt lgkmcnt(5)
  v_mfma_f32_32x32x16_bf16 v[92:107], a[60:63], v[32:35], v[92:107]
  v_mfma_f32_32x32x16_bf16 v[108:123], a[204:207], v[32:35], v[108:123]
  ds_read_b128 v[32:35], v14 offset:5120
  s_waitcnt lgkmcnt(5)
  v_mfma_f32_32x32x16_bf16 v[92:107], a[64:67], v[36:39], v[92:107]
  v_mfma_f32_32x32x16_bf16 v[108:123], a[208:211], v[36:39], v[108:123]
  ds_read_b128 v[36:39], v15 offset:5120
  s_waitcnt lgkmcnt(5)
  v_mfma_f32_32x32x16_bf16 v[92:107], a[68:71], v[40:43], v[92:107]
  v_mfma_f32_32x32x16_bf16 v[108:123], a[212:215], v[40:43], v[108:123]
  ds_read_b128 v[40:43], v16 offset:5120
  s_waitcnt lgkmcnt(5)
  v_mfma_f32_32x32x16_bf16 v[92:107], a[72:75], v[20:23], v[92:107]
  v_mfma_f32_32x32x16_bf16 v[108:123], a[216:219], v[20:23], v[108:123]
  ds_read_b128 v[20:23], v13 offset:6144
  s_waitcnt lgkmcnt(5)
  v_mfma_f32_32x32x16_bf16 v[92:107], a[76:79], v[24:27], v[92:107]
  v_mfma_f32_32x32x16_bf16 v[108:123], a[220:223], v[24:27], v[108:123]
  ds_read_b128 v[24:27], v14 offset:6144
  s_waitcnt lgkmcnt(5)
  v_mfma_f32_32x32x16_bf16 v[92:107], a[80:83], v[28:31], v[92:107]
  v_mfma_f32_32x32x16_bf16 v[108:123], a[224:227], v[28:31], v[108:123]
  ds_read_b128 v[28:31], v15 offset:6144
  s_waitcnt lgkmcnt(5)
  v_mfma_f32_32x32x16_bf16 v[92:107], a[84:87], v[32:35], v[92:107]
  v_mfma_f32_32x32x16_bf16 v[108:123], a[228:231], v[32:35], v[108:123]
  ds_read_b128 v[32:35], v16 offset:6144
  s_waitcnt lgkmcnt(5)
  v_mfma_f32_32x32x16_bf16 v[92:107], a[88:91], v[36:39], v[92:107]
  s_mov_b32 s51, s61
  s_mov_b32 s52, s62
  s_add_u32 s61, s61, s53
  s_add_u32 s62, s62, s71
  v_mfma_f32_32x32x16_bf16 v[108:123], a[232:235], v[36:39], v[108:123]
  s_waitcnt vmcnt(17)
  s_barrier
  ds_read_b128 v[36:39], v13 offset:7168
  s_waitcnt lgkmcnt(5)
  v_mfma_f32_32x32x16_bf16 v[92:107], a[92:95], v[40:43], v[92:107]
  v_mfma_f32_32x32x16_bf16 v[108:123], a[236:239], v[40:43], v[108:123]
  s_add_u32 m0, s55, 0
  ds_read_b128 v[40:43], v14 offset:7168
  s_waitcnt lgkmcnt(5)
  v_mfma_f32_32x32x16_bf16 v[92:107], a[96:99], v[20:23], v[92:107]
  buffer_load_dwordx4 v2, s[32:35], s48 offen offset:0 lds
  v_mfma_f32_32x32x16_bf16 v[108:123], a[240:243], v[20:23], v[108:123]
  s_add_u32 m0, s55, 896
  ds_read_b128 v[20:23], v15 offset:7168
  s_waitcnt lgkmcnt(5)
  v_mfma_f32_32x32x16_bf16 v[92:107], a[100:103], v[24:27], v[92:107]
  buffer_load_dwordx4 v2, s[32:35], s48 offen offset:128 lds
  v_mfma_f32_32x32x16_bf16 v[108:123], a[244:247], v[24:27], v[108:123]
  s_add_u32 m0, s55, 1792
  ds_read_b128 v[24:27], v16 offset:7168
  s_waitcnt lgkmcnt(5)
  v_mfma_f32_32x32x16_bf16 v[92:107], a[104:107], v[28:31], v[92:107]
  buffer_load_dwordx4 v2, s[32:35], s48 offen offset:256 lds
  v_mfma_f32_32x32x16_bf16 v[108:123], a[248:251], v[28:31], v[108:123]
  s_add_u32 m0, s55, 2688
  ds_read_b128 v[28:31], v13 offset:8192
  s_waitcnt lgkmcnt(5)
  v_mfma_f32_32x32x16_bf16 v[92:107], a[108:111], v[32:35], v[92:107]
  buffer_load_dwordx4 v2, s[32:35], s48 offen offset:384 lds
  v_mfma_f32_32x32x16_bf16 v[108:123], a[252:255], v[32:35], v[108:123]
  s_add_u32 m0, s55, 3584
  ds_read_b128 v[32:35], v14 offset:8192
  s_waitcnt lgkmcnt(5)
  v_mfma_f32_32x32x16_bf16 v[92:107], a[112:115], v[36:39], v[92:107]
  buffer_load_dwordx4 v2, s[32:35], s48 offen offset:512 lds
  v_mfma_f32_32x32x16_bf16 v[108:123], v[124:127], v[36:39], v[108:123]
  s_add_u32 m0, s55, 4480
  ds_read_b128 v[36:39], v15 offset:8192
  s_waitcnt lgkmcnt(5)
  v_mfma_f32_32x32x16_bf16 v[92:107], a[116:119], v[40:43], v[92:107]
  buffer_load_dwordx4 v2, s[32:35], s48 offen offset:640 lds
  v_mfma_f32_32x32x16_bf16 v[108:123], v[128:131], v[40:43], v[108:123]
  s_add_u32 m0, s55, 5376
  ds_read_b128 v[40:43], v16 offset:8192
  s_waitcnt lgkmcnt(5)
  v_mfma_f32_32x32x16_bf16 v[92:107], a[120:123], v[20:23], v[92:107]
  buffer_load_dwordx4 v2, s[32:35], s48 offen offset:768 lds
  v_mfma_f32_32x32x16_bf16 v[108:123], v[132:135], v[20:23], v[108:123]
  s_add_u32 m0, s55, 6272
  ds_read_b128 v[20:23], v9 offset:0
  s_waitcnt lgkmcnt(5)
  v_mfma_f32_32x32x16_bf16 v[92:107], a[124:127], v[24:27], v[92:107]
  buffer_load_dwordx4 v2, s[32:35], s48 offen offset:896 lds
  v_mfma_f32_32x32x16_bf16 v[108:123], v[136:139], v[24:27], v[108:123]
  s_add_u32 m0, s55, 7168
  ds_read_b128 v[24:27], v10 offset:0
  s_waitcnt lgkmcnt(5)
  v_mfma_f32_32x32x16_bf16 v[92:107], a[128:131], v[28:31], v[92:107]
  buffer_load_dwordx4 v2, s[32:35], s48 offen offset:1024 lds
  v_mfma_f32_32x32x16_bf16 v[108:123], v[140:143], v[28:31], v[108:123]
  ds_read_b128 v[28:31], v11 offset:0
  s_waitcnt lgkmcnt(5)
  v_mfma_f32_32x32x16_bf16 v[92:107], a[132:135], v[32:35], v[92:107]
  s_add_u32 s48, s48, s49
  s_sub_u32 s64, s64, 1
  s_cmp_gt_i32 s64, 0
  s_cselect_b32 s48, s48, 1073741824
  s_add_u32 s65, s65, 9216
  s_cmp_eq_u32 s65, 36864
  s_cselect_b32 s65, 0, s65
  s_add_u32 s55, s54, s65
  v_mfma_f32_32x32x16_bf16 v[108:123], v[144:147], v[32:35], v[108:123]
  ds_read_b128 v[32:35], v12 offset:0
  s_waitcnt lgkmcnt(5)
  v_mfma_f32_32x32x16_bf16 v[92:107], a[136:139], v[36:39], v[92:107]
  v_mfma_f32_32x32x16_bf16 v[108:123], v[148:151], v[36:39], v[108:123]
  ds_read_b128 v[36:39], v9 offset:1024
  s_waitcnt lgkmcnt(5)
  v_mfma_f32_32x32x16_bf16 v[92:107], a[140:143], v[40:43], v[92:107]
  v_mfma_f32_32x32x16_bf16 v[108:123], v[152:155], v[40:43], v[108:123]
  s_sub_u32 s50, s50, 1
  s_cmp_lg_u32 s50, 0
  s_cbranch_scc1 .Lconcat_heads__mha_block__memory_aug_recurrent_mem_tr__prompt_kernelaqk_loop
.Lconcat_heads__mha_block__memory_aug_recurrent_mem_tr__prompt_kernelaqk_tail1:
  s_nop 7
  s_nop 7
  v_mul_f32 v92, s70, v92
  v_mul_f32 v93, s70, v93
  v_mul_f32 v94, s70, v94
  v_mul_f32 v95, s70, v95
  v_mul_f32 v96, s70, v96
  v_mul_f32 v97, s70, v97
  v_mul_f32 v98, s70, v98
  v_mul_f32 v99, s70, v99
  v_mul_f32 v100, s70, v100
  v_mul_f32 v101, s70, v101
  v_cvt_pk_bf16_f32 v44, v92, v93
  v_cvt_pk_bf16_f32 v45, v94, v95
  v_cvt_pk_bf16_f32 v46, v96, v97
  v_cvt_pk_bf16_f32 v47, v98, v99
  v_cvt_pk_bf16_f32 v48, v100, v101
  buffer_store_dwordx4 v[44:47], v17, s[44:47], s51 offen offset:0 sc1
  s_mov_b64 exec, 0xffffffff
  buffer_store_dword v48, v158, s[44:47], s51 offen offset:1024 sc1
  s_mov_b64 exec, -1
  v_cvt_pk_bf16_f32 v52, v108, v109
  v_cvt_pk_bf16_f32 v53, v110, v111
  v_cvt_pk_bf16_f32 v54, v112, v113
  v_cvt_pk_bf16_f32 v55, v114, v115
  v_cvt_pk_bf16_f32 v56, v116, v117
  v_mov_b32 v57, 0x3f803f80
  buffer_store_dwordx4 v[52:55], v18, s[44:47], s52 offen offset:0 sc1
  s_mov_b64 exec, 0xffffffff
  buffer_store_dwordx2 v[56:57], v157, s[44:47], s52 offen offset:1024 sc1
  s_mov_b64 exec, -1
  s_branch .Lconcat_heads__mha_block__memory_aug_recurrent_mem_tr__prompt_kernelaqk_done
.Lconcat_heads__mha_block__memory_aug_recurrent_mem_tr__prompt_kernelaqk_tail0:
  s_nop 7
  s_nop 7
  v_mul_f32 v60, s70, v60
  v_mul_f32 v61, s70, v61
  v_mul_f32 v62, s70, v62
  v_mul_f32 v63, s70, v63
  v_mul_f32 v64, s70, v64
  v_mul_f32 v65, s70, v65
  v_mul_f32 v66, s70, v66
  v_mul_f32 v67, s70, v67
  v_mul_f32 v68, s70, v68
  v_mul_f32 v69, s70, v69
  v_cvt_pk_bf16_f32 v44, v60, v61
  v_cvt_pk_bf16_f32 v45, v62, v63
  v_cvt_pk_bf16_f32 v46, v64, v65
  v_cvt_pk_bf16_f32 v47, v66, v67
  v_cvt_pk_bf16_f32 v48, v68, v69
  buffer_store_dwordx4 v[44:47], v17, s[44:47], s51 offen offset:0 sc1
  s_mov_b64 exec, 0xffffffff
  buffer_store_dword v48, v158, s[44:47], s51 offen offset:1024 sc1
  s_mov_b64 exec, -1
  v_cvt_pk_bf16_f32 v52, v76, v77
  v_cvt_pk_bf16_f32 v53, v78, v79
  v_cvt_pk_bf16_f32 v54, v80, v81
  v_cvt_pk_bf16_f32 v55, v82, v83
  v_cvt_pk_bf16_f32 v56, v84, v85
  v_mov_b32 v57, 0x3f803f80
  buffer_store_dwordx4 v[52:55], v18, s[44:47], s52 offen offset:0 sc1
  s_mov_b64 exec, 0xffffffff
  buffer_store_dwordx2 v[56:57], v157, s[44:47], s52 offen offset:1024 sc1
  s_mov_b64 exec, -1
.Lconcat_heads__mha_block__memory_aug_recurrent_mem_tr__prompt_kernelaqk_done:
  s_waitcnt vmcnt(0) lgkmcnt(0)
  s_barrier
  s_branch .Lconcat_heads__mha_block__memory_aug_recurrent_mem_tr__prompt_kernel_apf
.Lconcat_heads__mha_block__memory_aug_recurrent_mem_tr__prompt_kernel_avv:
  s_cmp_ge_u32 s91, 96
  s_cbranch_scc1 .Lconcat_heads__mha_block__memory_aug_recurrent_mem_tr__prompt_kernel_apx
  s_sub_u32 s29, s91, 64
  s_mov_b32 s32, s4
  s_mov_b32 s33, s5
  s_mov_b32 s34, 2359296
  s_mov_b32 s35, 0x00020000
  s_mov_b32 s36, s6
  s_mov_b32 s37, s7
  s_mov_b32 s38, 1990656
  s_mov_b32 s39, 0x00020000
  s_mov_b32 s40, s6
  s_mov_b32 s41, s7
  s_mov_b32 s42, 1990656
  s_mov_b32 s43, 0x00020000
  s_mov_b32 s44, s26
  s_mov_b32 s45, s27
  s_mov_b32 s46, 268435456
  s_mov_b32 s47, 0x00020000
  s_and_b32 s60, s29, 3
  s_lshl_b32 s60, s60, 3
  s_lshl_b32 s62, s28, 1
  s_add_u32 s60, s60, s62
  s_lshr_b32 s61, s29, 2
  s_mov_b32 s59, 3456
  s_mul_i32 s57, s60, 36
  s_add_u32 s57, s57, 2304
  s_add_u32 s58, s57, 36
  s_mul_i32 s48, s61, 36864
  s_mov_b32 s49, 294912
  s_mov_b32 s50, 8
  s_lshl_b32 s62, s60, 6
  s_add_u32 s62, s62, s61
  s_mul_i32 s51, s62, 2496
  s_add_u32 s51, s51, 92274688
  s_add_u32 s52, s51, 159744
  s_mov_b32 s53, 19968
  s_mov_b32 s71, s53
  s_mul_i32 s54, s28, 36864
  v_lshrrev_b32 v19, 3, v1
  s_lshl_b32 s60, s28, 3
  v_add_u32 v19, s60, v19
  v_lshrrev_b32 v2, 1, v19
  v_and_b32 v2, 7, v2
  v_and_b32 v3, 7, v1
  v_xor_b32 v2, v2, v3
  v_lshlrev_b32 v2, 4, v2
  v_mul_u32_u24 v19, 1152, v19
  v_add_u32 v2, v2, v19
  v_lshrrev_b32 v19, 2, v1
  v_mul_lo_u32 v19, v19, s59
  v_and_b32 v3, 3, v1
  v_lshlrev_b32 v3, 4, v3
  v_add_u32 v3, v3, v19
  v_lshrrev_b32 v19, 5, v1
  v_lshlrev_b32 v4, 9, v19
  v_bfe_u32 v5, v1, 2, 2
  v_lshlrev_b32 v5, 6, v5
  v_add_u32 v4, v4, v5
  v_bfe_u32 v5, v1, 4, 1
  v_lshlrev_b32 v5, 5, v5
  v_add_u32 v4, v4, v5
  v_and_b32 v5, 3, v1
  v_lshlrev_b32 v5, 3, v5
  v_add_u32 v4, v4, v5
  v_add_u32 v4, s54, v4
  v_and_b32 v9, 31, v1
  v_lshrrev_b32 v10, 3, v9
  v_mul_u32_u24 v10, 36864, v10
  v_and_b32 v11, 7, v9
  v_lshlrev_b32 v11, 7, v11
  v_add_u32 v10, v10, v11
  v_lshrrev_b32 v11, 1, v9
  v_and_b32 v11, 7, v11
  v_add_u32 v12, 0, v19
  v_xor_b32 v12, v12, v11
  v_lshlrev_b32 v12, 4, v12
  v_add_u32 v5, v10, v12
  v_add_u32 v12, 2, v19
  v_xor_b32 v12, v12, v11
  v_lshlrev_b32 v12, 4, v12
  v_add_u32 v6, v10, v12
  v_add_u32 v12, 4, v19
  v_xor_b32 v12, v12, v11
  v_lshlrev_b32 v12, 4, v12
  v_add_u32 v7, v10, v12
  v_add_u32 v12, 6, v19
  v_xor_b32 v12, v12, v11
  v_lshlrev_b32 v12, 4, v12
  v_add_u32 v8, v10, v12
  v_and_b32 v19, 31, v1
  v_lshlrev_b32 v17, 4, v19
  v_lshrrev_b32 v19, 5, v1
  v_mul_u32_u24 v19, 304, v19
  v_add_u32 v17, v17, v19
  v_and_b32 v19, 31, v1
  v_lshlrev_b32 v18, 4, v19
  v_lshrrev_b32 v19, 5, v1
  v_mul_u32_u24 v19, 304, v19
  v_add_u32 v18, v18, v19
  v_and_b32 v19, 31, v1
  v_cmp_eq_u32 s[66:67], 18, v19
  s_mov_b32 s68, 0x0007ffff
  s_mov_b32 s69, 0x0007ffff
  v_mov_b32 v156, 0x3f803f80
  s_mov_b32 s64, s50
  s_mov_b32 s65, 0
  s_mov_b32 s55, s54
  s_mul_i32 s63, s59, 16
  s_mul_i32 s62, s59, 0
  s_add_u32 s62, s62, s57
  s_add_u32 m0, s54, 0
  s_nop 0
  buffer_load_dwordx4 v3, s[36:39], s62 offen lds
  s_add_u32 m0, s54, 1024
  s_add_u32 s62, s62, s63
  buffer_load_dwordx4 v3, s[36:39], s62 offen lds
  s_add_u32 m0, s54, 2048
  s_add_u32 s62, s62, s63
  buffer_load_dwordx4 v3, s[36:39], s62 offen lds
  s_add_u32 m0, s54, 3072
  s_add_u32 s62, s62, s63
  buffer_load_dwordx4 v3, s[36:39], s62 offen lds
  s_add_u32 m0, s54, 4096
  s_add_u32 s62, s62, s63
  buffer_load_dwordx4 v3, s[36:39], s62 offen lds
  s_add_u32 m0, s54, 5120
  s_add_u32 s62, s62, s63
  buffer_load_dwordx4 v3, s[36:39], s62 offen lds
  s_add_u32 m0, s54, 6144
  s_add_u32 s62, s62, s63
  buffer_load_dwordx4 v3, s[36:39], s62 offen lds
  s_add_u32 m0, s54, 7168
  s_add_u32 s62, s62, s63
  buffer_load_dwordx4 v3, s[36:39], s62 offen lds
  s_add_u32 m0, s54, 8192
  s_add_u32 s62, s62, s63
  buffer_load_dwordx4 v3, s[36:39], s62 offen lds
  s_mul_i32 s62, s59, 144
  s_add_u32 s62, s62, s57
  s_add_u32 m0, s54, 9216
  s_nop 0
  buffer_load_dwordx4 v3, s[36:39], s62 offen lds
  s_add_u32 m0, s54, 10240
  s_add_u32 s62, s62, s63
  buffer_load_dwordx4 v3, s[36:39], s62 offen lds
  s_add_u32 m0, s54, 11264
  s_add_u32 s62, s62, s63
  buffer_load_dwordx4 v3, s[36:39], s62 offen lds
  s_add_u32 m0, s54, 12288
  s_add_u32 s62, s62, s63
  buffer_load_dwordx4 v3, s[36:39], s62 offen lds
  s_add_u32 m0, s54, 13312
  s_add_u32 s62, s62, s63
  buffer_load_dwordx4 v3, s[36:39], s62 offen lds
  s_add_u32 m0, s54, 14336
  s_add_u32 s62, s62, s63
  buffer_load_dwordx4 v3, s[36:39], s62 offen lds
  s_add_u32 m0, s54, 15360
  s_add_u32 s62, s62, s63
  buffer_load_dwordx4 v3, s[36:39], s62 offen lds
  s_add_u32 m0, s54, 16384
  s_add_u32 s62, s62, s63
  buffer_load_dwordx4 v3, s[36:39], s62 offen lds
  s_add_u32 m0, s54, 17408
  s_add_u32 s62, s62, s63
  buffer_load_dwordx4 v3, s[36:39], s62 offen lds
  s_mul_i32 s62, s59, 288
  s_add_u32 s62, s62, s57
  s_add_u32 m0, s54, 18432
  s_nop 0
  buffer_load_dwordx4 v3, s[36:39], s62 offen lds
  s_add_u32 m0, s54, 19456
  s_add_u32 s62, s62, s63
  buffer_load_dwordx4 v3, s[36:39], s62 offen lds
  s_add_u32 m0, s54, 20480
  s_add_u32 s62, s62, s63
  buffer_load_dwordx4 v3, s[36:39], s62 offen lds
  s_add_u32 m0, s54, 21504
  s_add_u32 s62, s62, s63
  buffer_load_dwordx4 v3, s[36:39], s62 offen lds
  s_add_u32 m0, s54, 22528
  s_add_u32 s62, s62, s63
  buffer_load_dwordx4 v3, s[36:39], s62 offen lds
  s_add_u32 m0, s54, 23552
  s_add_u32 s62, s62, s63
  buffer_load_dwordx4 v3, s[36:39], s62 offen lds
  s_add_u32 m0, s54, 24576
  s_add_u32 s62, s62, s63
  buffer_load_dwordx4 v3, s[36:39], s62 offen lds
  s_add_u32 m0, s54, 25600
  s_add_u32 s62, s62, s63
  buffer_load_dwordx4 v3, s[36:39], s62 offen lds
  s_add_u32 m0, s54, 26624
  s_add_u32 s62, s62, s63
  buffer_load_dwordx4 v3, s[36:39], s62 offen lds
  s_mul_i32 s62, s59, 432
  s_add_u32 s62, s62, s57
  s_add_u32 m0, s54, 27648
  s_nop 0
  buffer_load_dwordx4 v3, s[36:39], s62 offen lds
  s_add_u32 m0, s54, 28672
  s_add_u32 s62, s62, s63
  buffer_load_dwordx4 v3, s[36:39], s62 offen lds
  s_add_u32 m0, s54, 29696
  s_add_u32 s62, s62, s63
  buffer_load_dwordx4 v3, s[36:39], s62 offen lds
  s_add_u32 m0, s54, 30720
  s_add_u32 s62, s62, s63
  buffer_load_dwordx4 v3, s[36:39], s62 offen lds
  s_add_u32 m0, s54, 31744
  s_add_u32 s62, s62, s63
  buffer_load_dwordx4 v3, s[36:39], s62 offen lds
  s_add_u32 m0, s54, 32768
  s_add_u32 s62, s62, s63
  buffer_load_dwordx4 v3, s[36:39], s62 offen lds
  s_add_u32 m0, s54, 33792
  s_add_u32 s62, s62, s63
  buffer_load_dwordx4 v3, s[36:39], s62 offen lds
  s_add_u32 m0, s54, 34816
  s_add_u32 s62, s62, s63
  buffer_load_dwordx4 v3, s[36:39], s62 offen lds
  s_add_u32 m0, s54, 35840
  s_add_u32 s62, s62, s63
  buffer_load_dwordx4 v3, s[36:39], s62 offen lds
  s_waitcnt vmcnt(27)
  ds_read_b64_tr_b16 a[0:1], v4 offset:0
  ds_read_b64_tr_b16 a[2:3], v4 offset:256
  ds_read_b64_tr_b16 a[4:5], v4 offset:1024
  ds_read_b64_tr_b16 a[6:7], v4 offset:1280
  ds_read_b64_tr_b16 a[8:9], v4 offset:2048
  ds_read_b64_tr_b16 a[10:11], v4 offset:2304
  ds_read_b64_tr_b16 a[12:13], v4 offset:3072
  ds_read_b64_tr_b16 a[14:15], v4 offset:3328
  ds_read_b64_tr_b16 a[16:17], v4 offset:4096
  ds_read_b64_tr_b16 a[18:19], v4 offset:4352
  ds_read_b64_tr_b16 a[20:21], v4 offset:5120
  ds_read_b64_tr_b16 a[22:23], v4 offset:5376
  ds_read_b64_tr_b16 a[24:25], v4 offset:6144
  ds_read_b64_tr_b16 a[26:27], v4 offset:6400
  ds_read_b64_tr_b16 a[28:29], v4 offset:7168
  ds_read_b64_tr_b16 a[30:31], v4 offset:7424
  ds_read_b64_tr_b16 a[32:33], v4 offset:8192
  ds_read_b64_tr_b16 a[34:35], v4 offset:8448
  s_waitcnt lgkmcnt(0)
  s_mul_i32 s62, s59, 0
  s_add_u32 s62, s62, s58
  s_add_u32 m0, s54, 0
  s_nop 0
  buffer_load_dwordx4 v3, s[40:43], s62 offen lds
  s_add_u32 m0, s54, 1024
  s_add_u32 s62, s62, s63
  buffer_load_dwordx4 v3, s[40:43], s62 offen lds
  s_add_u32 m0, s54, 2048
  s_add_u32 s62, s62, s63
  buffer_load_dwordx4 v3, s[40:43], s62 offen lds
  s_add_u32 m0, s54, 3072
  s_add_u32 s62, s62, s63
  buffer_load_dwordx4 v3, s[40:43], s62 offen lds
  s_add_u32 m0, s54, 4096
  s_add_u32 s62, s62, s63
  buffer_load_dwordx4 v3, s[40:43], s62 offen lds
  s_add_u32 m0, s54, 5120
  s_add_u32 s62, s62, s63
  buffer_load_dwordx4 v3, s[40:43], s62 offen lds
  s_add_u32 m0, s54, 6144
  s_add_u32 s62, s62, s63
  buffer_load_dwordx4 v3, s[40:43], s62 offen lds
  s_add_u32 m0, s54, 7168
  s_add_u32 s62, s62, s63
  buffer_load_dwordx4 v3, s[40:43], s62 offen lds
  s_add_u32 m0, s54, 8192
  s_add_u32 s62, s62, s63
  buffer_load_dwordx4 v3, s[40:43], s62 offen lds
  s_waitcnt vmcnt(27)
  ds_read_b64_tr_b16 a[36:37], v4 offset:9216
  ds_read_b64_tr_b16 a[38:39], v4 offset:9472
  ds_read_b64_tr_b16 a[40:41], v4 offset:10240
  ds_read_b64_tr_b16 a[42:43], v4 offset:10496
  ds_read_b64_tr_b16 a[44:45], v4 offset:11264
  ds_read_b64_tr_b16 a[46:47], v4 offset:11520
  ds_read_b64_tr_b16 a[48:49], v4 offset:12288
  ds_read_b64_tr_b16 a[50:51], v4 offset:12544
  ds_read_b64_tr_b16 a[52:53], v4 offset:13312
  ds_read_b64_tr_b16 a[54:55], v4 offset:13568
  ds_read_b64_tr_b16 a[56:57], v4 offset:14336
  ds_read_b64_tr_b16 a[58:59], v4 offset:14592
  ds_read_b64_tr_b16 a[60:61], v4 offset:15360
  ds_read_b64_tr_b16 a[62:63], v4 offset:15616
  ds_read_b64_tr_b16 a[64:65], v4 offset:16384
  ds_read_b64_tr_b16 a[66:67], v4 offset:16640
  ds_read_b64_tr_b16 a[68:69], v4 offset:17408
  ds_read_b64_tr_b16 a[70:71], v4 offset:17664
  s_waitcnt lgkmcnt(0)
  s_mul_i32 s62, s59, 144
  s_add_u32 s62, s62, s58
  s_add_u32 m0, s54, 9216
  s_nop 0
  buffer_load_dwordx4 v3, s[40:43], s62 offen lds
  s_add_u32 m0, s54, 10240
  s_add_u32 s62, s62, s63
  buffer_load_dwordx4 v3, s[40:43], s62 offen lds
  s_add_u32 m0, s54, 11264
  s_add_u32 s62, s62, s63
  buffer_load_dwordx4 v3, s[40:43], s62 offen lds
  s_add_u32 m0, s54, 12288
  s_add_u32 s62, s62, s63
  buffer_load_dwordx4 v3, s[40:43], s62 offen lds
  s_add_u32 m0, s54, 13312
  s_add_u32 s62, s62, s63
  buffer_load_dwordx4 v3, s[40:43], s62 offen lds
  s_add_u32 m0, s54, 14336
  s_add_u32 s62, s62, s63
  buffer_load_dwordx4 v3, s[40:43], s62 offen lds
  s_add_u32 m0, s54, 15360
  s_add_u32 s62, s62, s63
  buffer_load_dwordx4 v3, s[40:43], s62 offen lds
  s_add_u32 m0, s54, 16384
  s_add_u32 s62, s62, s63
  buffer_load_dwordx4 v3, s[40:43], s62 offen lds
  s_add_u32 m0, s54, 17408
  s_add_u32 s62, s62, s63
  buffer_load_dwordx4 v3, s[40:43], s62 offen lds
  s_waitcnt vmcnt(27)
  ds_read_b64_tr_b16 a[72:73], v4 offset:18432
  ds_read_b64_tr_b16 a[74:75], v4 offset:18688
  ds_read_b64_tr_b16 a[76:77], v4 offset:19456
  ds_read_b64_tr_b16 a[78:79], v4 offset:19712
  ds_read_b64_tr_b16 a[80:81], v4 offset:20480
  ds_read_b64_tr_b16 a[82:83], v4 offset:20736
  ds_read_b64_tr_b16 a[84:85], v4 offset:21504
  ds_read_b64_tr_b16 a[86:87], v4 offset:21760
  ds_read_b64_tr_b16 a[88:89], v4 offset:22528
  ds_read_b64_tr_b16 a[90:91], v4 offset:22784
  ds_read_b64_tr_b16 a[92:93], v4 offset:23552
  ds_read_b64_tr_b16 a[94:95], v4 offset:23808
  ds_read_b64_tr_b16 a[96:97], v4 offset:24576
  ds_read_b64_tr_b16 a[98:99], v4 offset:24832
  ds_read_b64_tr_b16 a[100:101], v4 offset:25600
  ds_read_b64_tr_b16 a[102:103], v4 offset:25856
  ds_read_b64_tr_b16 a[104:105], v4 offset:26624
  ds_read_b64_tr_b16 a[106:107], v4 offset:26880
  s_waitcnt lgkmcnt(0)
  s_mul_i32 s62, s59, 288
  s_add_u32 s62, s62, s58
  s_add_u32 m0, s54, 18432
  s_nop 0
  buffer_load_dwordx4 v3, s[40:43], s62 offen lds
  s_add_u32 m0, s54, 19456
  s_add_u32 s62, s62, s63
  buffer_load_dwordx4 v3, s[40:43], s62 offen lds
  s_add_u32 m0, s54, 20480
  s_add_u32 s62, s62, s63
  buffer_load_dwordx4 v3, s[40:43], s62 offen lds
  s_add_u32 m0, s54, 21504
  s_add_u32 s62, s62, s63
  buffer_load_dwordx4 v3, s[40:43], s62 offen lds
  s_add_u32 m0, s54, 22528
  s_add_u32 s62, s62, s63
  buffer_load_dwordx4 v3, s[40:43], s62 offen lds
  s_add_u32 m0, s54, 23552
  s_add_u32 s62, s62, s63
  buffer_load_dwordx4 v3, s[40:43], s62 offen lds
  s_add_u32 m0, s54, 24576
  s_add_u32 s62, s62, s63
  buffer_load_dwordx4 v3, s[40:43], s62 offen lds
  s_add_u32 m0, s54, 25600
  s_add_u32 s62, s62, s63
  buffer_load_dwordx4 v3, s[40:43], s62 offen lds
  s_add_u32 m0, s54, 26624
  s_add_u32 s62, s62, s63
  buffer_load_dwordx4 v3, s[40:43], s62 offen lds
  s_waitcnt vmcnt(27)
  ds_read_b64_tr_b16 a[108:109], v4 offset:27648
  ds_read_b64_tr_b16 a[110:111], v4 offset:27904
  ds_read_b64_tr_b16 a[112:113], v4 offset:28672
  ds_read_b64_tr_b16 a[114:115], v4 offset:28928
  ds_read_b64_tr_b16 a[116:117], v4 offset:29696
  ds_read_b64_tr_b16 a[118:119], v4 offset:29952
  ds_read_b64_tr_b16 a[120:121], v4 offset:30720
  ds_read_b64_tr_b16 a[122:123], v4 offset:30976
  ds_read_b64_tr_b16 a[124:125], v4 offset:31744
  ds_read_b64_tr_b16 a[126:127], v4 offset:32000
  ds_read_b64_tr_b16 a[128:129], v4 offset:32768
  ds_read_b64_tr_b16 a[130:131], v4 offset:33024
  ds_read_b64_tr_b16 a[132:133], v4 offset:33792
  ds_read_b64_tr_b16 a[134:135], v4 offset:34048
  ds_read_b64_tr_b16 a[136:137], v4 offset:34816
  ds_read_b64_tr_b16 a[138:139], v4 offset:35072
  ds_read_b64_tr_b16 a[140:141], v4 offset:35840
  ds_read_b64_tr_b16 a[142:143], v4 offset:36096
  s_waitcnt lgkmcnt(0)
  s_mul_i32 s62, s59, 432
  s_add_u32 s62, s62, s58
  s_add_u32 m0, s54, 27648
  s_nop 0
  buffer_load_dwordx4 v3, s[40:43], s62 offen lds
  s_add_u32 m0, s54, 28672
  s_add_u32 s62, s62, s63
  buffer_load_dwordx4 v3, s[40:43], s62 offen lds
  s_add_u32 m0, s54, 29696
  s_add_u32 s62, s62, s63
  buffer_load_dwordx4 v3, s[40:43], s62 offen lds
  s_add_u32 m0, s54, 30720
  s_add_u32 s62, s62, s63
  buffer_load_dwordx4 v3, s[40:43], s62 offen lds
  s_add_u32 m0, s54, 31744
  s_add_u32 s62, s62, s63
  buffer_load_dwordx4 v3, s[40:43], s62 offen lds
  s_add_u32 m0, s54, 32768
  s_add_u32 s62, s62, s63
  buffer_load_dwordx4 v3, s[40:43], s62 offen lds
  s_add_u32 m0, s54, 33792
  s_add_u32 s62, s62, s63
  buffer_load_dwordx4 v3, s[40:43], s62 offen lds
  s_add_u32 m0, s54, 34816
  s_add_u32 s62, s62, s63
  buffer_load_dwordx4 v3, s[40:43], s62 offen lds
  s_add_u32 m0, s54, 35840
  s_add_u32 s62, s62, s63
  buffer_load_dwordx4 v3, s[40:43], s62 offen lds
  s_waitcnt vmcnt(27)
  ds_read_b64_tr_b16 a[144:145], v4 offset:0
  ds_read_b64_tr_b16 a[146:147], v4 offset:256
  ds_read_b64_tr_b16 a[148:149], v4 offset:1024
  ds_read_b64_tr_b16 a[150:151], v4 offset:1280
  ds_read_b64_tr_b16 a[152:153], v4 offset:2048
  ds_read_b64_tr_b16 a[154:155], v4 offset:2304
  ds_read_b64_tr_b16 a[156:157], v4 offset:3072
  ds_read_b64_tr_b16 a[158:159], v4 offset:3328
  ds_read_b64_tr_b16 a[160:161], v4 offset:4096
  ds_read_b64_tr_b16 a[162:163], v4 offset:4352
  ds_read_b64_tr_b16 a[164:165], v4 offset:5120
  ds_read_b64_tr_b16 a[166:167], v4 offset:5376
  ds_read_b64_tr_b16 a[168:169], v4 offset:6144
  ds_read_b64_tr_b16 a[170:171], v4 offset:6400
  ds_read_b64_tr_b16 a[172:173], v4 offset:7168
  ds_read_b64_tr_b16 a[174:175], v4 offset:7424
  ds_read_b64_tr_b16 a[176:177], v4 offset:8192
  ds_read_b64_tr_b16 a[178:179], v4 offset:8448
  s_waitcnt lgkmcnt(0)
  s_add_u32 m0, s55, 0
  s_nop 0
  buffer_load_dwordx4 v2, s[32:35], s48 offen offset:0 lds
  s_add_u32 m0, s55, 896
  s_nop 0
  buffer_load_dwordx4 v2, s[32:35], s48 offen offset:128 lds
  s_add_u32 m0, s55, 1792
  s_nop 0
  buffer_load_dwordx4 v2, s[32:35], s48 offen offset:256 lds
  s_add_u32 m0, s55, 2688
  s_nop 0
  buffer_load_dwordx4 v2, s[32:35], s48 offen offset:384 lds
  s_add_u32 m0, s55, 3584
  s_nop 0
  buffer_load_dwordx4 v2, s[32:35], s48 offen offset:512 lds
  s_add_u32 m0, s55, 4480
  s_nop 0
  buffer_load_dwordx4 v2, s[32:35], s48 offen offset:640 lds
  s_add_u32 m0, s55, 5376
  s_nop 0
  buffer_load_dwordx4 v2, s[32:35], s48 offen offset:768 lds
  s_add_u32 m0, s55, 6272
  s_nop 0
  buffer_load_dwordx4 v2, s[32:35], s48 offen offset:896 lds
  s_add_u32 m0, s55, 7168
  s_nop 0
  buffer_load_dwordx4 v2, s[32:35], s48 offen offset:1024 lds
  s_add_u32 s48, s48, s49
  s_sub_u32 s64, s64, 1
  s_cmp_gt_i32 s64, 0
  s_cselect_b32 s48, s48, 1073741824
  s_add_u32 s65, s65, 9216
  s_cmp_eq_u32 s65, 36864
  s_cselect_b32 s65, 0, s65
  s_add_u32 s55, s54, s65
  s_waitcnt vmcnt(27)
  ds_read_b64_tr_b16 a[180:181], v4 offset:9216
  ds_read_b64_tr_b16 a[182:183], v4 offset:9472
  ds_read_b64_tr_b16 a[184:185], v4 offset:10240
  ds_read_b64_tr_b16 a[186:187], v4 offset:10496
  ds_read_b64_tr_b16 a[188:189], v4 offset:11264
  ds_read_b64_tr_b16 a[190:191], v4 offset:11520
  ds_read_b64_tr_b16 a[192:193], v4 offset:12288
  ds_read_b64_tr_b16 a[194:195], v4 offset:12544
  ds_read_b64_tr_b16 a[196:197], v4 offset:13312
  ds_read_b64_tr_b16 a[198:199], v4 offset:13568
  ds_read_b64_tr_b16 a[200:201], v4 offset:14336
  ds_read_b64_tr_b16 a[202:203], v4 offset:14592
  ds_read_b64_tr_b16 a[204:205], v4 offset:15360
  ds_read_b64_tr_b16 a[206:207], v4 offset:15616
  ds_read_b64_tr_b16 a[208:209], v4 offset:16384
  ds_read_b64_tr_b16 a[210:211], v4 offset:16640
  ds_read_b64_tr_b16 a[212:213], v4 offset:17408
  ds_read_b64_tr_b16 a[214:215], v4 offset:17664
  s_waitcnt lgkmcnt(0)
  s_add_u32 m0, s55, 0
  s_nop 0
  buffer_load_dwordx4 v2, s[32:35], s48 offen offset:0 lds
  s_add_u32 m0, s55, 896
  s_nop 0
  buffer_load_dwordx4 v2, s[32:35], s48 offen offset:128 lds
  s_add_u32 m0, s55, 1792
  s_nop 0
  buffer_load_dwordx4 v2, s[32:35], s48 offen offset:256 lds
  s_add_u32 m0, s55, 2688
  s_nop 0
  buffer_load_dwordx4 v2, s[32:35], s48 offen offset:384 lds
  s_add_u32 m0, s55, 3584
  s_nop 0
  buffer_load_dwordx4 v2, s[32:35], s48 offen offset:512 lds
  s_add_u32 m0, s55, 4480
  s_nop 0
  buffer_load_dwordx4 v2, s[32:35], s48 offen offset:640 lds
  s_add_u32 m0, s55, 5376
  s_nop 0
  buffer_load_dwordx4 v2, s[32:35], s48 offen offset:768 lds
  s_add_u32 m0, s55, 6272
  s_nop 0
  buffer_load_dwordx4 v2, s[32:35], s48 offen offset:896 lds
  s_add_u32 m0, s55, 7168
  s_nop 0
  buffer_load_dwordx4 v2, s[32:35], s48 offen offset:1024 lds
  s_add_u32 s48, s48, s49
  s_sub_u32 s64, s64, 1
  s_cmp_gt_i32 s64, 0
  s_cselect_b32 s48, s48, 1073741824
  s_add_u32 s65, s65, 9216
  s_cmp_eq_u32 s65, 36864
  s_cselect_b32 s65, 0, s65
  s_add_u32 s55, s54, s65
  s_waitcnt vmcnt(27)
  ds_read_b64_tr_b16 a[216:217], v4 offset:18432
  ds_read_b64_tr_b16 a[218:219], v4 offset:18688
  ds_read_b64_tr_b16 a[220:221], v4 offset:19456
  ds_read_b64_tr_b16 a[222:223], v4 offset:19712
  ds_read_b64_tr_b16 a[224:225], v4 offset:20480
  ds_read_b64_tr_b16 a[226:227], v4 offset:20736
  ds_read_b64_tr_b16 a[228:229], v4 offset:21504
  ds_read_b64_tr_b16 a[230:231], v4 offset:21760
  ds_read_b64_tr_b16 a[232:233], v4 offset:22528
  ds_read_b64_tr_b16 a[234:235], v4 offset:22784
  ds_read_b64_tr_b16 a[236:237], v4 offset:23552
  ds_read_b64_tr_b16 a[238:239], v4 offset:23808
  ds_read_b64_tr_b16 a[240:241], v4 offset:24576
  ds_read_b64_tr_b16 a[242:243], v4 offset:24832
  ds_read_b64_tr_b16 a[244:245], v4 offset:25600
  ds_read_b64_tr_b16 a[246:247], v4 offset:25856
  ds_read_b64_tr_b16 a[248:249], v4 offset:26624
  ds_read_b64_tr_b16 a[250:251], v4 offset:26880
  s_waitcnt lgkmcnt(0)
  s_add_u32 m0, s55, 0
  s_nop 0
  buffer_load_dwordx4 v2, s[32:35], s48 offen offset:0 lds
  s_add_u32 m0, s55, 896
  s_nop 0
  buffer_load_dwordx4 v2, s[32:35], s48 offen offset:128 lds
  s_add_u32 m0, s55, 1792
  s_nop 0
  buffer_load_dwordx4 v2, s[32:35], s48 offen offset:256 lds
  s_add_u32 m0, s55, 2688
  s_nop 0
  buffer_load_dwordx4 v2, s[32:35], s48 offen offset:384 lds
  s_add_u32 m0, s55, 3584
  s_nop 0
  buffer_load_dwordx4 v2, s[32:35], s48 offen offset:512 lds
  s_add_u32 m0, s55, 4480
  s_nop 0
  buffer_load_dwordx4 v2, s[32:35], s48 offen offset:640 lds
  s_add_u32 m0, s55, 5376
  s_nop 0
  buffer_load_dwordx4 v2, s[32:35], s48 offen offset:768 lds
  s_add_u32 m0, s55, 6272
  s_nop 0
  buffer_load_dwordx4 v2, s[32:35], s48 offen offset:896 lds
  s_add_u32 m0, s55, 7168
  s_nop 0
  buffer_load_dwordx4 v2, s[32:35], s48 offen offset:1024 lds
  s_add_u32 s48, s48, s49
  s_sub_u32 s64, s64, 1
  s_cmp_gt_i32 s64, 0
  s_cselect_b32 s48, s48, 1073741824
  s_add_u32 s65, s65, 9216
  s_cmp_eq_u32 s65, 36864
  s_cselect_b32 s65, 0, s65
  s_add_u32 s55, s54, s65
  s_waitcnt vmcnt(27)
  ds_read_b64_tr_b16 a[252:253], v4 offset:27648
  ds_read_b64_tr_b16 a[254:255], v4 offset:27904
  ds_read_b64_tr_b16 v[124:125], v4 offset:28672
  ds_read_b64_tr_b16 v[126:127], v4 offset:28928
  ds_read_b64_tr_b16 v[128:129], v4 offset:29696
  ds_read_b64_tr_b16 v[130:131], v4 offset:29952
  ds_read_b64_tr_b16 v[132:133], v4 offset:30720
  ds_read_b64_tr_b16 v[134:135], v4 offset:30976
  ds_read_b64_tr_b16 v[136:137], v4 offset:31744
  ds_read_b64_tr_b16 v[138:139], v4 offset:32000
  ds_read_b64_tr_b16 v[140:141], v4 offset:32768
  ds_read_b64_tr_b16 v[142:143], v4 offset:33024
  ds_read_b64_tr_b16 v[144:145], v4 offset:33792
  ds_read_b64_tr_b16 v[146:147], v4 offset:34048
  ds_read_b64_tr_b16 v[148:149], v4 offset:34816
  ds_read_b64_tr_b16 v[150:151], v4 offset:35072
  ds_read_b64_tr_b16 v[152:153], v4 offset:35840
  ds_read_b64_tr_b16 v[154:155], v4 offset:36096
  s_waitcnt lgkmcnt(0)
  v_mov_b32 v250, 72
  s_mov_b32 s95, 4000000
.ww9:
  global_load_dword v251, v250, s[24:25] sc1
  s_waitcnt vmcnt(0)
  v_readfirstlane_b32 s94, v251
  s_cmp_lg_u32 s94, 0
  s_cbranch_scc1 .ww9_ok
  s_sleep 1
  s_sub_u32 s95, s95, 1
  s_cmp_lg_u32 s95, 0
  s_cbranch_scc1 .ww9
.ww9_ok:
  s_mov_b32 s61, s51
  s_mov_b32 s62, s52
  s_mov_b32 s51, 1073741824
  s_mov_b32 s52, 1073741824
  s_mov_b32 s56, 0
  v_mov_b32 v9, v5
  v_mov_b32 v10, v6
  v_mov_b32 v11, v7
  v_mov_b32 v12, v8
  s_waitcnt vmcnt(9)
  s_barrier
  ds_read_b128 v[20:23], v9 offset:0
  ds_read_b128 v[24:27], v10 offset:0
  ds_read_b128 v[28:31], v11 offset:0
  ds_read_b128 v[32:35], v12 offset:0
  ds_read_b128 v[36:39], v9 offset:1024
.Lconcat_heads__mha_block__memory_aug_recurrent_mem_tr__prompt_kernelavv_loop:
  ds_read_b128 v[40:43], v10 offset:1024
  s_waitcnt lgkmcnt(5)
  v_mfma_f32_32x32x16_bf16 v[60:75], v[20:23], a[0:3], 0
  s_add_u32 s56, s56, 9216
  s_cmp_eq_u32 s56, 36864
  s_cselect_b32 s56, 0, s56
  v_mfma_f32_32x32x16_bf16 v[76:91], v[20:23], a[144:147], 0
  v_add_u32 v13, s56, v5
  ds_read_b128 v[20:23], v11 offset:1024
  s_waitcnt lgkmcnt(5)
  v_mfma_f32_32x32x16_bf16 v[60:75], v[24:27], a[4:7], v[60:75]
  v_add_u32 v14, s56, v6
  v_mfma_f32_32x32x16_bf16 v[76:91], v[24:27], a[148:151], v[76:91]
  v_add_u32 v15, s56, v7
  ds_read_b128 v[24:27], v12 offset:1024
  s_waitcnt lgkmcnt(5)
  v_mfma_f32_32x32x16_bf16 v[60:75], v[28:31], a[8:11], v[60:75]
  v_add_u32 v16, s56, v8
  v_mfma_f32_32x32x16_bf16 v[76:91], v[28:31], a[152:155], v[76:91]
  v_cvt_pk_bf16_f32 v44, v92, v93
  ds_read_b128 v[28:31], v9 offset:2048
  s_waitcnt lgkmcnt(5)
  v_mfma_f32_32x32x16_bf16 v[60:75], v[32:35], a[12:15], v[60:75]
  v_cvt_pk_bf16_f32 v45, v94, v95
  v_mfma_f32_32x32x16_bf16 v[76:91], v[32:35], a[156:159], v[76:91]
  v_cvt_pk_bf16_f32 v46, v96, v97
  ds_read_b128 v[32:35], v10 offset:2048
  s_waitcnt lgkmcnt(5)
  v_mfma_f32_32x32x16_bf16 v[60:75], v[36:39], a[16:19], v[60:75]
  v_cvt_pk_bf16_f32 v47, v98, v99
  v_mfma_f32_32x32x16_bf16 v[76:91], v[36:39], a[160:163], v[76:91]
  v_cvt_pk_bf16_f32 v48, v100, v101
  ds_read_b128 v[36:39], v11 offset:2048
  s_waitcnt lgkmcnt(5)
  v_mfma_f32_32x32x16_bf16 v[60:75], v[40:43], a[20:23], v[60:75]
  v_cvt_pk_bf16_f32 v49, v102, v103
  v_mfma_f32_32x32x16_bf16 v[76:91], v[40:43], a[164:167], v[76:91]
  v_cvt_pk_bf16_f32 v50, v104, v105
  ds_read_b128 v[40:43], v12 offset:2048
  s_waitcnt lgkmcnt(5)
  v_mfma_f32_32x32x16_bf16 v[60:75], v[20:23], a[24:27], v[60:75]
  v_cvt_pk_bf16_f32 v51, v106, v107
  v_mfma_f32_32x32x16_bf16 v[76:91], v[20:23], a[168:171], v[76:91]
  v_cndmask_b32 v44, v44, v156, s[66:67]
  ds_read_b128 v[20:23], v9 offset:3072
  s_waitcnt lgkmcnt(5)
  v_mfma_f32_32x32x16_bf16 v[60:75], v[24:27], a[28:31], v[60:75]
  v_cndmask_b32 v45, v45, v156, s[66:67]
  v_mfma_f32_32x32x16_bf16 v[76:91], v[24:27], a[172:175], v[76:91]
  v_cndmask_b32 v46, v46, v156, s[66:67]
  ds_read_b128 v[24:27], v10 offset:3072
  s_waitcnt lgkmcnt(5)
  v_mfma_f32_32x32x16_bf16 v[60:75], v[28:31], a[32:35], v[60:75]
  v_cndmask_b32 v47, v47, v156, s[66:67]
  v_mfma_f32_32x32x16_bf16 v[76:91], v[28:31], a[176:179], v[76:91]
  v_cndmask_b32 v48, v48, v156, s[66:67]
  ds_read_b128 v[28:31], v11 offset:3072
  s_waitcnt lgkmcnt(5)
  v_mfma_f32_32x32x16_bf16 v[60:75], v[32:35], a[36:39], v[60:75]
  v_cndmask_b32 v49, v49, v156, s[66:67]
  v_mfma_f32_32x32x16_bf16 v[76:91], v[32:35], a[180:183], v[76:91]
  v_cndmask_b32 v50, v50, v156, s[66:67]
  ds_read_b128 v[32:35], v12 offset:3072
  s_waitcnt lgkmcnt(5)
  v_mfma_f32_32x32x16_bf16 v[60:75], v[36:39], a[40:43], v[60:75]
  v_cndmask_b32 v51, v51, v156, s[66:67]
  v_mfma_f32_32x32x16_bf16 v[76:91], v[36:39], a[184:187], v[76:91]
  s_mov_b64 exec, s[68:69]
  buffer_store_dwordx4 v[44:47], v17, s[44:47], s51 offen offset:1280 sc1
  buffer_store_dwordx4 v[48:51], v17, s[44:47], s51 offen offset:1888 sc1
  s_mov_b64 exec, -1
  ds_read_b128 v[36:39], v9 offset:4096
  s_waitcnt lgkmcnt(5)
  v_mfma_f32_32x32x16_bf16 v[60:75], v[40:43], a[44:47], v[60:75]
  v_cvt_pk_bf16_f32 v52, v108, v109
  v_mfma_f32_32x32x16_bf16 v[76:91], v[40:43], a[188:191], v[76:91]
  v_cvt_pk_bf16_f32 v53, v110, v111
  ds_read_b128 v[40:43], v10 offset:4096
  s_waitcnt lgkmcnt(5)
  v_mfma_f32_32x32x16_bf16 v[60:75], v[20:23], a[48:51], v[60:75]
  v_cvt_pk_bf16_f32 v54, v112, v113
  v_mfma_f32_32x32x16_bf16 v[76:91], v[20:23], a[192:195], v[76:91]
  v_cvt_pk_bf16_f32 v55, v114, v115
  ds_read_b128 v[20:23], v11 offset:4096
  s_waitcnt lgkmcnt(5)
  v_mfma_f32_32x32x16_bf16 v[60:75], v[24:27], a[52:55], v[60:75]
  v_cvt_pk_bf16_f32 v56, v116, v117
  v_mfma_f32_32x32x16_bf16 v[76:91], v[24:27], a[196:199], v[76:91]
  v_cvt_pk_bf16_f32 v57, v118, v119
  ds_read_b128 v[24:27], v12 offset:4096
  s_waitcnt lgkmcnt(5)
  v_mfma_f32_32x32x16_bf16 v[60:75], v[28:31], a[56:59], v[60:75]
  v_cvt_pk_bf16_f32 v58, v120, v121
  v_mfma_f32_32x32x16_bf16 v[76:91], v[28:31], a[200:203], v[76:91]
  v_cvt_pk_bf16_f32 v59, v122, v123
  ds_read_b128 v[28:31], v9 offset:5120
  s_waitcnt lgkmcnt(5)
  v_mfma_f32_32x32x16_bf16 v[60:75], v[32:35], a[60:63], v[60:75]
  v_cndmask_b32 v52, v52, v156, s[66:67]
  v_mfma_f32_32x32x16_bf16 v[76:91], v[32:35], a[204:207], v[76:91]
  v_cndmask_b32 v53, v53, v156, s[66:67]
  ds_read_b128 v[32:35], v10 offset:5120
  s_waitcnt lgkmcnt(5)
  v_mfma_f32_32x32x16_bf16 v[60:75], v[36:39], a[64:67], v[60:75]
  v_cndmask_b32 v54, v54, v156, s[66:67]
  v_mfma_f32_32x32x16_bf16 v[76:91], v[36:39], a[208:211], v[76:91]
  v_cndmask_b32 v55, v55, v156, s[66:67]
  ds_read_b128 v[36:39], v11 offset:5120
  s_waitcnt lgkmcnt(5)
  v_mfma_f32_32x32x16_bf16 v[60:75], v[40:43], a[68:71], v[60:75]
  v_cndmask_b32 v56, v56, v156, s[66:67]
  v_mfma_f32_32x32x16_bf16 v[76:91], v[40:43], a[212:215], v[76:91]
  v_cndmask_b32 v57, v57, v156, s[66:67]
  ds_read_b128 v[40:43], v12 offset:5120
  s_waitcnt lgkmcnt(5)
  v_mfma_f32_32x32x16_bf16 v[60:75], v[20:23], a[72:75], v[60:75]
  v_cndmask_b32 v58, v58, v156, s[66:67]
  v_mfma_f32_32x32x16_bf16 v[76:91], v[20:23], a[216:219], v[76:91]
  v_cndmask_b32 v59, v59, v156, s[66:67]
  ds_read_b128 v[20:23], v9 offset:6144
  s_waitcnt lgkmcnt(5)
  v_mfma_f32_32x32x16_bf16 v[60:75], v[24:27], a[76:79], v[60:75]
  s_mov_b64 exec, s[68:69]
  buffer_store_dwordx4 v[52:55], v18, s[44:47], s52 offen offset:1280 sc1
  buffer_store_dwordx4 v[56:59], v18, s[44:47], s52 offen offset:1888 sc1
  s_mov_b64 exec, -1
  v_mfma_f32_32x32x16_bf16 v[76:91], v[24:27], a[220:223], v[76:91]
  ds_read_b128 v[24:27], v10 offset:6144
  s_waitcnt lgkmcnt(5)
  v_mfma_f32_32x32x16_bf16 v[60:75], v[28:31], a[80:83], v[60:75]
  v_mfma_f32_32x32x16_bf16 v[76:91], v[28:31], a[224:227], v[76:91]
  ds_read_b128 v[28:31], v11 offset:6144
  s_waitcnt lgkmcnt(5)
  v_mfma_f32_32x32x16_bf16 v[60:75], v[32:35], a[84:87], v[60:75]
  v_mfma_f32_32x32x16_bf16 v[76:91], v[32:35], a[228:231], v[76:91]
  ds_read_b128 v[32:35], v12 offset:6144
  s_waitcnt lgkmcnt(5)
  v_mfma_f32_32x32x16_bf16 v[60:75], v[36:39], a[88:91], v[60:75]
  s_mov_b32 s51, s61
  s_mov_b32 s52, s62
  s_add_u32 s61, s61, s53
  s_add_u32 s62, s62, s71
  v_mfma_f32_32x32x16_bf16 v[76:91], v[36:39], a[232:235], v[76:91]
  s_waitcnt vmcnt(17)
  s_barrier
  ds_read_b128 v[36:39], v9 offset:7168
  s_waitcnt lgkmcnt(5)
  v_mfma_f32_32x32x16_bf16 v[60:75], v[40:43], a[92:95], v[60:75]
  v_mfma_f32_32x32x16_bf16 v[76:91], v[40:43], a[236:239], v[76:91]
  s_add_u32 m0, s55, 0
  ds_read_b128 v[40:43], v10 offset:7168
  s_waitcnt lgkmcnt(5)
  v_mfma_f32_32x32x16_bf16 v[60:75], v[20:23], a[96:99], v[60:75]
  buffer_load_dwordx4 v2, s[32:35], s48 offen offset:0 lds
  v_mfma_f32_32x32x16_bf16 v[76:91], v[20:23], a[240:243], v[76:91]
  s_add_u32 m0, s55, 896
  ds_read_b128 v[20:23], v11 offset:7168
  s_waitcnt lgkmcnt(5)
  v_mfma_f32_32x32x16_bf16 v[60:75], v[24:27], a[100:103], v[60:75]
  buffer_load_dwordx4 v2, s[32:35], s48 offen offset:128 lds
  v_mfma_f32_32x32x16_bf16 v[76:91], v[24:27], a[244:247], v[76:91]
  s_add_u32 m0, s55, 1792
  ds_read_b128 v[24:27], v12 offset:7168
  s_waitcnt lgkmcnt(5)
  v_mfma_f32_32x32x16_bf16 v[60:75], v[28:31], a[104:107], v[60:75]
  buffer_load_dwordx4 v2, s[32:35], s48 offen offset:256 lds
  v_mfma_f32_32x32x16_bf16 v[76:91], v[28:31], a[248:251], v[76:91]
  s_add_u32 m0, s55, 2688
  ds_read_b128 v[28:31], v9 offset:8192
  s_waitcnt lgkmcnt(5)
  v_mfma_f32_32x32x16_bf16 v[60:75], v[32:35], a[108:111], v[60:75]
  buffer_load_dwordx4 v2, s[32:35], s48 offen offset:384 lds
  v_mfma_f32_32x32x16_bf16 v[76:91], v[32:35], a[252:255], v[76:91]
  s_add_u32 m0, s55, 3584
  ds_read_b128 v[32:35], v10 offset:8192
  s_waitcnt lgkmcnt(5)
  v_mfma_f32_32x32x16_bf16 v[60:75], v[36:39], a[112:115], v[60:75]
  buffer_load_dwordx4 v2, s[32:35], s48 offen offset:512 lds
  v_mfma_f32_32x32x16_bf16 v[76:91], v[36:39], v[124:127], v[76:91]
  s_add_u32 m0, s55, 4480
  ds_read_b128 v[36:39], v11 offset:8192
  s_waitcnt lgkmcnt(5)
  v_mfma_f32_32x32x16_bf16 v[60:75], v[40:43], a[116:119], v[60:75]
  buffer_load_dwordx4 v2, s[32:35], s48 offen offset:640 lds
  v_mfma_f32_32x32x16_bf16 v[76:91], v[40:43], v[128:131], v[76:91]
  s_add_u32 m0, s55, 5376
  ds_read_b128 v[40:43], v12 offset:8192
  s_waitcnt lgkmcnt(5)
  v_mfma_f32_32x32x16_bf16 v[60:75], v[20:23], a[120:123], v[60:75]
  buffer_load_dwordx4 v2, s[32:35], s48 offen offset:768 lds
  v_mfma_f32_32x32x16_bf16 v[76:91], v[20:23], v[132:135], v[76:91]
  s_add_u32 m0, s55, 6272
  ds_read_b128 v[20:23], v13 offset:0
  s_waitcnt lgkmcnt(5)
  v_mfma_f32_32x32x16_bf16 v[60:75], v[24:27], a[124:127], v[60:75]
  buffer_load_dwordx4 v2, s[32:35], s48 offen offset:896 lds
  v_mfma_f32_32x32x16_bf16 v[76:91], v[24:27], v[136:139], v[76:91]
  s_add_u32 m0, s55, 7168
  ds_read_b128 v[24:27], v14 offset:0
  s_waitcnt lgkmcnt(5)
  v_mfma_f32_32x32x16_bf16 v[60:75], v[28:31], a[128:131], v[60:75]
  buffer_load_dwordx4 v2, s[32:35], s48 offen offset:1024 lds
  v_mfma_f32_32x32x16_bf16 v[76:91], v[28:31], v[140:143], v[76:91]
  ds_read_b128 v[28:31], v15 offset:0
  s_waitcnt lgkmcnt(5)
  v_mfma_f32_32x32x16_bf16 v[60:75], v[32:35], a[132:135], v[60:75]
  s_add_u32 s48, s48, s49
  s_sub_u32 s64, s64, 1
  s_cmp_gt_i32 s64, 0
  s_cselect_b32 s48, s48, 1073741824
  s_add_u32 s65, s65, 9216
  s_cmp_eq_u32 s65, 36864
  s_cselect_b32 s65, 0, s65
  s_add_u32 s55, s54, s65
  v_mfma_f32_32x32x16_bf16 v[76:91], v[32:35], v[144:147], v[76:91]
  ds_read_b128 v[32:35], v16 offset:0
  s_waitcnt lgkmcnt(5)
  v_mfma_f32_32x32x16_bf16 v[60:75], v[36:39], a[136:139], v[60:75]
  v_mfma_f32_32x32x16_bf16 v[76:91], v[36:39], v[148:151], v[76:91]
  ds_read_b128 v[36:39], v13 offset:1024
  s_waitcnt lgkmcnt(5)
  v_mfma_f32_32x32x16_bf16 v[60:75], v[40:43], a[140:143], v[60:75]
  v_mfma_f32_32x32x16_bf16 v[76:91], v[40:43], v[152:155], v[76:91]
  s_sub_u32 s50, s50, 1
  s_cmp_eq_u32 s50, 0
  s_cbranch_scc1 .Lconcat_heads__mha_block__memory_aug_recurrent_mem_tr__prompt_kernelavv_tail0
  ds_read_b128 v[40:43], v14 offset:1024
  s_waitcnt lgkmcnt(5)
  v_mfma_f32_32x32x16_bf16 v[92:107], v[20:23], a[0:3], 0
  s_add_u32 s56, s56, 9216
  s_cmp_eq_u32 s56, 36864
  s_cselect_b32 s56, 0, s56
  v_mfma_f32_32x32x16_bf16 v[108:123], v[20:23], a[144:147], 0
  v_add_u32 v9, s56, v5
  ds_read_b128 v[20:23], v15 offset:1024
  s_waitcnt lgkmcnt(5)
  v_mfma_f32_32x32x16_bf16 v[92:107], v[24:27], a[4:7], v[92:107]
  v_add_u32 v10, s56, v6
  v_mfma_f32_32x32x16_bf16 v[108:123], v[24:27], a[148:151], v[108:123]
  v_add_u32 v11, s56, v7
  ds_read_b128 v[24:27], v16 offset:1024
  s_waitcnt lgkmcnt(5)
  v_mfma_f32_32x32x16_bf16 v[92:107], v[28:31], a[8:11], v[92:107]
  v_add_u32 v12, s56, v8
  v_mfma_f32_32x32x16_bf16 v[108:123], v[28:31], a[152:155], v[108:123]
  v_cvt_pk_bf16_f32 v44, v60, v61
  ds_read_b128 v[28:31], v13 offset:2048
  s_waitcnt lgkmcnt(5)
  v_mfma_f32_32x32x16_bf16 v[92:107], v[32:35], a[12:15], v[92:107]
  v_cvt_pk_bf16_f32 v45, v62, v63
  v_mfma_f32_32x32x16_bf16 v[108:123], v[32:35], a[156:159], v[108:123]
  v_cvt_pk_bf16_f32 v46, v64, v65
  ds_read_b128 v[32:35], v14 offset:2048
  s_waitcnt lgkmcnt(5)
  v_mfma_f32_32x32x16_bf16 v[92:107], v[36:39], a[16:19], v[92:107]
  v_cvt_pk_bf16_f32 v47, v66, v67
  v_mfma_f32_32x32x16_bf16 v[108:123], v[36:39], a[160:163], v[108:123]
  v_cvt_pk_bf16_f32 v48, v68, v69
  ds_read_b128 v[36:39], v15 offset:2048
  s_waitcnt lgkmcnt(5)
  v_mfma_f32_32x32x16_bf16 v[92:107], v[40:43], a[20:23], v[92:107]
  v_cvt_pk_bf16_f32 v49, v70, v71
  v_mfma_f32_32x32x16_bf16 v[108:123], v[40:43], a[164:167], v[108:123]
  v_cvt_pk_bf16_f32 v50, v72, v73
  ds_read_b128 v[40:43], v16 offset:2048
  s_waitcnt lgkmcnt(5)
  v_mfma_f32_32x32x16_bf16 v[92:107], v[20:23], a[24:27], v[92:107]
  v_cvt_pk_bf16_f32 v51, v74, v75
  v_mfma_f32_32x32x16_bf16 v[108:123], v[20:23], a[168:171], v[108:123]
  v_cndmask_b32 v44, v44, v156, s[66:67]
  ds_read_b128 v[20:23], v13 offset:3072
  s_waitcnt lgkmcnt(5)
  v_mfma_f32_32x32x16_bf16 v[92:107], v[24:27], a[28:31], v[92:107]
  v_cndmask_b32 v45, v45, v156, s[66:67]
  v_mfma_f32_32x32x16_bf16 v[108:123], v[24:27], a[172:175], v[108:123]
  v_cndmask_b32 v46, v46, v156, s[66:67]
  ds_read_b128 v[24:27], v14 offset:3072
  s_waitcnt lgkmcnt(5)
  v_mfma_f32_32x32x16_bf16 v[92:107], v[28:31], a[32:35], v[92:107]
  v_cndmask_b32 v47, v47, v156, s[66:67]
  v_mfma_f32_32x32x16_bf16 v[108:123], v[28:31], a[176:179], v[108:123]
  v_cndmask_b32 v48, v48, v156, s[66:67]
  ds_read_b128 v[28:31], v15 offset:3072
  s_waitcnt lgkmcnt(5)
  v_mfma_f32_32x32x16_bf16 v[92:107], v[32:35], a[36:39], v[92:107]
  v_cndmask_b32 v49, v49, v156, s[66:67]
  v_mfma_f32_32x32x16_bf16 v[108:123], v[32:35], a[180:183], v[108:123]
  v_cndmask_b32 v50, v50, v156, s[66:67]
  ds_read_b128 v[32:35], v16 offset:3072
  s_waitcnt lgkmcnt(5)
  v_mfma_f32_32x32x16_bf16 v[92:107], v[36:39], a[40:43], v[92:107]
  v_cndmask_b32 v51, v51, v156, s[66:67]
  v_mfma_f32_32x32x16_bf16 v[108:123], v[36:39], a[184:187], v[108:123]
  s_mov_b64 exec, s[68:69]
  buffer_store_dwordx4 v[44:47], v17, s[44:47], s51 offen offset:1280 sc1
  buffer_store_dwordx4 v[48:51], v17, s[44:47], s51 offen offset:1888 sc1
  s_mov_b64 exec, -1
  ds_read_b128 v[36:39], v13 offset:4096
  s_waitcnt lgkmcnt(5)
  v_mfma_f32_32x32x16_bf16 v[92:107], v[40:43], a[44:47], v[92:107]
  v_cvt_pk_bf16_f32 v52, v76, v77
  v_mfma_f32_32x32x16_bf16 v[108:123], v[40:43], a[188:191], v[108:123]
  v_cvt_pk_bf16_f32 v53, v78, v79
  ds_read_b128 v[40:43], v14 offset:4096
  s_waitcnt lgkmcnt(5)
  v_mfma_f32_32x32x16_bf16 v[92:107], v[20:23], a[48:51], v[92:107]
  v_cvt_pk_bf16_f32 v54, v80, v81
  v_mfma_f32_32x32x16_bf16 v[108:123], v[20:23], a[192:195], v[108:123]
  v_cvt_pk_bf16_f32 v55, v82, v83
  ds_read_b128 v[20:23], v15 offset:4096
  s_waitcnt lgkmcnt(5)
  v_mfma_f32_32x32x16_bf16 v[92:107], v[24:27], a[52:55], v[92:107]
  v_cvt_pk_bf16_f32 v56, v84, v85
  v_mfma_f32_32x32x16_bf16 v[108:123], v[24:27], a[196:199], v[108:123]
  v_cvt_pk_bf16_f32 v57, v86, v87
  ds_read_b128 v[24:27], v16 offset:4096
  s_waitcnt lgkmcnt(5)
  v_mfma_f32_32x32x16_bf16 v[92:107], v[28:31], a[56:59], v[92:107]
  v_cvt_pk_bf16_f32 v58, v88, v89
  v_mfma_f32_32x32x16_bf16 v[108:123], v[28:31], a[200:203], v[108:123]
  v_cvt_pk_bf16_f32 v59, v90, v91
  ds_read_b128 v[28:31], v13 offset:5120
  s_waitcnt lgkmcnt(5)
  v_mfma_f32_32x32x16_bf16 v[92:107], v[32:35], a[60:63], v[92:107]
  v_cndmask_b32 v52, v52, v156, s[66:67]
  v_mfma_f32_32x32x16_bf16 v[108:123], v[32:35], a[204:207], v[108:123]
  v_cndmask_b32 v53, v53, v156, s[66:67]
  ds_read_b128 v[32:35], v14 offset:5120
  s_waitcnt lgkmcnt(5)
  v_mfma_f32_32x32x16_bf16 v[92:107], v[36:39], a[64:67], v[92:107]
  v_cndmask_b32 v54, v54, v156, s[66:67]
  v_mfma_f32_32x32x16_bf16 v[108:123], v[36:39], a[208:211], v[108:123]
  v_cndmask_b32 v55, v55, v156, s[66:67]
  ds_read_b128 v[36:39], v15 offset:5120
  s_waitcnt lgkmcnt(5)
  v_mfma_f32_32x32x16_bf16 v[92:107], v[40:43], a[68:71], v[92:107]
  v_cndmask_b32 v56, v56, v156, s[66:67]
  v_mfma_f32_32x32x16_bf16 v[108:123], v[40:43], a[212:215], v[108:123]
  v_cndmask_b32 v57, v57, v156, s[66:67]
  ds_read_b128 v[40:43], v16 offset:5120
  s_waitcnt lgkmcnt(5)
  v_mfma_f32_32x32x16_bf16 v[92:107], v[20:23], a[72:75], v[92:107]
  v_cndmask_b32 v58, v58, v156, s[66:67]
  v_mfma_f32_32x32x16_bf16 v[108:123], v[20:23], a[216:219], v[108:123]
  v_cndmask_b32 v59, v59, v156, s[66:67]
  ds_read_b128 v[20:23], v13 offset:6144
  s_waitcnt lgkmcnt(5)
  v_mfma_f32_32x32x16_bf16 v[92:107], v[24:27], a[76:79], v[92:107]
  s_mov_b64 exec, s[68:69]
  buffer_store_dwordx4 v[52:55], v18, s[44:47], s52 offen offset:1280 sc1
  buffer_store_dwordx4 v[56:59], v18, s[44:47], s52 offen offset:1888 sc1
  s_mov_b64 exec, -1
  v_mfma_f32_32x32x16_bf16 v[108:123], v[24:27], a[220:223], v[108:123]
  ds_read_b128 v[24:27], v14 offset:6144
  s_waitcnt lgkmcnt(5)
  v_mfma_f32_32x32x16_bf16 v[92:107], v[28:31], a[80:83], v[92:107]
  v_mfma_f32_32x32x16_bf16 v[108:123], v[28:31], a[224:227], v[108:123]
  ds_read_b128 v[28:31], v15 offset:6144
  s_waitcnt lgkmcnt(5)
  v_mfma_f32_32x32x16_bf16 v[92:107], v[32:35], a[84:87], v[92:107]
  v_mfma_f32_32x32x16_bf16 v[108:123], v[32:35], a[228:231], v[108:123]
  ds_read_b128 v[32:35], v16 offset:6144
  s_waitcnt lgkmcnt(5)
  v_mfma_f32_32x32x16_bf16 v[92:107], v[36:39], a[88:91], v[92:107]
  s_mov_b32 s51, s61
  s_mov_b32 s52, s62
  s_add_u32 s61, s61, s53
  s_add_u32 s62, s62, s71
  v_mfma_f32_32x32x16_bf16 v[108:123], v[36:39], a[232:235], v[108:123]
  s_waitcnt vmcnt(17)
  s_barrier
  ds_read_b128 v[36:39], v13 offset:7168
  s_waitcnt lgkmcnt(5)
  v_mfma_f32_32x32x16_bf16 v[92:107], v[40:43], a[92:95], v[92:107]
  v_mfma_f32_32x32x16_bf16 v[108:123], v[40:43], a[236:239], v[108:123]
  s_add_u32 m0, s55, 0
  ds_read_b128 v[40:43], v14 offset:7168
  s_waitcnt lgkmcnt(5)
  v_mfma_f32_32x32x16_bf16 v[92:107], v[20:23], a[96:99], v[92:107]
  buffer_load_dwordx4 v2, s[32:35], s48 offen offset:0 lds
  v_mfma_f32_32x32x16_bf16 v[108:123], v[20:23], a[240:243], v[108:123]
  s_add_u32 m0, s55, 896
  ds_read_b128 v[20:23], v15 offset:7168
  s_waitcnt lgkmcnt(5)
  v_mfma_f32_32x32x16_bf16 v[92:107], v[24:27], a[100:103], v[92:107]
  buffer_load_dwordx4 v2, s[32:35], s48 offen offset:128 lds
  v_mfma_f32_32x32x16_bf16 v[108:123], v[24:27], a[244:247], v[108:123]
  s_add_u32 m0, s55, 1792
  ds_read_b128 v[24:27], v16 offset:7168
  s_waitcnt lgkmcnt(5)
  v_mfma_f32_32x32x16_bf16 v[92:107], v[28:31], a[104:107], v[92:107]
  buffer_load_dwordx4 v2, s[32:35], s48 offen offset:256 lds
  v_mfma_f32_32x32x16_bf16 v[108:123], v[28:31], a[248:251], v[108:123]
  s_add_u32 m0, s55, 2688
  ds_read_b128 v[28:31], v13 offset:8192
  s_waitcnt lgkmcnt(5)
  v_mfma_f32_32x32x16_bf16 v[92:107], v[32:35], a[108:111], v[92:107]
  buffer_load_dwordx4 v2, s[32:35], s48 offen offset:384 lds
  v_mfma_f32_32x32x16_bf16 v[108:123], v[32:35], a[252:255], v[108:123]
  s_add_u32 m0, s55, 3584
  ds_read_b128 v[32:35], v14 offset:8192
  s_waitcnt lgkmcnt(5)
  v_mfma_f32_32x32x16_bf16 v[92:107], v[36:39], a[112:115], v[92:107]
  buffer_load_dwordx4 v2, s[32:35], s48 offen offset:512 lds
  v_mfma_f32_32x32x16_bf16 v[108:123], v[36:39], v[124:127], v[108:123]
  s_add_u32 m0, s55, 4480
  ds_read_b128 v[36:39], v15 offset:8192
  s_waitcnt lgkmcnt(5)
  v_mfma_f32_32x32x16_bf16 v[92:107], v[40:43], a[116:119], v[92:107]
  buffer_load_dwordx4 v2, s[32:35], s48 offen offset:640 lds
  v_mfma_f32_32x32x16_bf16 v[108:123], v[40:43], v[128:131], v[108:123]
  s_add_u32 m0, s55, 5376
  ds_read_b128 v[40:43], v16 offset:8192
  s_waitcnt lgkmcnt(5)
  v_mfma_f32_32x32x16_bf16 v[92:107], v[20:23], a[120:123], v[92:107]
  buffer_load_dwordx4 v2, s[32:35], s48 offen offset:768 lds
  v_mfma_f32_32x32x16_bf16 v[108:123], v[20:23], v[132:135], v[108:123]
  s_add_u32 m0, s55, 6272
  ds_read_b128 v[20:23], v9 offset:0
  s_waitcnt lgkmcnt(5)
  v_mfma_f32_32x32x16_bf16 v[92:107], v[24:27], a[124:127], v[92:107]
  buffer_load_dwordx4 v2, s[32:35], s48 offen offset:896 lds
  v_mfma_f32_32x32x16_bf16 v[108:123], v[24:27], v[136:139], v[108:123]
  s_add_u32 m0, s55, 7168
  ds_read_b128 v[24:27], v10 offset:0
  s_waitcnt lgkmcnt(5)
  v_mfma_f32_32x32x16_bf16 v[92:107], v[28:31], a[128:131], v[92:107]
  buffer_load_dwordx4 v2, s[32:35], s48 offen offset:1024 lds
  v_mfma_f32_32x32x16_bf16 v[108:123], v[28:31], v[140:143], v[108:123]
  ds_read_b128 v[28:31], v11 offset:0
  s_waitcnt lgkmcnt(5)
  v_mfma_f32_32x32x16_bf16 v[92:107], v[32:35], a[132:135], v[92:107]
  s_add_u32 s48, s48, s49
  s_sub_u32 s64, s64, 1
  s_cmp_gt_i32 s64, 0
  s_cselect_b32 s48, s48, 1073741824
  s_add_u32 s65, s65, 9216
  s_cmp_eq_u32 s65, 36864
  s_cselect_b32 s65, 0, s65
  s_add_u32 s55, s54, s65
  v_mfma_f32_32x32x16_bf16 v[108:123], v[32:35], v[144:147], v[108:123]
  ds_read_b128 v[32:35], v12 offset:0
  s_waitcnt lgkmcnt(5)
  v_mfma_f32_32x32x16_bf16 v[92:107], v[36:39], a[136:139], v[92:107]
  v_mfma_f32_32x32x16_bf16 v[108:123], v[36:39], v[148:151], v[108:123]
  ds_read_b128 v[36:39], v9 offset:1024
  s_waitcnt lgkmcnt(5)
  v_mfma_f32_32x32x16_bf16 v[92:107], v[40:43], a[140:143], v[92:107]
  v_mfma_f32_32x32x16_bf16 v[108:123], v[40:43], v[152:155], v[108:123]
  s_sub_u32 s50, s50, 1
  s_cmp_lg_u32 s50, 0
  s_cbranch_scc1 .Lconcat_heads__mha_block__memory_aug_recurrent_mem_tr__prompt_kernelavv_loop
.Lconcat_heads__mha_block__memory_aug_recurrent_mem_tr__prompt_kernelavv_tail1:
  s_nop 7
  s_nop 7
  v_cvt_pk_bf16_f32 v44, v92, v93
  v_cvt_pk_bf16_f32 v45, v94, v95
  v_cvt_pk_bf16_f32 v46, v96, v97
  v_cvt_pk_bf16_f32 v47, v98, v99
  v_cvt_pk_bf16_f32 v48, v100, v101
  v_cvt_pk_bf16_f32 v49, v102, v103
  v_cvt_pk_bf16_f32 v50, v104, v105
  v_cvt_pk_bf16_f32 v51, v106, v107
  v_cndmask_b32 v44, v44, v156, s[66:67]
  v_cndmask_b32 v45, v45, v156, s[66:67]
  v_cndmask_b32 v46, v46, v156, s[66:67]
  v_cndmask_b32 v47, v47, v156, s[66:67]
  v_cndmask_b32 v48, v48, v156, s[66:67]
  v_cndmask_b32 v49, v49, v156, s[66:67]
  v_cndmask_b32 v50, v50, v156, s[66:67]
  v_cndmask_b32 v51, v51, v156, s[66:67]
  s_mov_b64 exec, s[68:69]
  buffer_store_dwordx4 v[44:47], v17, s[44:47], s51 offen offset:1280 sc1
  buffer_store_dwordx4 v[48:51], v17, s[44:47], s51 offen offset:1888 sc1
  s_mov_b64 exec, -1
  v_cvt_pk_bf16_f32 v52, v108, v109
  v_cvt_pk_bf16_f32 v53, v110, v111
  v_cvt_pk_bf16_f32 v54, v112, v113
  v_cvt_pk_bf16_f32 v55, v114, v115
  v_cvt_pk_bf16_f32 v56, v116, v117
  v_cvt_pk_bf16_f32 v57, v118, v119
  v_cvt_pk_bf16_f32 v58, v120, v121
  v_cvt_pk_bf16_f32 v59, v122, v123
  v_cndmask_b32 v52, v52, v156, s[66:67]
  v_cndmask_b32 v53, v53, v156, s[66:67]
  v_cndmask_b32 v54, v54, v156, s[66:67]
  v_cndmask_b32 v55, v55, v156, s[66:67]
  v_cndmask_b32 v56, v56, v156, s[66:67]
  v_cndmask_b32 v57, v57, v156, s[66:67]
  v_cndmask_b32 v58, v58, v156, s[66:67]
  v_cndmask_b32 v59, v59, v156, s[66:67]
  s_mov_b64 exec, s[68:69]
  buffer_store_dwordx4 v[52:55], v18, s[44:47], s52 offen offset:1280 sc1
  buffer_store_dwordx4 v[56:59], v18, s[44:47], s52 offen offset:1888 sc1
  s_mov_b64 exec, -1
  s_branch .Lconcat_heads__mha_block__memory_aug_recurrent_mem_tr__prompt_kernelavv_done
.Lconcat_heads__mha_block__memory_aug_recurrent_mem_tr__prompt_kernelavv_tail0:
  s_nop 7
  s_nop 7
  v_cvt_pk_bf16_f32 v44, v60, v61
  v_cvt_pk_bf16_f32 v45, v62, v63
  v_cvt_pk_bf16_f32 v46, v64, v65
  v_cvt_pk_bf16_f32 v47, v66, v67
  v_cvt_pk_bf16_f32 v48, v68, v69
  v_cvt_pk_bf16_f32 v49, v70, v71
  v_cvt_pk_bf16_f32 v50, v72, v73
  v_cvt_pk_bf16_f32 v51, v74, v75
  v_cndmask_b32 v44, v44, v156, s[66:67]
  v_cndmask_b32 v45, v45, v156, s[66:67]
  v_cndmask_b32 v46, v46, v156, s[66:67]
  v_cndmask_b32 v47, v47, v156, s[66:67]
  v_cndmask_b32 v48, v48, v156, s[66:67]
  v_cndmask_b32 v49, v49, v156, s[66:67]
  v_cndmask_b32 v50, v50, v156, s[66:67]
  v_cndmask_b32 v51, v51, v156, s[66:67]
  s_mov_b64 exec, s[68:69]
  buffer_store_dwordx4 v[44:47], v17, s[44:47], s51 offen offset:1280 sc1
  buffer_store_dwordx4 v[48:51], v17, s[44:47], s51 offen offset:1888 sc1
  s_mov_b64 exec, -1
  v_cvt_pk_bf16_f32 v52, v76, v77
  v_cvt_pk_bf16_f32 v53, v78, v79
  v_cvt_pk_bf16_f32 v54, v80, v81
  v_cvt_pk_bf16_f32 v55, v82, v83
  v_cvt_pk_bf16_f32 v56, v84, v85
  v_cvt_pk_bf16_f32 v57, v86, v87
  v_cvt_pk_bf16_f32 v58, v88, v89
  v_cvt_pk_bf16_f32 v59, v90, v91
  v_cndmask_b32 v52, v52, v156, s[66:67]
  v_cndmask_b32 v53, v53, v156, s[66:67]
  v_cndmask_b32 v54, v54, v156, s[66:67]
  v_cndmask_b32 v55, v55, v156, s[66:67]
  v_cndmask_b32 v56, v56, v156, s[66:67]
  v_cndmask_b32 v57, v57, v156, s[66:67]
  v_cndmask_b32 v58, v58, v156, s[66:67]
  v_cndmask_b32 v59, v59, v156, s[66:67]
  s_mov_b64 exec, s[68:69]
  buffer_store_dwordx4 v[52:55], v18, s[44:47], s52 offen offset:1280 sc1
  buffer_store_dwordx4 v[56:59], v18, s[44:47], s52 offen offset:1888 sc1
  s_mov_b64 exec, -1
.Lconcat_heads__mha_block__memory_aug_recurrent_mem_tr__prompt_kernelavv_done:
  s_waitcnt vmcnt(0) lgkmcnt(0)
  s_barrier
.Lconcat_heads__mha_block__memory_aug_recurrent_mem_tr__prompt_kernel_apf:
  s_lshl_b32 s60, s91, 2
  s_add_u32 s60, s60, 70025216
  s_cmp_lg_u32 s28, 0
  s_cbranch_scc1 .f110
  v_mov_b32 v250, 1
  s_mov_b64 exec, 1
  buffer_store_dword v250, off, s[44:47], s60 sc1
  s_mov_b64 exec, -1
.f110:
  s_branch .Lconcat_heads__mha_block__memory_aug_recurrent_mem_tr__prompt_kernel_apw
.Lconcat_heads__mha_block__memory_aug_recurrent_mem_tr__prompt_kernel_apx:
  v_mov_b32 v250, 72
  s_mov_b32 s95, 4000000
.ww11:
  global_load_dword v251, v250, s[24:25] sc1
  s_waitcnt vmcnt(0)
  v_readfirstlane_b32 s94, v251
  s_cmp_lg_u32 s94, 0
  s_cbranch_scc1 .ww11_ok
  s_sleep 1
  s_sub_u32 s95, s95, 1
  s_cmp_lg_u32 s95, 0
  s_cbranch_scc1 .ww11
.ww11_ok:
.Lconcat_heads__mha_block__memory_aug_recurrent_mem_tr__prompt_kernel_apw:
  s_cmp_lg_u32 s28, 0
  s_cbranch_scc1 .wp12
  v_lshlrev_b32 v248, 2, v1
  v_add_u32 v248, 70025216, v248
  s_mov_b32 s95, 4000000
  s_mov_b32 exec_lo, 0xffffffff
  s_mov_b32 exec_hi, 0xffffffff
.wm13:
  global_load_dword v251, v248, s[26:27] sc1
  s_waitcnt vmcnt(0)
  v_cmp_eq_u32 vcc, 0, v251
  s_cbranch_vccz .wm13_ok
  s_sleep 4
  s_sub_u32 s95, s95, 1
  s_cmp_lg_u32 s95, 0
  s_cbranch_scc1 .wm13
.wm13_ok:
  s_mov_b64 exec, -1
  v_add_u32 v248, 256, v248
  s_mov_b32 s95, 4000000
  s_mov_b32 exec_lo, 0xffffffff
  s_mov_b32 exec_hi, 0x0
.wm14:
  global_load_dword v251, v248, s[26:27] sc1
  s_waitcnt vmcnt(0)
  v_cmp_eq_u32 vcc, 0, v251
  s_cbranch_vccz .wm14_ok
  s_sleep 4
  s_sub_u32 s95, s95, 1
  s_cmp_lg_u32 s95, 0
  s_cbranch_scc1 .wm14
.wm14_ok:
  s_mov_b64 exec, -1
  buffer_inv sc1
  s_waitcnt vmcnt(0)
.wp12:
  s_barrier
  s_mov_b32 s29, s91
  s_mov_b32 s32, s26
  s_mov_b32 s33, s27
  s_mov_b32 s34, 268435456
  s_mov_b32 s35, 0x00020000
  s_lshr_b32 s60, s29, 2
  s_and_b32 s61, s29, 3
  s_mov_b32 s67, 2
  s_mul_i32 s62, s60, 159744
  s_add_u32 s62, s62, 92274688
  s_mul_i32 s63, s28, 39936
  s_add_u32 s62, s62, s63
  v_lshlrev_b32 v2, 4, v1
  s_add_u32 m0, s63, 0
  s_add_u32 s64, s62, 0
  buffer_load_dwordx4 v2, s[32:35], s64 offen lds
  s_add_u32 m0, s63, 1024
  s_add_u32 s64, s62, 1024
  buffer_load_dwordx4 v2, s[32:35], s64 offen lds
  s_add_u32 m0, s63, 2048
  s_add_u32 s64, s62, 2048
  buffer_load_dwordx4 v2, s[32:35], s64 offen lds
  s_add_u32 m0, s63, 3072
  s_add_u32 s64, s62, 3072
  buffer_load_dwordx4 v2, s[32:35], s64 offen lds
  s_add_u32 m0, s63, 4096
  s_add_u32 s64, s62, 4096
  buffer_load_dwordx4 v2, s[32:35], s64 offen lds
  s_add_u32 m0, s63, 5120
  s_add_u32 s64, s62, 5120
  buffer_load_dwordx4 v2, s[32:35], s64 offen lds
  s_add_u32 m0, s63, 6144
  s_add_u32 s64, s62, 6144
  buffer_load_dwordx4 v2, s[32:35], s64 offen lds
  s_add_u32 m0, s63, 7168
  s_add_u32 s64, s62, 7168
  buffer_load_dwordx4 v2, s[32:35], s64 offen lds
  s_add_u32 m0, s63, 8192
  s_add_u32 s64, s62, 8192
  buffer_load_dwordx4 v2, s[32:35], s64 offen lds
  s_add_u32 m0, s63, 9216
  s_add_u32 s64, s62, 9216
  buffer_load_dwordx4 v2, s[32:35], s64 offen lds
  s_add_u32 m0, s63, 10240
  s_add_u32 s64, s62, 10240
  buffer_load_dwordx4 v2, s[32:35], s64 offen lds
  s_add_u32 m0, s63, 11264
  s_add_u32 s64, s62, 11264
  buffer_load_dwordx4 v2, s[32:35], s64 offen lds
  s_add_u32 m0, s63, 12288
  s_add_u32 s64, s62, 12288
  buffer_load_dwordx4 v2, s[32:35], s64 offen lds
  s_add_u32 m0, s63, 13312
  s_add_u32 s64, s62, 13312
  buffer_load_dwordx4 v2, s[32:35], s64 offen lds
  s_add_u32 m0, s63, 14336
  s_add_u32 s64, s62, 14336
  buffer_load_dwordx4 v2, s[32:35], s64 offen lds
  s_add_u32 m0, s63, 15360
  s_add_u32 s64, s62, 15360
  buffer_load_dwordx4 v2, s[32:35], s64 offen lds
  s_add_u32 m0, s63, 16384
  s_add_u32 s64, s62, 16384
  buffer_load_dwordx4 v2, s[32:35], s64 offen lds
  s_add_u32 m0, s63, 17408
  s_add_u32 s64, s62, 17408
  buffer_load_dwordx4 v2, s[32:35], s64 offen lds
  s_add_u32 m0, s63, 18432
  s_add_u32 s64, s62, 18432
  buffer_load_dwordx4 v2, s[32:35], s64 offen lds
  s_add_u32 m0, s63, 19456
  s_add_u32 s64, s62, 19456
  buffer_load_dwordx4 v2, s[32:35], s64 offen lds
  s_add_u32 m0, s63, 20480
  s_add_u32 s64, s62, 20480
  buffer_load_dwordx4 v2, s[32:35], s64 offen lds
  s_add_u32 m0, s63, 21504
  s_add_u32 s64, s62, 21504
  buffer_load_dwordx4 v2, s[32:35], s64 offen lds
  s_add_u32 m0, s63, 22528
  s_add_u32 s64, s62, 22528
  buffer_load_dwordx4 v2, s[32:35], s64 offen lds
  s_add_u32 m0, s63, 23552
  s_add_u32 s64, s62, 23552
  buffer_load_dwordx4 v2, s[32:35], s64 offen lds
  s_add_u32 m0, s63, 24576
  s_add_u32 s64, s62, 24576
  buffer_load_dwordx4 v2, s[32:35], s64 offen lds
  s_add_u32 m0, s63, 25600
  s_add_u32 s64, s62, 25600
  buffer_load_dwordx4 v2, s[32:35], s64 offen lds
  s_add_u32 m0, s63, 26624
  s_add_u32 s64, s62, 26624
  buffer_load_dwordx4 v2, s[32:35], s64 offen lds
  s_add_u32 m0, s63, 27648
  s_add_u32 s64, s62, 27648
  buffer_load_dwordx4 v2, s[32:35], s64 offen lds
  s_add_u32 m0, s63, 28672
  s_add_u32 s64, s62, 28672
  buffer_load_dwordx4 v2, s[32:35], s64 offen lds
  s_add_u32 m0, s63, 29696
  s_add_u32 s64, s62, 29696
  buffer_load_dwordx4 v2, s[32:35], s64 offen lds
  s_add_u32 m0, s63, 30720
  s_add_u32 s64, s62, 30720
  buffer_load_dwordx4 v2, s[32:35], s64 offen lds
  s_add_u32 m0, s63, 31744
  s_add_u32 s64, s62, 31744
  buffer_load_dwordx4 v2, s[32:35], s64 offen lds
  s_add_u32 m0, s63, 32768
  s_add_u32 s64, s62, 32768
  buffer_load_dwordx4 v2, s[32:35], s64 offen lds
  s_add_u32 m0, s63, 33792
  s_add_u32 s64, s62, 33792
  buffer_load_dwordx4 v2, s[32:35], s64 offen lds
  s_add_u32 m0, s63, 34816
  s_add_u32 s64, s62, 34816
  buffer_load_dwordx4 v2, s[32:35], s64 offen lds
  s_add_u32 m0, s63, 35840
  s_add_u32 s64, s62, 35840
  buffer_load_dwordx4 v2, s[32:35], s64 offen lds
  s_add_u32 m0, s63, 36864
  s_add_u32 s64, s62, 36864
  buffer_load_dwordx4 v2, s[32:35], s64 offen lds
  s_add_u32 m0, s63, 37888
  s_add_u32 s64, s62, 37888
  buffer_load_dwordx4 v2, s[32:35], s64 offen lds
  s_add_u32 m0, s63, 38912
  s_add_u32 s64, s62, 38912
  buffer_load_dwordx4 v2, s[32:35], s64 offen lds
.Lconcat_heads__mha_block__memory_aug_recurrent_mem_tr__prompt_kernelatt_q:
  v_lshlrev_b32 v2, 4, v1
  s_lshl_b32 s64, s60, 6
  s_lshl_b32 s65, s61, 3
  s_add_u32 s64, s64, s65
  s_lshl_b32 s65, s28, 1
  s_add_u32 s64, s64, s65
  s_mul_i32 s64, s64, 1152
  s_add_u32 s64, s64, 88080384
  s_add_u32 s65, s64, 1152
  v_and_b32 v5, 31, v1
  v_lshlrev_b32 v6, 2, v5
  buffer_load_dwordx4 v[8:11], v2, s[32:35], s64 offen
  buffer_load_dwordx4 v[12:15], v2, s[32:35], s65 offen
  buffer_load_dword v16, v6, s[32:35], s64 offen offset:1024
  buffer_load_dword v18, v6, s[32:35], s65 offen offset:1024
  v_lshlrev_b32 v3, 3, v5
  v_add_u32 v3, 1024, v3
  v_min_u32 v4, 18, v5
  v_lshlrev_b32 v4, 4, v4
  v_lshrrev_b32 v7, 5, v1
  v_mul_u32_u24 v7, 304, v7
  v_add_u32 v4, v4, v7
  v_add_u32 v4, 1280, v4
  v_mov_b32 v20, 0xff800000
  v_mov_b32 v21, 0xff800000
  v_mov_b32 v17, 0
  v_mov_b32 v19, 0
  v_mov_b32 v84, 0xff800000
  v_mov_b32 v85, 0xff800000
  v_mov_b32 v86, 0xff800000
  v_mov_b32 v87, 0xff800000
  v_mov_b32 v88, 0xff800000
  v_mov_b32 v89, 0xff800000
  v_mov_b32 v90, 0xff800000
  v_mov_b32 v91, 0xff800000
  v_mov_b32 v92, 0xff800000
  v_mov_b32 v93, 0xff800000
  v_mov_b32 v94, 0xff800000
  v_mov_b32 v95, 0xff800000
  v_mov_b32 v96, 0xff800000
  v_mov_b32 v97, 0xff800000
  v_mov_b32 v98, 0xff800000
  v_mov_b32 v99, 0xff800000
  v_mov_b32 v100, 0xff800000
  v_mov_b32 v101, 0xff800000
  v_mov_b32 v102, 0xff800000
  v_mov_b32 v103, 0xff800000
  v_mov_b32 v104, 0xff800000
  v_mov_b32 v105, 0xff800000
  v_mov_b32 v106, 0xff800000
  v_mov_b32 v107, 0xff800000
  v_mov_b32 v108, 0xff800000
  v_mov_b32 v109, 0xff800000
  v_mov_b32 v110, 0xff800000
  v_mov_b32 v111, 0xff800000
  v_mov_b32 v112, 0xff800000
  v_mov_b32 v113, 0xff800000
  v_mov_b32 v114, 0xff800000
  v_mov_b32 v115, 0xff800000
  s_waitcnt vmcnt(0)
  s_barrier
  v_cmp_gt_u32 vcc, 32, v1
  s_nop 1
  v_cndmask_b32 v16, 0, v16, vcc
  v_cndmask_b32 v18, 0, v18, vcc
  ds_read_b128 v[24:27], v2 offset:0
  ds_read_b64 v[32:33], v3 offset:0
  ds_read_b128 v[28:31], v2 offset:2496
  ds_read_b64 v[34:35], v3 offset:2496
  s_mov_b32 s66, 32
.Lconcat_heads__mha_block__memory_aug_recurrent_mem_tr__prompt_kernelatt_p1:
  s_waitcnt lgkmcnt(2)
  v_mfma_f32_32x32x16_bf16 v[52:67], v[24:27], v[8:11], 0
  v_mfma_f32_32x32x16_bf16 v[68:83], v[24:27], v[12:15], 0
  v_max3_f32 v20, v20, v84, v85
  v_max3_f32 v20, v20, v86, v87
  v_max3_f32 v20, v20, v88, v89
  v_max3_f32 v20, v20, v90, v91
  v_max3_f32 v20, v20, v92, v93
  v_max3_f32 v20, v20, v94, v95
  v_mfma_f32_32x32x8_bf16 v[52:67], v[32:33], v[16:17], v[52:67]
  v_max3_f32 v20, v20, v96, v97
  v_max3_f32 v20, v20, v98, v99
  v_max3_f32 v21, v21, v100, v101
  v_max3_f32 v21, v21, v102, v103
  v_max3_f32 v21, v21, v104, v105
  v_max3_f32 v21, v21, v106, v107
  v_mfma_f32_32x32x8_bf16 v[68:83], v[32:33], v[18:19], v[68:83]
  ds_read_b128 v[24:27], v2 offset:4992
  ds_read_b64 v[32:33], v3 offset:4992
  v_max3_f32 v21, v21, v108, v109
  v_max3_f32 v21, v21, v110, v111
  v_max3_f32 v21, v21, v112, v113
  v_max3_f32 v21, v21, v114, v115
  s_waitcnt lgkmcnt(2)
  v_mfma_f32_32x32x16_bf16 v[84:99], v[28:31], v[8:11], 0
  v_mfma_f32_32x32x16_bf16 v[100:115], v[28:31], v[12:15], 0
  v_max3_f32 v20, v20, v52, v53
  v_max3_f32 v20, v20, v54, v55
  v_max3_f32 v20, v20, v56, v57
  v_max3_f32 v20, v20, v58, v59
  v_max3_f32 v20, v20, v60, v61
  v_max3_f32 v20, v20, v62, v63
  v_mfma_f32_32x32x8_bf16 v[84:99], v[34:35], v[16:17], v[84:99]
  v_max3_f32 v20, v20, v64, v65
  v_max3_f32 v20, v20, v66, v67
  v_max3_f32 v21, v21, v68, v69
  v_max3_f32 v21, v21, v70, v71
  v_max3_f32 v21, v21, v72, v73
  v_max3_f32 v21, v21, v74, v75
  v_mfma_f32_32x32x8_bf16 v[100:115], v[34:35], v[18:19], v[100:115]
  ds_read_b128 v[28:31], v2 offset:7488
  ds_read_b64 v[34:35], v3 offset:7488
  v_max3_f32 v21, v21, v76, v77
  v_max3_f32 v21, v21, v78, v79
  v_max3_f32 v21, v21, v80, v81
  v_max3_f32 v21, v21, v82, v83
  v_add_u32 v2, 4992, v2
  v_add_u32 v3, 4992, v3
  s_sub_u32 s66, s66, 1
  s_cmp_lg_u32 s66, 0
  s_cbranch_scc1 .Lconcat_heads__mha_block__memory_aug_recurrent_mem_tr__prompt_kernelatt_p1
  s_nop 7
  s_nop 7
  v_max3_f32 v20, v20, v84, v85
  v_max3_f32 v20, v20, v86, v87
  v_max3_f32 v20, v20, v88, v89
  v_max3_f32 v20, v20, v90, v91
  v_max3_f32 v20, v20, v92, v93
  v_max3_f32 v20, v20, v94, v95
  v_max3_f32 v20, v20, v96, v97
  v_max3_f32 v20, v20, v98, v99
  v_max3_f32 v21, v21, v100, v101
  v_max3_f32 v21, v21, v102, v103
  v_max3_f32 v21, v21, v104, v105
  v_max3_f32 v21, v21, v106, v107
  v_max3_f32 v21, v21, v108, v109
  v_max3_f32 v21, v21, v110, v111
  v_max3_f32 v21, v21, v112, v113
  v_max3_f32 v21, v21, v114, v115
  v_subrev_u32 v2, 159744, v2
  v_subrev_u32 v3, 159744, v3
  s_waitcnt lgkmcnt(0)
  ds_read_b128 v[24:27], v2 offset:0
  ds_read_b64 v[32:33], v3 offset:0
  ds_read_b128 v[28:31], v2 offset:2496
  ds_read_b64 v[34:35], v3 offset:2496
  ds_read_b128 v[36:39], v4 offset:0
  ds_read_b128 v[40:43], v4 offset:608
  v_mov_b32 v5, v20
  s_nop 1
  v_permlane32_swap_b32 v20, v5
  v_max_f32 v20, v20, v5
  v_sub_f32 v20, 0, v20
  v_cvt_pk_bf16_f32 v5, v20, v20
  v_lshlrev_b32 v5, 16, v5
  v_sub_f32 v5, v20, v5
  v_cvt_pk_bf16_f32 v5, v20, v5
  v_cndmask_b32 v17, 0, v5, vcc
  v_mov_b32 v5, v21
  s_nop 1
  v_permlane32_swap_b32 v21, v5
  v_max_f32 v21, v21, v5
  v_sub_f32 v21, 0, v21
  v_cvt_pk_bf16_f32 v5, v21, v21
  v_lshlrev_b32 v5, 16, v5
  v_sub_f32 v5, v21, v5
  v_cvt_pk_bf16_f32 v5, v21, v5
  v_cndmask_b32 v19, 0, v5, vcc
  v_mov_b32 v132, 0
  v_mov_b32 v133, 0
  v_mov_b32 v134, 0
  v_mov_b32 v135, 0
  v_mov_b32 v136, 0
  v_mov_b32 v137, 0
  v_mov_b32 v138, 0
  v_mov_b32 v139, 0
  v_mov_b32 v140, 0
  v_mov_b32 v141, 0
  v_mov_b32 v142, 0
  v_mov_b32 v143, 0
  v_mov_b32 v144, 0
  v_mov_b32 v145, 0
  v_mov_b32 v146, 0
  v_mov_b32 v147, 0
  v_mov_b32 v148, 0
  v_mov_b32 v149, 0
  v_mov_b32 v150, 0
  v_mov_b32 v151, 0
  v_mov_b32 v152, 0
  v_mov_b32 v153, 0
  v_mov_b32 v154, 0
  v_mov_b32 v155, 0
  v_mov_b32 v156, 0
  v_mov_b32 v157, 0
  v_mov_b32 v158, 0
  v_mov_b32 v159, 0
  v_mov_b32 v160, 0
  v_mov_b32 v161, 0
  v_mov_b32 v162, 0
  v_mov_b32 v163, 0
  s_waitcnt lgkmcnt(4)
  v_mfma_f32_32x32x16_bf16 v[52:67], v[24:27], v[8:11], 0
  v_mfma_f32_32x32x16_bf16 v[68:83], v[24:27], v[12:15], 0
  v_mfma_f32_32x32x8_bf16 v[52:67], v[32:33], v[16:17], v[52:67]
  v_mfma_f32_32x32x8_bf16 v[68:83], v[32:33], v[18:19], v[68:83]
  ds_read_b128 v[24:27], v2 offset:4992
  ds_read_b64 v[32:33], v3 offset:4992
  s_mov_b32 s66, 32
  s_nop 7
  s_nop 3
.Lconcat_heads__mha_block__memory_aug_recurrent_mem_tr__prompt_kernelatt_p2:
  v_exp_f32 v52, v52
  v_exp_f32 v53, v53
  v_exp_f32 v54, v54
  v_exp_f32 v55, v55
  v_cvt_pk_bf16_f32 v116, v52, v53
  s_waitcnt lgkmcnt(4)
  v_mfma_f32_32x32x16_bf16 v[84:99], v[28:31], v[8:11], 0
  ds_read_b128 v[44:47], v4 offset:2496
  ds_read_b128 v[48:51], v4 offset:3104
  v_exp_f32 v56, v56
  v_exp_f32 v57, v57
  v_cvt_pk_bf16_f32 v117, v54, v55
  v_exp_f32 v58, v58
  v_exp_f32 v59, v59
  v_cvt_pk_bf16_f32 v118, v56, v57
  v_mfma_f32_32x32x16_bf16 v[100:115], v[28:31], v[12:15], 0
  v_exp_f32 v60, v60
  v_exp_f32 v61, v61
  v_cvt_pk_bf16_f32 v119, v58, v59
  v_exp_f32 v62, v62
  v_exp_f32 v63, v63
  v_cvt_pk_bf16_f32 v120, v60, v61
  s_waitcnt lgkmcnt(4)
  v_mfma_f32_32x32x16_bf16 v[132:147], v[36:39], v[116:119], v[132:147]
  v_exp_f32 v64, v64
  v_exp_f32 v65, v65
  v_cvt_pk_bf16_f32 v121, v62, v63
  v_exp_f32 v66, v66
  v_exp_f32 v67, v67
  v_cvt_pk_bf16_f32 v122, v64, v65
  v_mfma_f32_32x32x8_bf16 v[84:99], v[34:35], v[16:17], v[84:99]
  v_cvt_pk_bf16_f32 v123, v66, v67
  v_exp_f32 v68, v68
  v_exp_f32 v69, v69
  v_exp_f32 v70, v70
  v_exp_f32 v71, v71
  v_cvt_pk_bf16_f32 v124, v68, v69
  v_mfma_f32_32x32x16_bf16 v[132:147], v[40:43], v[120:123], v[132:147]
  v_exp_f32 v72, v72
  v_exp_f32 v73, v73
  v_cvt_pk_bf16_f32 v125, v70, v71
  v_exp_f32 v74, v74
  v_exp_f32 v75, v75
  v_cvt_pk_bf16_f32 v126, v72, v73
  v_mfma_f32_32x32x8_bf16 v[100:115], v[34:35], v[18:19], v[100:115]
  ds_read_b128 v[28:31], v2 offset:7488
  ds_read_b64 v[34:35], v3 offset:7488
  v_exp_f32 v76, v76
  v_exp_f32 v77, v77
  v_cvt_pk_bf16_f32 v127, v74, v75
  v_exp_f32 v78, v78
  v_exp_f32 v79, v79
  v_cvt_pk_bf16_f32 v128, v76, v77
  v_mfma_f32_32x32x16_bf16 v[148:163], v[36:39], v[124:127], v[148:163]
  v_exp_f32 v80, v80
  v_exp_f32 v81, v81
  v_cvt_pk_bf16_f32 v129, v78, v79
  v_exp_f32 v82, v82
  v_exp_f32 v83, v83
  v_cvt_pk_bf16_f32 v130, v80, v81
  v_cvt_pk_bf16_f32 v131, v82, v83
  s_nop 1
  v_mfma_f32_32x32x16_bf16 v[148:163], v[40:43], v[128:131], v[148:163]
  v_exp_f32 v84, v84
  v_exp_f32 v85, v85
  v_exp_f32 v86, v86
  v_exp_f32 v87, v87
  v_cvt_pk_bf16_f32 v116, v84, v85
  s_waitcnt lgkmcnt(4)
  v_mfma_f32_32x32x16_bf16 v[52:67], v[24:27], v[8:11], 0
  ds_read_b128 v[36:39], v4 offset:4992
  ds_read_b128 v[40:43], v4 offset:5600
  v_exp_f32 v88, v88
  v_exp_f32 v89, v89
  v_cvt_pk_bf16_f32 v117, v86, v87
  v_exp_f32 v90, v90
  v_exp_f32 v91, v91
  v_cvt_pk_bf16_f32 v118, v88, v89
  v_mfma_f32_32x32x16_bf16 v[68:83], v[24:27], v[12:15], 0
  v_exp_f32 v92, v92
  v_exp_f32 v93, v93
  v_cvt_pk_bf16_f32 v119, v90, v91
  v_exp_f32 v94, v94
  v_exp_f32 v95, v95
  v_cvt_pk_bf16_f32 v120, v92, v93
  s_waitcnt lgkmcnt(4)
  v_mfma_f32_32x32x16_bf16 v[132:147], v[44:47], v[116:119], v[132:147]
  v_exp_f32 v96, v96
  v_exp_f32 v97, v97
  v_cvt_pk_bf16_f32 v121, v94, v95
  v_exp_f32 v98, v98
  v_exp_f32 v99, v99
  v_cvt_pk_bf16_f32 v122, v96, v97
  v_mfma_f32_32x32x8_bf16 v[52:67], v[32:33], v[16:17], v[52:67]
  v_cvt_pk_bf16_f32 v123, v98, v99
  v_exp_f32 v100, v100
  v_exp_f32 v101, v101
  v_exp_f32 v102, v102
  v_exp_f32 v103, v103
  v_cvt_pk_bf16_f32 v124, v100, v101
  v_mfma_f32_32x32x16_bf16 v[132:147], v[48:51], v[120:123], v[132:147]
  v_exp_f32 v104, v104
  v_exp_f32 v105, v105
  v_cvt_pk_bf16_f32 v125, v102, v103
  v_exp_f32 v106, v106
  v_exp_f32 v107, v107
  v_cvt_pk_bf16_f32 v126, v104, v105
  v_mfma_f32_32x32x8_bf16 v[68:83], v[32:33], v[18:19], v[68:83]
  ds_read_b128 v[24:27], v2 offset:9984
  ds_read_b64 v[32:33], v3 offset:9984
  v_exp_f32 v108, v108
  v_exp_f32 v109, v109
  v_cvt_pk_bf16_f32 v127, v106, v107
  v_exp_f32 v110, v110
  v_exp_f32 v111, v111
  v_cvt_pk_bf16_f32 v128, v108, v109
  v_mfma_f32_32x32x16_bf16 v[148:163], v[44:47], v[124:127], v[148:163]
  v_exp_f32 v112, v112
  v_exp_f32 v113, v113
  v_cvt_pk_bf16_f32 v129, v110, v111
  v_exp_f32 v114, v114
  v_exp_f32 v115, v115
  v_cvt_pk_bf16_f32 v130, v112, v113
  v_cvt_pk_bf16_f32 v131, v114, v115
  s_nop 1
  v_mfma_f32_32x32x16_bf16 v[148:163], v[48:51], v[128:131], v[148:163]
  v_add_u32 v2, 4992, v2
  v_add_u32 v3, 4992, v3
  v_add_u32 v4, 4992, v4
  s_sub_u32 s66, s66, 1
  s_cmp_lg_u32 s66, 0
  s_cbranch_scc1 .Lconcat_heads__mha_block__memory_aug_recurrent_mem_tr__prompt_kernelatt_p2
  s_nop 7
  s_nop 7
  s_add_u32 s36, s26, 98566144
  s_addc_u32 s37, s27, 0
  s_mov_b32 s38, 2359296
  s_mov_b32 s39, 0x00020000
  s_lshl_b32 s64, s61, 3
  s_lshl_b32 s65, s28, 1
  s_add_u32 s64, s64, s65
  s_mul_i32 s64, s64, 36864
  s_mul_i32 s65, s60, 36
  s_add_u32 s64, s64, s65
  s_add_u32 s65, s64, 36864
  v_and_b32 v5, 31, v1
  v_mul_u32_u24 v5, 1152, v5
  v_lshrrev_b32 v6, 5, v1
  v_lshlrev_b32 v6, 4, v6
  v_add_u32 v6, v5, v6
  v_mov_b32 v7, v142
  s_nop 1
  v_permlane32_swap_b32 v142, v7
  v_rcp_f32 v7, v142
  s_nop 0
  v_mul_f32 v132, v132, v7
  v_mul_f32 v133, v133, v7
  v_mul_f32 v134, v134, v7
  v_mul_f32 v135, v135, v7
  v_mul_f32 v136, v136, v7
  v_mul_f32 v137, v137, v7
  v_mul_f32 v138, v138, v7
  v_mul_f32 v139, v139, v7
  v_mul_f32 v140, v140, v7
  v_mul_f32 v141, v141, v7
  v_cvt_pk_bf16_f32 v116, v132, v133
  v_cvt_pk_bf16_f32 v117, v134, v135
  v_cvt_pk_bf16_f32 v118, v136, v137
  v_cvt_pk_bf16_f32 v119, v138, v139
  v_cvt_pk_bf16_f32 v120, v140, v141
  s_nop 1
  v_permlane32_swap_b32 v116, v118
  v_permlane32_swap_b32 v117, v119
  buffer_store_dwordx4 v[116:119], v6, s[36:39], s64 offen sc1
  s_mov_b64 exec, 0xffffffff
  buffer_store_dword v120, v5, s[36:39], s64 offen offset:32 sc1
  s_mov_b64 exec, -1
  v_mov_b32 v7, v158
  s_nop 1
  v_permlane32_swap_b32 v158, v7
  v_rcp_f32 v7, v158
  s_nop 0
  v_mul_f32 v148, v148, v7
  v_mul_f32 v149, v149, v7
  v_mul_f32 v150, v150, v7
  v_mul_f32 v151, v151, v7
  v_mul_f32 v152, v152, v7
  v_mul_f32 v153, v153, v7
  v_mul_f32 v154, v154, v7
  v_mul_f32 v155, v155, v7
  v_mul_f32 v156, v156, v7
  v_mul_f32 v157, v157, v7
  v_cvt_pk_bf16_f32 v124, v148, v149
  v_cvt_pk_bf16_f32 v125, v150, v151
  v_cvt_pk_bf16_f32 v126, v152, v153
  v_cvt_pk_bf16_f32 v127, v154, v155
  v_cvt_pk_bf16_f32 v128, v156, v157
  s_nop 1
  v_permlane32_swap_b32 v124, v126
  v_permlane32_swap_b32 v125, v127
  buffer_store_dwordx4 v[124:127], v6, s[36:39], s65 offen sc1
  s_mov_b64 exec, 0xffffffff
  buffer_store_dword v128, v5, s[36:39], s65 offen offset:32 sc1
  s_mov_b64 exec, -1
  s_add_u32 s61, s61, 4
  s_sub_u32 s67, s67, 1
  s_cmp_lg_u32 s67, 0
  s_waitcnt lgkmcnt(0)
  s_cbranch_scc1 .Lconcat_heads__mha_block__memory_aug_recurrent_mem_tr__prompt_kernelatt_q
  s_waitcnt vmcnt(0) lgkmcnt(0)
  s_barrier
  s_lshl_b32 s60, s91, 2
  s_add_u32 s60, s60, 70025728
  s_cmp_lg_u32 s28, 0
  s_cbranch_scc1 .f115
  v_mov_b32 v250, 1
  s_mov_b64 exec, 1
  buffer_store_dword v250, off, s[32:35], s60 sc1
  s_mov_b64 exec, -1
.f115:
  s_cmp_ge_u32 s91, 48
  s_cbranch_scc1 .Lconcat_heads__mha_block__memory_aug_recurrent_mem_tr__prompt_kernel_end
  s_mov_b32 s29, s91
  s_cmp_lg_u32 s28, 0
  s_cbranch_scc1 .wp16
  v_lshlrev_b32 v248, 2, v1
  v_add_u32 v248, 70025728, v248
  s_mov_b32 s95, 4000000
  s_mov_b32 exec_lo, 0xffffffff
  s_mov_b32 exec_hi, 0xffffffff
.wm17:
  global_load_dword v251, v248, s[26:27] sc1
  s_waitcnt vmcnt(0)
  v_cmp_eq_u32 vcc, 0, v251
  s_cbranch_vccz .wm17_ok
  s_sleep 4
  s_sub_u32 s95, s95, 1
  s_cmp_lg_u32 s95, 0
  s_cbranch_scc1 .wm17
.wm17_ok:
  s_mov_b64 exec, -1
  v_add_u32 v248, 256, v248
  s_mov_b32 s95, 4000000
  s_mov_b32 exec_lo, 0xffffffff
  s_mov_b32 exec_hi, 0xffffffff
.wm18:
  global_load_dword v251, v248, s[26:27] sc1
  s_waitcnt vmcnt(0)
  v_cmp_eq_u32 vcc, 0, v251
  s_cbranch_vccz .wm18_ok
  s_sleep 4
  s_sub_u32 s95, s95, 1
  s_cmp_lg_u32 s95, 0
  s_cbranch_scc1 .wm18
.wm18_ok:
  s_mov_b64 exec, -1
  buffer_inv sc1
  s_waitcnt vmcnt(0)
.wp16:
  s_barrier
  s_mov_b32 s36, s8
  s_mov_b32 s37, s9
  s_mov_b32 s38, 663552
  s_mov_b32 s39, 0x00020000
  s_mov_b32 s40, s8
  s_mov_b32 s41, s9
  s_mov_b32 s42, 663552
  s_mov_b32 s43, 0x00020000
  s_mov_b32 s44, s22
  s_mov_b32 s45, s23
  s_mov_b32 s46, 4718592
  s_mov_b32 s47, 0x00020000
  s_add_u32 s32, s26, 98566144
  s_addc_u32 s33, s27, 0
  s_mov_b32 s34, 2359296
  s_mov_b32 s35, 0x00020000
  s_mul_i32 s61, s29, 43691
  s_lshr_b32 s61, s61, 17
  s_mul_i32 s60, s61, 3
  s_sub_u32 s60, s29, s60
  s_lshl_b32 s60, s60, 3
  s_lshl_b32 s62, s28, 1
  s_add_u32 s60, s60, s62
  s_mov_b32 s59, 1152
  s_lshl_b32 s57, s60, 6
  s_add_u32 s58, s57, 64
  s_mul_i32 s48, s61, 36864
  s_mov_b32 s49, 589824
  s_mov_b32 s50, 4
  s_mul_i32 s51, s61, 73728
  s_add_u32 s51, s51, s57
  s_add_u32 s52, s51, 64
  s_mov_b32 s53, 1179648
  s_cmp_lt_u32 s60, 18
  s_cselect_b32 s51, s51, 1073741824
  s_cselect_b32 s52, s52, 1073741824
  s_cselect_b32 s53, s53, 0
  s_cselect_b32 s57, s57, 0
  s_cselect_b32 s58, s58, 0
  s_mov_b32 s71, s53
  s_mul_i32 s54, s28, 36864
  v_lshrrev_b32 v19, 3, v1
  s_lshl_b32 s60, s28, 3
  v_add_u32 v19, s60, v19
  v_lshrrev_b32 v2, 1, v19
  v_and_b32 v2, 7, v2
  v_and_b32 v3, 7, v1
  v_xor_b32 v2, v2, v3
  v_lshlrev_b32 v2, 4, v2
  v_mul_u32_u24 v19, 1152, v19
  v_add_u32 v2, v2, v19
  v_lshrrev_b32 v19, 2, v1
  v_mul_lo_u32 v19, v19, s59
  v_and_b32 v3, 3, v1
  v_lshlrev_b32 v3, 4, v3
  v_add_u32 v3, v3, v19
  v_lshrrev_b32 v19, 5, v1
  v_lshlrev_b32 v4, 9, v19
  v_bfe_u32 v5, v1, 2, 2
  v_lshlrev_b32 v5, 6, v5
  v_add_u32 v4, v4, v5
  v_bfe_u32 v5, v1, 4, 1
  v_lshlrev_b32 v5, 5, v5
  v_add_u32 v4, v4, v5
  v_and_b32 v5, 3, v1
  v_lshlrev_b32 v5, 3, v5
  v_add_u32 v4, v4, v5
  v_add_u32 v4, s54, v4
  v_and_b32 v9, 31, v1
  v_lshrrev_b32 v10, 3, v9
  v_mul_u32_u24 v10, 36864, v10
  v_and_b32 v11, 7, v9
  v_lshlrev_b32 v11, 7, v11
  v_add_u32 v10, v10, v11
  v_lshrrev_b32 v11, 1, v9
  v_and_b32 v11, 7, v11
  v_add_u32 v12, 0, v19
  v_xor_b32 v12, v12, v11
  v_lshlrev_b32 v12, 4, v12
  v_add_u32 v5, v10, v12
  v_add_u32 v12, 2, v19
  v_xor_b32 v12, v12, v11
  v_lshlrev_b32 v12, 4, v12
  v_add_u32 v6, v10, v12
  v_add_u32 v12, 4, v19
  v_xor_b32 v12, v12, v11
  v_lshlrev_b32 v12, 4, v12
  v_add_u32 v7, v10, v12
  v_add_u32 v12, 6, v19
  v_xor_b32 v12, v12, v11
  v_lshlrev_b32 v12, 4, v12
  v_add_u32 v8, v10, v12
  v_and_b32 v19, 31, v1
  v_mul_u32_u24 v17, 2304, v19
  v_lshrrev_b32 v19, 5, v1
  v_lshlrev_b32 v19, 4, v19
  v_add_u32 v17, v17, v19
  v_and_b32 v19, 31, v1
  v_mul_u32_u24 v18, 2304, v19
  v_lshrrev_b32 v19, 5, v1
  v_lshlrev_b32 v19, 4, v19
  v_add_u32 v18, v18, v19
  s_mov_b32 s64, s50
  s_mov_b32 s65, 0
  s_mov_b32 s55, s54
  s_mul_i32 s63, s59, 16
  s_mul_i32 s62, s59, 0
  s_add_u32 s62, s62, s57
  s_add_u32 m0, s54, 0
  s_nop 0
  buffer_load_dwordx4 v3, s[36:39], s62 offen lds
  s_add_u32 m0, s54, 1024
  s_add_u32 s62, s62, s63
  buffer_load_dwordx4 v3, s[36:39], s62 offen lds
  s_add_u32 m0, s54, 2048
  s_add_u32 s62, s62, s63
  buffer_load_dwordx4 v3, s[36:39], s62 offen lds
  s_add_u32 m0, s54, 3072
  s_add_u32 s62, s62, s63
  buffer_load_dwordx4 v3, s[36:39], s62 offen lds
  s_add_u32 m0, s54, 4096
  s_add_u32 s62, s62, s63
  buffer_load_dwordx4 v3, s[36:39], s62 offen lds
  s_add_u32 m0, s54, 5120
  s_add_u32 s62, s62, s63
  buffer_load_dwordx4 v3, s[36:39], s62 offen lds
  s_add_u32 m0, s54, 6144
  s_add_u32 s62, s62, s63
  buffer_load_dwordx4 v3, s[36:39], s62 offen lds
  s_add_u32 m0, s54, 7168
  s_add_u32 s62, s62, s63
  buffer_load_dwordx4 v3, s[36:39], s62 offen lds
  s_add_u32 m0, s54, 8192
  s_add_u32 s62, s62, s63
  buffer_load_dwordx4 v3, s[36:39], s62 offen lds
  s_mul_i32 s62, s59, 144
  s_add_u32 s62, s62, s57
  s_add_u32 m0, s54, 9216
  s_nop 0
  buffer_load_dwordx4 v3, s[36:39], s62 offen lds
  s_add_u32 m0, s54, 10240
  s_add_u32 s62, s62, s63
  buffer_load_dwordx4 v3, s[36:39], s62 offen lds
  s_add_u32 m0, s54, 11264
  s_add_u32 s62, s62, s63
  buffer_load_dwordx4 v3, s[36:39], s62 offen lds
  s_add_u32 m0, s54, 12288
  s_add_u32 s62, s62, s63
  buffer_load_dwordx4 v3, s[36:39], s62 offen lds
  s_add_u32 m0, s54, 13312
  s_add_u32 s62, s62, s63
  buffer_load_dwordx4 v3, s[36:39], s62 offen lds
  s_add_u32 m0, s54, 14336
  s_add_u32 s62, s62, s63
  buffer_load_dwordx4 v3, s[36:39], s62 offen lds
  s_add_u32 m0, s54, 15360
  s_add_u32 s62, s62, s63
  buffer_load_dwordx4 v3, s[36:39], s62 offen lds
  s_add_u32 m0, s54, 16384
  s_add_u32 s62, s62, s63
  buffer_load_dwordx4 v3, s[36:39], s62 offen lds
  s_add_u32 m0, s54, 17408
  s_add_u32 s62, s62, s63
  buffer_load_dwordx4 v3, s[36:39], s62 offen lds
  s_mul_i32 s62, s59, 288
  s_add_u32 s62, s62, s57
  s_add_u32 m0, s54, 18432
  s_nop 0
  buffer_load_dwordx4 v3, s[36:39], s62 offen lds
  s_add_u32 m0, s54, 19456
  s_add_u32 s62, s62, s63
  buffer_load_dwordx4 v3, s[36:39], s62 offen lds
  s_add_u32 m0, s54, 20480
  s_add_u32 s62, s62, s63
  buffer_load_dwordx4 v3, s[36:39], s62 offen lds
  s_add_u32 m0, s54, 21504
  s_add_u32 s62, s62, s63
  buffer_load_dwordx4 v3, s[36:39], s62 offen lds
  s_add_u32 m0, s54, 22528
  s_add_u32 s62, s62, s63
  buffer_load_dwordx4 v3, s[36:39], s62 offen lds
  s_add_u32 m0, s54, 23552
  s_add_u32 s62, s62, s63
  buffer_load_dwordx4 v3, s[36:39], s62 offen lds
  s_add_u32 m0, s54, 24576
  s_add_u32 s62, s62, s63
  buffer_load_dwordx4 v3, s[36:39], s62 offen lds
  s_add_u32 m0, s54, 25600
  s_add_u32 s62, s62, s63
  buffer_load_dwordx4 v3, s[36:39], s62 offen lds
  s_add_u32 m0, s54, 26624
  s_add_u32 s62, s62, s63
  buffer_load_dwordx4 v3, s[36:39], s62 offen lds
  s_mul_i32 s62, s59, 432
  s_add_u32 s62, s62, s57
  s_add_u32 m0, s54, 27648
  s_nop 0
  buffer_load_dwordx4 v3, s[36:39], s62 offen lds
  s_add_u32 m0, s54, 28672
  s_add_u32 s62, s62, s63
  buffer_load_dwordx4 v3, s[36:39], s62 offen lds
  s_add_u32 m0, s54, 29696
  s_add_u32 s62, s62, s63
  buffer_load_dwordx4 v3, s[36:39], s62 offen lds
  s_add_u32 m0, s54, 30720
  s_add_u32 s62, s62, s63
  buffer_load_dwordx4 v3, s[36:39], s62 offen lds
  s_add_u32 m0, s54, 31744
  s_add_u32 s62, s62, s63
  buffer_load_dwordx4 v3, s[36:39], s62 offen lds
  s_add_u32 m0, s54, 32768
  s_add_u32 s62, s62, s63
  buffer_load_dwordx4 v3, s[36:39], s62 offen lds
  s_add_u32 m0, s54, 33792
  s_add_u32 s62, s62, s63
  buffer_load_dwordx4 v3, s[36:39], s62 offen lds
  s_add_u32 m0, s54, 34816
  s_add_u32 s62, s62, s63
  buffer_load_dwordx4 v3, s[36:39], s62 offen lds
  s_add_u32 m0, s54, 35840
  s_add_u32 s62, s62, s63
  buffer_load_dwordx4 v3, s[36:39], s62 offen lds
  s_waitcnt vmcnt(27)
  ds_read_b64_tr_b16 a[0:1], v4 offset:0
  ds_read_b64_tr_b16 a[2:3], v4 offset:256
  ds_read_b64_tr_b16 a[4:5], v4 offset:1024
  ds_read_b64_tr_b16 a[6:7], v4 offset:1280
  ds_read_b64_tr_b16 a[8:9], v4 offset:2048
  ds_read_b64_tr_b16 a[10:11], v4 offset:2304
  ds_read_b64_tr_b16 a[12:13], v4 offset:3072
  ds_read_b64_tr_b16 a[14:15], v4 offset:3328
  ds_read_b64_tr_b16 a[16:17], v4 offset:4096
  ds_read_b64_tr_b16 a[18:19], v4 offset:4352
  ds_read_b64_tr_b16 a[20:21], v4 offset:5120
  ds_read_b64_tr_b16 a[22:23], v4 offset:5376
  ds_read_b64_tr_b16 a[24:25], v4 offset:6144
  ds_read_b64_tr_b16 a[26:27], v4 offset:6400
  ds_read_b64_tr_b16 a[28:29], v4 offset:7168
  ds_read_b64_tr_b16 a[30:31], v4 offset:7424
  ds_read_b64_tr_b16 a[32:33], v4 offset:8192
  ds_read_b64_tr_b16 a[34:35], v4 offset:8448
  s_waitcnt lgkmcnt(0)
  s_mul_i32 s62, s59, 0
  s_add_u32 s62, s62, s58
  s_add_u32 m0, s54, 0
  s_nop 0
  buffer_load_dwordx4 v3, s[40:43], s62 offen lds
  s_add_u32 m0, s54, 1024
  s_add_u32 s62, s62, s63
  buffer_load_dwordx4 v3, s[40:43], s62 offen lds
  s_add_u32 m0, s54, 2048
  s_add_u32 s62, s62, s63
  buffer_load_dwordx4 v3, s[40:43], s62 offen lds
  s_add_u32 m0, s54, 3072
  s_add_u32 s62, s62, s63
  buffer_load_dwordx4 v3, s[40:43], s62 offen lds
  s_add_u32 m0, s54, 4096
  s_add_u32 s62, s62, s63
  buffer_load_dwordx4 v3, s[40:43], s62 offen lds
  s_add_u32 m0, s54, 5120
  s_add_u32 s62, s62, s63
  buffer_load_dwordx4 v3, s[40:43], s62 offen lds
  s_add_u32 m0, s54, 6144
  s_add_u32 s62, s62, s63
  buffer_load_dwordx4 v3, s[40:43], s62 offen lds
  s_add_u32 m0, s54, 7168
  s_add_u32 s62, s62, s63
  buffer_load_dwordx4 v3, s[40:43], s62 offen lds
  s_add_u32 m0, s54, 8192
  s_add_u32 s62, s62, s63
  buffer_load_dwordx4 v3, s[40:43], s62 offen lds
  s_waitcnt vmcnt(27)
  ds_read_b64_tr_b16 a[36:37], v4 offset:9216
  ds_read_b64_tr_b16 a[38:39], v4 offset:9472
  ds_read_b64_tr_b16 a[40:41], v4 offset:10240
  ds_read_b64_tr_b16 a[42:43], v4 offset:10496
  ds_read_b64_tr_b16 a[44:45], v4 offset:11264
  ds_read_b64_tr_b16 a[46:47], v4 offset:11520
  ds_read_b64_tr_b16 a[48:49], v4 offset:12288
  ds_read_b64_tr_b16 a[50:51], v4 offset:12544
  ds_read_b64_tr_b16 a[52:53], v4 offset:13312
  ds_read_b64_tr_b16 a[54:55], v4 offset:13568
  ds_read_b64_tr_b16 a[56:57], v4 offset:14336
  ds_read_b64_tr_b16 a[58:59], v4 offset:14592
  ds_read_b64_tr_b16 a[60:61], v4 offset:15360
  ds_read_b64_tr_b16 a[62:63], v4 offset:15616
  ds_read_b64_tr_b16 a[64:65], v4 offset:16384
  ds_read_b64_tr_b16 a[66:67], v4 offset:16640
  ds_read_b64_tr_b16 a[68:69], v4 offset:17408
  ds_read_b64_tr_b16 a[70:71], v4 offset:17664
  s_waitcnt lgkmcnt(0)
  s_mul_i32 s62, s59, 144
  s_add_u32 s62, s62, s58
  s_add_u32 m0, s54, 9216
  s_nop 0
  buffer_load_dwordx4 v3, s[40:43], s62 offen lds
  s_add_u32 m0, s54, 10240
  s_add_u32 s62, s62, s63
  buffer_load_dwordx4 v3, s[40:43], s62 offen lds
  s_add_u32 m0, s54, 11264
  s_add_u32 s62, s62, s63
  buffer_load_dwordx4 v3, s[40:43], s62 offen lds
  s_add_u32 m0, s54, 12288
  s_add_u32 s62, s62, s63
  buffer_load_dwordx4 v3, s[40:43], s62 offen lds
  s_add_u32 m0, s54, 13312
  s_add_u32 s62, s62, s63
  buffer_load_dwordx4 v3, s[40:43], s62 offen lds
  s_add_u32 m0, s54, 14336
  s_add_u32 s62, s62, s63
  buffer_load_dwordx4 v3, s[40:43], s62 offen lds
  s_add_u32 m0, s54, 15360
  s_add_u32 s62, s62, s63
  buffer_load_dwordx4 v3, s[40:43], s62 offen lds
  s_add_u32 m0, s54, 16384
  s_add_u32 s62, s62, s63
  buffer_load_dwordx4 v3, s[40:43], s62 offen lds
  s_add_u32 m0, s54, 17408
  s_add_u32 s62, s62, s63
  buffer_load_dwordx4 v3, s[40:43], s62 offen lds
  s_waitcnt vmcnt(27)
  ds_read_b64_tr_b16 a[72:73], v4 offset:18432
  ds_read_b64_tr_b16 a[74:75], v4 offset:18688
  ds_read_b64_tr_b16 a[76:77], v4 offset:19456
  ds_read_b64_tr_b16 a[78:79], v4 offset:19712
  ds_read_b64_tr_b16 a[80:81], v4 offset:20480
  ds_read_b64_tr_b16 a[82:83], v4 offset:20736
  ds_read_b64_tr_b16 a[84:85], v4 offset:21504
  ds_read_b64_tr_b16 a[86:87], v4 offset:21760
  ds_read_b64_tr_b16 a[88:89], v4 offset:22528
  ds_read_b64_tr_b16 a[90:91], v4 offset:22784
  ds_read_b64_tr_b16 a[92:93], v4 offset:23552
  ds_read_b64_tr_b16 a[94:95], v4 offset:23808
  ds_read_b64_tr_b16 a[96:97], v4 offset:24576
  ds_read_b64_tr_b16 a[98:99], v4 offset:24832
  ds_read_b64_tr_b16 a[100:101], v4 offset:25600
  ds_read_b64_tr_b16 a[102:103], v4 offset:25856
  ds_read_b64_tr_b16 a[104:105], v4 offset:26624
  ds_read_b64_tr_b16 a[106:107], v4 offset:26880
  s_waitcnt lgkmcnt(0)
  s_mul_i32 s62, s59, 288
  s_add_u32 s62, s62, s58
  s_add_u32 m0, s54, 18432
  s_nop 0
  buffer_load_dwordx4 v3, s[40:43], s62 offen lds
  s_add_u32 m0, s54, 19456
  s_add_u32 s62, s62, s63
  buffer_load_dwordx4 v3, s[40:43], s62 offen lds
  s_add_u32 m0, s54, 20480
  s_add_u32 s62, s62, s63
  buffer_load_dwordx4 v3, s[40:43], s62 offen lds
  s_add_u32 m0, s54, 21504
  s_add_u32 s62, s62, s63
  buffer_load_dwordx4 v3, s[40:43], s62 offen lds
  s_add_u32 m0, s54, 22528
  s_add_u32 s62, s62, s63
  buffer_load_dwordx4 v3, s[40:43], s62 offen lds
  s_add_u32 m0, s54, 23552
  s_add_u32 s62, s62, s63
  buffer_load_dwordx4 v3, s[40:43], s62 offen lds
  s_add_u32 m0, s54, 24576
  s_add_u32 s62, s62, s63
  buffer_load_dwordx4 v3, s[40:43], s62 offen lds
  s_add_u32 m0, s54, 25600
  s_add_u32 s62, s62, s63
  buffer_load_dwordx4 v3, s[40:43], s62 offen lds
  s_add_u32 m0, s54, 26624
  s_add_u32 s62, s62, s63
  buffer_load_dwordx4 v3, s[40:43], s62 offen lds
  s_waitcnt vmcnt(27)
  ds_read_b64_tr_b16 a[108:109], v4 offset:27648
  ds_read_b64_tr_b16 a[110:111], v4 offset:27904
  ds_read_b64_tr_b16 a[112:113], v4 offset:28672
  ds_read_b64_tr_b16 a[114:115], v4 offset:28928
  ds_read_b64_tr_b16 a[116:117], v4 offset:29696
  ds_read_b64_tr_b16 a[118:119], v4 offset:29952
  ds_read_b64_tr_b16 a[120:121], v4 offset:30720
  ds_read_b64_tr_b16 a[122:123], v4 offset:30976
  ds_read_b64_tr_b16 a[124:125], v4 offset:31744
  ds_read_b64_tr_b16 a[126:127], v4 offset:32000
  ds_read_b64_tr_b16 a[128:129], v4 offset:32768
  ds_read_b64_tr_b16 a[130:131], v4 offset:33024
  ds_read_b64_tr_b16 a[132:133], v4 offset:33792
  ds_read_b64_tr_b16 a[134:135], v4 offset:34048
  ds_read_b64_tr_b16 a[136:137], v4 offset:34816
  ds_read_b64_tr_b16 a[138:139], v4 offset:35072
  ds_read_b64_tr_b16 a[140:141], v4 offset:35840
  ds_read_b64_tr_b16 a[142:143], v4 offset:36096
  s_waitcnt lgkmcnt(0)
  s_mul_i32 s62, s59, 432
  s_add_u32 s62, s62, s58
  s_add_u32 m0, s54, 27648
  s_nop 0
  buffer_load_dwordx4 v3, s[40:43], s62 offen lds
  s_add_u32 m0, s54, 28672
  s_add_u32 s62, s62, s63
  buffer_load_dwordx4 v3, s[40:43], s62 offen lds
  s_add_u32 m0, s54, 29696
  s_add_u32 s62, s62, s63
  buffer_load_dwordx4 v3, s[40:43], s62 offen lds
  s_add_u32 m0, s54, 30720
  s_add_u32 s62, s62, s63
  buffer_load_dwordx4 v3, s[40:43], s62 offen lds
  s_add_u32 m0, s54, 31744
  s_add_u32 s62, s62, s63
  buffer_load_dwordx4 v3, s[40:43], s62 offen lds
  s_add_u32 m0, s54, 32768
  s_add_u32 s62, s62, s63
  buffer_load_dwordx4 v3, s[40:43], s62 offen lds
  s_add_u32 m0, s54, 33792
  s_add_u32 s62, s62, s63
  buffer_load_dwordx4 v3, s[40:43], s62 offen lds
  s_add_u32 m0, s54, 34816
  s_add_u32 s62, s62, s63
  buffer_load_dwordx4 v3, s[40:43], s62 offen lds
  s_add_u32 m0, s54, 35840
  s_add_u32 s62, s62, s63
  buffer_load_dwordx4 v3, s[40:43], s62 offen lds
  s_waitcnt vmcnt(27)
  ds_read_b64_tr_b16 a[144:145], v4 offset:0
  ds_read_b64_tr_b16 a[146:147], v4 offset:256
  ds_read_b64_tr_b16 a[148:149], v4 offset:1024
  ds_read_b64_tr_b16 a[150:151], v4 offset:1280
  ds_read_b64_tr_b16 a[152:153], v4 offset:2048
  ds_read_b64_tr_b16 a[154:155], v4 offset:2304
  ds_read_b64_tr_b16 a[156:157], v4 offset:3072
  ds_read_b64_tr_b16 a[158:159], v4 offset:3328
  ds_read_b64_tr_b16 a[160:161], v4 offset:4096
  ds_read_b64_tr_b16 a[162:163], v4 offset:4352
  ds_read_b64_tr_b16 a[164:165], v4 offset:5120
  ds_read_b64_tr_b16 a[166:167], v4 offset:5376
  ds_read_b64_tr_b16 a[168:169], v4 offset:6144
  ds_read_b64_tr_b16 a[170:171], v4 offset:6400
  ds_read_b64_tr_b16 a[172:173], v4 offset:7168
  ds_read_b64_tr_b16 a[174:175], v4 offset:7424
  ds_read_b64_tr_b16 a[176:177], v4 offset:8192
  ds_read_b64_tr_b16 a[178:179], v4 offset:8448
  s_waitcnt lgkmcnt(0)
  s_add_u32 m0, s55, 0
  s_nop 0
  buffer_load_dwordx4 v2, s[32:35], s48 offen offset:0 lds
  s_add_u32 m0, s55, 896
  s_nop 0
  buffer_load_dwordx4 v2, s[32:35], s48 offen offset:128 lds
  s_add_u32 m0, s55, 1792
  s_nop 0
  buffer_load_dwordx4 v2, s[32:35], s48 offen offset:256 lds
  s_add_u32 m0, s55, 2688
  s_nop 0
  buffer_load_dwordx4 v2, s[32:35], s48 offen offset:384 lds
  s_add_u32 m0, s55, 3584
  s_nop 0
  buffer_load_dwordx4 v2, s[32:35], s48 offen offset:512 lds
  s_add_u32 m0, s55, 4480
  s_nop 0
  buffer_load_dwordx4 v2, s[32:35], s48 offen offset:640 lds
  s_add_u32 m0, s55, 5376
  s_nop 0
  buffer_load_dwordx4 v2, s[32:35], s48 offen offset:768 lds
  s_add_u32 m0, s55, 6272
  s_nop 0
  buffer_load_dwordx4 v2, s[32:35], s48 offen offset:896 lds
  s_add_u32 m0, s55, 7168
  s_nop 0
  buffer_load_dwordx4 v2, s[32:35], s48 offen offset:1024 lds
  s_add_u32 s48, s48, s49
  s_sub_u32 s64, s64, 1
  s_cmp_gt_i32 s64, 0
  s_cselect_b32 s48, s48, 1073741824
  s_add_u32 s65, s65, 9216
  s_cmp_eq_u32 s65, 36864
  s_cselect_b32 s65, 0, s65
  s_add_u32 s55, s54, s65
  s_waitcnt vmcnt(27)
  ds_read_b64_tr_b16 a[180:181], v4 offset:9216
  ds_read_b64_tr_b16 a[182:183], v4 offset:9472
  ds_read_b64_tr_b16 a[184:185], v4 offset:10240
  ds_read_b64_tr_b16 a[186:187], v4 offset:10496
  ds_read_b64_tr_b16 a[188:189], v4 offset:11264
  ds_read_b64_tr_b16 a[190:191], v4 offset:11520
  ds_read_b64_tr_b16 a[192:193], v4 offset:12288
  ds_read_b64_tr_b16 a[194:195], v4 offset:12544
  ds_read_b64_tr_b16 a[196:197], v4 offset:13312
  ds_read_b64_tr_b16 a[198:199], v4 offset:13568
  ds_read_b64_tr_b16 a[200:201], v4 offset:14336
  ds_read_b64_tr_b16 a[202:203], v4 offset:14592
  ds_read_b64_tr_b16 a[204:205], v4 offset:15360
  ds_read_b64_tr_b16 a[206:207], v4 offset:15616
  ds_read_b64_tr_b16 a[208:209], v4 offset:16384
  ds_read_b64_tr_b16 a[210:211], v4 offset:16640
  ds_read_b64_tr_b16 a[212:213], v4 offset:17408
  ds_read_b64_tr_b16 a[214:215], v4 offset:17664
  s_waitcnt lgkmcnt(0)
  s_add_u32 m0, s55, 0
  s_nop 0
  buffer_load_dwordx4 v2, s[32:35], s48 offen offset:0 lds
  s_add_u32 m0, s55, 896
  s_nop 0
  buffer_load_dwordx4 v2, s[32:35], s48 offen offset:128 lds
  s_add_u32 m0, s55, 1792
  s_nop 0
  buffer_load_dwordx4 v2, s[32:35], s48 offen offset:256 lds
  s_add_u32 m0, s55, 2688
  s_nop 0
  buffer_load_dwordx4 v2, s[32:35], s48 offen offset:384 lds
  s_add_u32 m0, s55, 3584
  s_nop 0
  buffer_load_dwordx4 v2, s[32:35], s48 offen offset:512 lds
  s_add_u32 m0, s55, 4480
  s_nop 0
  buffer_load_dwordx4 v2, s[32:35], s48 offen offset:640 lds
  s_add_u32 m0, s55, 5376
  s_nop 0
  buffer_load_dwordx4 v2, s[32:35], s48 offen offset:768 lds
  s_add_u32 m0, s55, 6272
  s_nop 0
  buffer_load_dwordx4 v2, s[32:35], s48 offen offset:896 lds
  s_add_u32 m0, s55, 7168
  s_nop 0
  buffer_load_dwordx4 v2, s[32:35], s48 offen offset:1024 lds
  s_add_u32 s48, s48, s49
  s_sub_u32 s64, s64, 1
  s_cmp_gt_i32 s64, 0
  s_cselect_b32 s48, s48, 1073741824
  s_add_u32 s65, s65, 9216
  s_cmp_eq_u32 s65, 36864
  s_cselect_b32 s65, 0, s65
  s_add_u32 s55, s54, s65
  s_waitcnt vmcnt(27)
  ds_read_b64_tr_b16 a[216:217], v4 offset:18432
  ds_read_b64_tr_b16 a[218:219], v4 offset:18688
  ds_read_b64_tr_b16 a[220:221], v4 offset:19456
  ds_read_b64_tr_b16 a[222:223], v4 offset:19712
  ds_read_b64_tr_b16 a[224:225], v4 offset:20480
  ds_read_b64_tr_b16 a[226:227], v4 offset:20736
  ds_read_b64_tr_b16 a[228:229], v4 offset:21504
  ds_read_b64_tr_b16 a[230:231], v4 offset:21760
  ds_read_b64_tr_b16 a[232:233], v4 offset:22528
  ds_read_b64_tr_b16 a[234:235], v4 offset:22784
  ds_read_b64_tr_b16 a[236:237], v4 offset:23552
  ds_read_b64_tr_b16 a[238:239], v4 offset:23808
  ds_read_b64_tr_b16 a[240:241], v4 offset:24576
  ds_read_b64_tr_b16 a[242:243], v4 offset:24832
  ds_read_b64_tr_b16 a[244:245], v4 offset:25600
  ds_read_b64_tr_b16 a[246:247], v4 offset:25856
  ds_read_b64_tr_b16 a[248:249], v4 offset:26624
  ds_read_b64_tr_b16 a[250:251], v4 offset:26880
  s_waitcnt lgkmcnt(0)
  s_add_u32 m0, s55, 0
  s_nop 0
  buffer_load_dwordx4 v2, s[32:35], s48 offen offset:0 lds
  s_add_u32 m0, s55, 896
  s_nop 0
  buffer_load_dwordx4 v2, s[32:35], s48 offen offset:128 lds
  s_add_u32 m0, s55, 1792
  s_nop 0
  buffer_load_dwordx4 v2, s[32:35], s48 offen offset:256 lds
  s_add_u32 m0, s55, 2688
  s_nop 0
  buffer_load_dwordx4 v2, s[32:35], s48 offen offset:384 lds
  s_add_u32 m0, s55, 3584
  s_nop 0
  buffer_load_dwordx4 v2, s[32:35], s48 offen offset:512 lds
  s_add_u32 m0, s55, 4480
  s_nop 0
  buffer_load_dwordx4 v2, s[32:35], s48 offen offset:640 lds
  s_add_u32 m0, s55, 5376
  s_nop 0
  buffer_load_dwordx4 v2, s[32:35], s48 offen offset:768 lds
  s_add_u32 m0, s55, 6272
  s_nop 0
  buffer_load_dwordx4 v2, s[32:35], s48 offen offset:896 lds
  s_add_u32 m0, s55, 7168
  s_nop 0
  buffer_load_dwordx4 v2, s[32:35], s48 offen offset:1024 lds
  s_add_u32 s48, s48, s49
  s_sub_u32 s64, s64, 1
  s_cmp_gt_i32 s64, 0
  s_cselect_b32 s48, s48, 1073741824
  s_add_u32 s65, s65, 9216
  s_cmp_eq_u32 s65, 36864
  s_cselect_b32 s65, 0, s65
  s_add_u32 s55, s54, s65
  s_waitcnt vmcnt(27)
  ds_read_b64_tr_b16 a[252:253], v4 offset:27648
  ds_read_b64_tr_b16 a[254:255], v4 offset:27904
  ds_read_b64_tr_b16 v[124:125], v4 offset:28672
  ds_read_b64_tr_b16 v[126:127], v4 offset:28928
  ds_read_b64_tr_b16 v[128:129], v4 offset:29696
  ds_read_b64_tr_b16 v[130:131], v4 offset:29952
  ds_read_b64_tr_b16 v[132:133], v4 offset:30720
  ds_read_b64_tr_b16 v[134:135], v4 offset:30976
  ds_read_b64_tr_b16 v[136:137], v4 offset:31744
  ds_read_b64_tr_b16 v[138:139], v4 offset:32000
  ds_read_b64_tr_b16 v[140:141], v4 offset:32768
  ds_read_b64_tr_b16 v[142:143], v4 offset:33024
  ds_read_b64_tr_b16 v[144:145], v4 offset:33792
  ds_read_b64_tr_b16 v[146:147], v4 offset:34048
  ds_read_b64_tr_b16 v[148:149], v4 offset:34816
  ds_read_b64_tr_b16 v[150:151], v4 offset:35072
  ds_read_b64_tr_b16 v[152:153], v4 offset:35840
  ds_read_b64_tr_b16 v[154:155], v4 offset:36096
  s_waitcnt lgkmcnt(0)
  s_mov_b32 s61, s51
  s_mov_b32 s62, s52
  s_mov_b32 s51, 1073741824
  s_mov_b32 s52, 1073741824
  s_mov_b32 s56, 0
  v_mov_b32 v9, v5
  v_mov_b32 v10, v6
  v_mov_b32 v11, v7
  v_mov_b32 v12, v8
  s_waitcnt vmcnt(9)
  s_barrier
  ds_read_b128 v[20:23], v9 offset:0
  ds_read_b128 v[24:27], v10 offset:0
  ds_read_b128 v[28:31], v11 offset:0
  ds_read_b128 v[32:35], v12 offset:0
  ds_read_b128 v[36:39], v9 offset:1024
.Lconcat_heads__mha_block__memory_aug_recurrent_mem_tr__prompt_kernelaout_loop:
  ds_read_b128 v[40:43], v10 offset:1024
  s_waitcnt lgkmcnt(5)
  v_mfma_f32_32x32x16_bf16 v[60:75], a[0:3], v[20:23], 0
  s_add_u32 s56, s56, 9216
  s_cmp_eq_u32 s56, 36864
  s_cselect_b32 s56, 0, s56
  v_mfma_f32_32x32x16_bf16 v[76:91], a[144:147], v[20:23], 0
  v_add_u32 v13, s56, v5
  ds_read_b128 v[20:23], v11 offset:1024
  s_waitcnt lgkmcnt(5)
  v_mfma_f32_32x32x16_bf16 v[60:75], a[4:7], v[24:27], v[60:75]
  v_add_u32 v14, s56, v6
  v_mfma_f32_32x32x16_bf16 v[76:91], a[148:151], v[24:27], v[76:91]
  v_add_u32 v15, s56, v7
  ds_read_b128 v[24:27], v12 offset:1024
  s_waitcnt lgkmcnt(5)
  v_mfma_f32_32x32x16_bf16 v[60:75], a[8:11], v[28:31], v[60:75]
  v_add_u32 v16, s56, v8
  v_mfma_f32_32x32x16_bf16 v[76:91], a[152:155], v[28:31], v[76:91]
  v_cvt_pk_bf16_f32 v44, v92, v93
  ds_read_b128 v[28:31], v9 offset:2048
  s_waitcnt lgkmcnt(5)
  v_mfma_f32_32x32x16_bf16 v[60:75], a[12:15], v[32:35], v[60:75]
  v_cvt_pk_bf16_f32 v45, v94, v95
  v_mfma_f32_32x32x16_bf16 v[76:91], a[156:159], v[32:35], v[76:91]
  v_cvt_pk_bf16_f32 v46, v96, v97
  ds_read_b128 v[32:35], v10 offset:2048
  s_waitcnt lgkmcnt(5)
  v_mfma_f32_32x32x16_bf16 v[60:75], a[16:19], v[36:39], v[60:75]
  v_cvt_pk_bf16_f32 v47, v98, v99
  v_mfma_f32_32x32x16_bf16 v[76:91], a[160:163], v[36:39], v[76:91]
  v_cvt_pk_bf16_f32 v48, v100, v101
  ds_read_b128 v[36:39], v11 offset:2048
  s_waitcnt lgkmcnt(5)
  v_mfma_f32_32x32x16_bf16 v[60:75], a[20:23], v[40:43], v[60:75]
  v_cvt_pk_bf16_f32 v49, v102, v103
  v_mfma_f32_32x32x16_bf16 v[76:91], a[164:167], v[40:43], v[76:91]
  v_cvt_pk_bf16_f32 v50, v104, v105
  ds_read_b128 v[40:43], v12 offset:2048
  s_waitcnt lgkmcnt(5)
  v_mfma_f32_32x32x16_bf16 v[60:75], a[24:27], v[20:23], v[60:75]
  v_cvt_pk_bf16_f32 v51, v106, v107
  v_mfma_f32_32x32x16_bf16 v[76:91], a[168:171], v[20:23], v[76:91]
  s_nop 1
  ds_read_b128 v[20:23], v9 offset:3072
  s_waitcnt lgkmcnt(5)
  v_mfma_f32_32x32x16_bf16 v[60:75], a[28:31], v[24:27], v[60:75]
  v_permlane32_swap_b32 v44, v46
  v_mfma_f32_32x32x16_bf16 v[76:91], a[172:175], v[24:27], v[76:91]
  v_permlane32_swap_b32 v45, v47
  ds_read_b128 v[24:27], v10 offset:3072
  s_waitcnt lgkmcnt(5)
  v_mfma_f32_32x32x16_bf16 v[60:75], a[32:35], v[28:31], v[60:75]
  v_permlane32_swap_b32 v48, v50
  v_mfma_f32_32x32x16_bf16 v[76:91], a[176:179], v[28:31], v[76:91]
  v_permlane32_swap_b32 v49, v51
  ds_read_b128 v[28:31], v11 offset:3072
  s_waitcnt lgkmcnt(5)
  v_mfma_f32_32x32x16_bf16 v[60:75], a[36:39], v[32:35], v[60:75]
  buffer_store_dwordx4 v[44:47], v17, s[44:47], s51 offen offset:0
  v_mfma_f32_32x32x16_bf16 v[76:91], a[180:183], v[32:35], v[76:91]
  buffer_store_dwordx4 v[48:51], v17, s[44:47], s51 offen offset:32
  ds_read_b128 v[32:35], v12 offset:3072
  s_waitcnt lgkmcnt(5)
  v_mfma_f32_32x32x16_bf16 v[60:75], a[40:43], v[36:39], v[60:75]
  v_cvt_pk_bf16_f32 v52, v108, v109
  v_mfma_f32_32x32x16_bf16 v[76:91], a[184:187], v[36:39], v[76:91]
  v_cvt_pk_bf16_f32 v53, v110, v111
  ds_read_b128 v[36:39], v9 offset:4096
  s_waitcnt lgkmcnt(5)
  v_mfma_f32_32x32x16_bf16 v[60:75], a[44:47], v[40:43], v[60:75]
  v_cvt_pk_bf16_f32 v54, v112, v113
  v_mfma_f32_32x32x16_bf16 v[76:91], a[188:191], v[40:43], v[76:91]
  v_cvt_pk_bf16_f32 v55, v114, v115
  ds_read_b128 v[40:43], v10 offset:4096
  s_waitcnt lgkmcnt(5)
  v_mfma_f32_32x32x16_bf16 v[60:75], a[48:51], v[20:23], v[60:75]
  v_cvt_pk_bf16_f32 v56, v116, v117
  v_mfma_f32_32x32x16_bf16 v[76:91], a[192:195], v[20:23], v[76:91]
  v_cvt_pk_bf16_f32 v57, v118, v119
  ds_read_b128 v[20:23], v11 offset:4096
  s_waitcnt lgkmcnt(5)
  v_mfma_f32_32x32x16_bf16 v[60:75], a[52:55], v[24:27], v[60:75]
  v_cvt_pk_bf16_f32 v58, v120, v121
  v_mfma_f32_32x32x16_bf16 v[76:91], a[196:199], v[24:27], v[76:91]
  v_cvt_pk_bf16_f32 v59, v122, v123
  ds_read_b128 v[24:27], v12 offset:4096
  s_waitcnt lgkmcnt(5)
  v_mfma_f32_32x32x16_bf16 v[60:75], a[56:59], v[28:31], v[60:75]
  s_nop 1
  v_mfma_f32_32x32x16_bf16 v[76:91], a[200:203], v[28:31], v[76:91]
  v_permlane32_swap_b32 v52, v54
  ds_read_b128 v[28:31], v9 offset:5120
  s_waitcnt lgkmcnt(5)
  v_mfma_f32_32x32x16_bf16 v[60:75], a[60:63], v[32:35], v[60:75]
  v_permlane32_swap_b32 v53, v55
  v_mfma_f32_32x32x16_bf16 v[76:91], a[204:207], v[32:35], v[76:91]
  v_permlane32_swap_b32 v56, v58
  ds_read_b128 v[32:35], v10 offset:5120
  s_waitcnt lgkmcnt(5)
  v_mfma_f32_32x32x16_bf16 v[60:75], a[64:67], v[36:39], v[60:75]
  v_permlane32_swap_b32 v57, v59
  v_mfma_f32_32x32x16_bf16 v[76:91], a[208:211], v[36:39], v[76:91]
  buffer_store_dwordx4 v[52:55], v18, s[44:47], s52 offen offset:0
  ds_read_b128 v[36:39], v11 offset:5120
  s_waitcnt lgkmcnt(5)
  v_mfma_f32_32x32x16_bf16 v[60:75], a[68:71], v[40:43], v[60:75]
  buffer_store_dwordx4 v[56:59], v18, s[44:47], s52 offen offset:32
  v_mfma_f32_32x32x16_bf16 v[76:91], a[212:215], v[40:43], v[76:91]
  ds_read_b128 v[40:43], v12 offset:5120
  s_waitcnt lgkmcnt(5)
  v_mfma_f32_32x32x16_bf16 v[60:75], a[72:75], v[20:23], v[60:75]
  v_mfma_f32_32x32x16_bf16 v[76:91], a[216:219], v[20:23], v[76:91]
  ds_read_b128 v[20:23], v9 offset:6144
  s_waitcnt lgkmcnt(5)
  v_mfma_f32_32x32x16_bf16 v[60:75], a[76:79], v[24:27], v[60:75]
  v_mfma_f32_32x32x16_bf16 v[76:91], a[220:223], v[24:27], v[76:91]
  ds_read_b128 v[24:27], v10 offset:6144
  s_waitcnt lgkmcnt(5)
  v_mfma_f32_32x32x16_bf16 v[60:75], a[80:83], v[28:31], v[60:75]
  v_mfma_f32_32x32x16_bf16 v[76:91], a[224:227], v[28:31], v[76:91]
  ds_read_b128 v[28:31], v11 offset:6144
  s_waitcnt lgkmcnt(5)
  v_mfma_f32_32x32x16_bf16 v[60:75], a[84:87], v[32:35], v[60:75]
  v_mfma_f32_32x32x16_bf16 v[76:91], a[228:231], v[32:35], v[76:91]
  ds_read_b128 v[32:35], v12 offset:6144
  s_waitcnt lgkmcnt(5)
  v_mfma_f32_32x32x16_bf16 v[60:75], a[88:91], v[36:39], v[60:75]
  s_mov_b32 s51, s61
  s_mov_b32 s52, s62
  s_add_u32 s61, s61, s53
  s_add_u32 s62, s62, s71
  v_mfma_f32_32x32x16_bf16 v[76:91], a[232:235], v[36:39], v[76:91]
  s_waitcnt vmcnt(17)
  s_barrier
  ds_read_b128 v[36:39], v9 offset:7168
  s_waitcnt lgkmcnt(5)
  v_mfma_f32_32x32x16_bf16 v[60:75], a[92:95], v[40:43], v[60:75]
  v_mfma_f32_32x32x16_bf16 v[76:91], a[236:239], v[40:43], v[76:91]
  s_add_u32 m0, s55, 0
  ds_read_b128 v[40:43], v10 offset:7168
  s_waitcnt lgkmcnt(5)
  v_mfma_f32_32x32x16_bf16 v[60:75], a[96:99], v[20:23], v[60:75]
  buffer_load_dwordx4 v2, s[32:35], s48 offen offset:0 lds
  v_mfma_f32_32x32x16_bf16 v[76:91], a[240:243], v[20:23], v[76:91]
  s_add_u32 m0, s55, 896
  ds_read_b128 v[20:23], v11 offset:7168
  s_waitcnt lgkmcnt(5)
  v_mfma_f32_32x32x16_bf16 v[60:75], a[100:103], v[24:27], v[60:75]
  buffer_load_dwordx4 v2, s[32:35], s48 offen offset:128 lds
  v_mfma_f32_32x32x16_bf16 v[76:91], a[244:247], v[24:27], v[76:91]
  s_add_u32 m0, s55, 1792
  ds_read_b128 v[24:27], v12 offset:7168
  s_waitcnt lgkmcnt(5)
  v_mfma_f32_32x32x16_bf16 v[60:75], a[104:107], v[28:31], v[60:75]
  buffer_load_dwordx4 v2, s[32:35], s48 offen offset:256 lds
  v_mfma_f32_32x32x16_bf16 v[76:91], a[248:251], v[28:31], v[76:91]
  s_add_u32 m0, s55, 2688
  ds_read_b128 v[28:31], v9 offset:8192
  s_waitcnt lgkmcnt(5)
  v_mfma_f32_32x32x16_bf16 v[60:75], a[108:111], v[32:35], v[60:75]
  buffer_load_dwordx4 v2, s[32:35], s48 offen offset:384 lds
  v_mfma_f32_32x32x16_bf16 v[76:91], a[252:255], v[32:35], v[76:91]
  s_add_u32 m0, s55, 3584
  ds_read_b128 v[32:35], v10 offset:8192
  s_waitcnt lgkmcnt(5)
  v_mfma_f32_32x32x16_bf16 v[60:75], a[112:115], v[36:39], v[60:75]
  buffer_load_dwordx4 v2, s[32:35], s48 offen offset:512 lds
  v_mfma_f32_32x32x16_bf16 v[76:91], v[124:127], v[36:39], v[76:91]
  s_add_u32 m0, s55, 4480
  ds_read_b128 v[36:39], v11 offset:8192
  s_waitcnt lgkmcnt(5)
  v_mfma_f32_32x32x16_bf16 v[60:75], a[116:119], v[40:43], v[60:75]
  buffer_load_dwordx4 v2, s[32:35], s48 offen offset:640 lds
  v_mfma_f32_32x32x16_bf16 v[76:91], v[128:131], v[40:43], v[76:91]
  s_add_u32 m0, s55, 5376
  ds_read_b128 v[40:43], v12 offset:8192
  s_waitcnt lgkmcnt(5)
  v_mfma_f32_32x32x16_bf16 v[60:75], a[120:123], v[20:23], v[60:75]
  buffer_load_dwordx4 v2, s[32:35], s48 offen offset:768 lds
  v_mfma_f32_32x32x16_bf16 v[76:91], v[132:135], v[20:23], v[76:91]
  s_add_u32 m0, s55, 6272
  ds_read_b128 v[20:23], v13 offset:0
  s_waitcnt lgkmcnt(5)
  v_mfma_f32_32x32x16_bf16 v[60:75], a[124:127], v[24:27], v[60:75]
  buffer_load_dwordx4 v2, s[32:35], s48 offen offset:896 lds
  v_mfma_f32_32x32x16_bf16 v[76:91], v[136:139], v[24:27], v[76:91]
  s_add_u32 m0, s55, 7168
  ds_read_b128 v[24:27], v14 offset:0
  s_waitcnt lgkmcnt(5)
  v_mfma_f32_32x32x16_bf16 v[60:75], a[128:131], v[28:31], v[60:75]
  buffer_load_dwordx4 v2, s[32:35], s48 offen offset:1024 lds
  v_mfma_f32_32x32x16_bf16 v[76:91], v[140:143], v[28:31], v[76:91]
  ds_read_b128 v[28:31], v15 offset:0
  s_waitcnt lgkmcnt(5)
  v_mfma_f32_32x32x16_bf16 v[60:75], a[132:135], v[32:35], v[60:75]
  s_add_u32 s48, s48, s49
  s_sub_u32 s64, s64, 1
  s_cmp_gt_i32 s64, 0
  s_cselect_b32 s48, s48, 1073741824
  s_add_u32 s65, s65, 9216
  s_cmp_eq_u32 s65, 36864
  s_cselect_b32 s65, 0, s65
  s_add_u32 s55, s54, s65
  v_mfma_f32_32x32x16_bf16 v[76:91], v[144:147], v[32:35], v[76:91]
  ds_read_b128 v[32:35], v16 offset:0
  s_waitcnt lgkmcnt(5)
  v_mfma_f32_32x32x16_bf16 v[60:75], a[136:139], v[36:39], v[60:75]
  v_mfma_f32_32x32x16_bf16 v[76:91], v[148:151], v[36:39], v[76:91]
  ds_read_b128 v[36:39], v13 offset:1024
  s_waitcnt lgkmcnt(5)
  v_mfma_f32_32x32x16_bf16 v[60:75], a[140:143], v[40:43], v[60:75]
  v_mfma_f32_32x32x16_bf16 v[76:91], v[152:155], v[40:43], v[76:91]
  s_sub_u32 s50, s50, 1
  s_cmp_eq_u32 s50, 0
  s_cbranch_scc1 .Lconcat_heads__mha_block__memory_aug_recurrent_mem_tr__prompt_kernelaout_tail0
  ds_read_b128 v[40:43], v14 offset:1024
  s_waitcnt lgkmcnt(5)
  v_mfma_f32_32x32x16_bf16 v[92:107], a[0:3], v[20:23], 0
  s_add_u32 s56, s56, 9216
  s_cmp_eq_u32 s56, 36864
  s_cselect_b32 s56, 0, s56
  v_mfma_f32_32x32x16_bf16 v[108:123], a[144:147], v[20:23], 0
  v_add_u32 v9, s56, v5
  ds_read_b128 v[20:23], v15 offset:1024
  s_waitcnt lgkmcnt(5)
  v_mfma_f32_32x32x16_bf16 v[92:107], a[4:7], v[24:27], v[92:107]
  v_add_u32 v10, s56, v6
  v_mfma_f32_32x32x16_bf16 v[108:123], a[148:151], v[24:27], v[108:123]
  v_add_u32 v11, s56, v7
  ds_read_b128 v[24:27], v16 offset:1024
  s_waitcnt lgkmcnt(5)
  v_mfma_f32_32x32x16_bf16 v[92:107], a[8:11], v[28:31], v[92:107]
  v_add_u32 v12, s56, v8
  v_mfma_f32_32x32x16_bf16 v[108:123], a[152:155], v[28:31], v[108:123]
  v_cvt_pk_bf16_f32 v44, v60, v61
  ds_read_b128 v[28:31], v13 offset:2048
  s_waitcnt lgkmcnt(5)
  v_mfma_f32_32x32x16_bf16 v[92:107], a[12:15], v[32:35], v[92:107]
  v_cvt_pk_bf16_f32 v45, v62, v63
  v_mfma_f32_32x32x16_bf16 v[108:123], a[156:159], v[32:35], v[108:123]
  v_cvt_pk_bf16_f32 v46, v64, v65
  ds_read_b128 v[32:35], v14 offset:2048
  s_waitcnt lgkmcnt(5)
  v_mfma_f32_32x32x16_bf16 v[92:107], a[16:19], v[36:39], v[92:107]
  v_cvt_pk_bf16_f32 v47, v66, v67
  v_mfma_f32_32x32x16_bf16 v[108:123], a[160:163], v[36:39], v[108:123]
  v_cvt_pk_bf16_f32 v48, v68, v69
  ds_read_b128 v[36:39], v15 offset:2048
  s_waitcnt lgkmcnt(5)
  v_mfma_f32_32x32x16_bf16 v[92:107], a[20:23], v[40:43], v[92:107]
  v_cvt_pk_bf16_f32 v49, v70, v71
  v_mfma_f32_32x32x16_bf16 v[108:123], a[164:167], v[40:43], v[108:123]
  v_cvt_pk_bf16_f32 v50, v72, v73
  ds_read_b128 v[40:43], v16 offset:2048
  s_waitcnt lgkmcnt(5)
  v_mfma_f32_32x32x16_bf16 v[92:107], a[24:27], v[20:23], v[92:107]
  v_cvt_pk_bf16_f32 v51, v74, v75
  v_mfma_f32_32x32x16_bf16 v[108:123], a[168:171], v[20:23], v[108:123]
  s_nop 1
  ds_read_b128 v[20:23], v13 offset:3072
  s_waitcnt lgkmcnt(5)
  v_mfma_f32_32x32x16_bf16 v[92:107], a[28:31], v[24:27], v[92:107]
  v_permlane32_swap_b32 v44, v46
  v_mfma_f32_32x32x16_bf16 v[108:123], a[172:175], v[24:27], v[108:123]
  v_permlane32_swap_b32 v45, v47
  ds_read_b128 v[24:27], v14 offset:3072
  s_waitcnt lgkmcnt(5)
  v_mfma_f32_32x32x16_bf16 v[92:107], a[32:35], v[28:31], v[92:107]
  v_permlane32_swap_b32 v48, v50
  v_mfma_f32_32x32x16_bf16 v[108:123], a[176:179], v[28:31], v[108:123]
  v_permlane32_swap_b32 v49, v51
  ds_read_b128 v[28:31], v15 offset:3072
  s_waitcnt lgkmcnt(5)
  v_mfma_f32_32x32x16_bf16 v[92:107], a[36:39], v[32:35], v[92:107]
  buffer_store_dwordx4 v[44:47], v17, s[44:47], s51 offen offset:0
  v_mfma_f32_32x32x16_bf16 v[108:123], a[180:183], v[32:35], v[108:123]
  buffer_store_dwordx4 v[48:51], v17, s[44:47], s51 offen offset:32
  ds_read_b128 v[32:35], v16 offset:3072
  s_waitcnt lgkmcnt(5)
  v_mfma_f32_32x32x16_bf16 v[92:107], a[40:43], v[36:39], v[92:107]
  v_cvt_pk_bf16_f32 v52, v76, v77
  v_mfma_f32_32x32x16_bf16 v[108:123], a[184:187], v[36:39], v[108:123]
  v_cvt_pk_bf16_f32 v53, v78, v79
  ds_read_b128 v[36:39], v13 offset:4096
  s_waitcnt lgkmcnt(5)
  v_mfma_f32_32x32x16_bf16 v[92:107], a[44:47], v[40:43], v[92:107]
  v_cvt_pk_bf16_f32 v54, v80, v81
  v_mfma_f32_32x32x16_bf16 v[108:123], a[188:191], v[40:43], v[108:123]
  v_cvt_pk_bf16_f32 v55, v82, v83
  ds_read_b128 v[40:43], v14 offset:4096
  s_waitcnt lgkmcnt(5)
  v_mfma_f32_32x32x16_bf16 v[92:107], a[48:51], v[20:23], v[92:107]
  v_cvt_pk_bf16_f32 v56, v84, v85
  v_mfma_f32_32x32x16_bf16 v[108:123], a[192:195], v[20:23], v[108:123]
  v_cvt_pk_bf16_f32 v57, v86, v87
  ds_read_b128 v[20:23], v15 offset:4096
  s_waitcnt lgkmcnt(5)
  v_mfma_f32_32x32x16_bf16 v[92:107], a[52:55], v[24:27], v[92:107]
  v_cvt_pk_bf16_f32 v58, v88, v89
  v_mfma_f32_32x32x16_bf16 v[108:123], a[196:199], v[24:27], v[108:123]
  v_cvt_pk_bf16_f32 v59, v90, v91
  ds_read_b128 v[24:27], v16 offset:4096
  s_waitcnt lgkmcnt(5)
  v_mfma_f32_32x32x16_bf16 v[92:107], a[56:59], v[28:31], v[92:107]
  s_nop 1
  v_mfma_f32_32x32x16_bf16 v[108:123], a[200:203], v[28:31], v[108:123]
  v_permlane32_swap_b32 v52, v54
  ds_read_b128 v[28:31], v13 offset:5120
  s_waitcnt lgkmcnt(5)
  v_mfma_f32_32x32x16_bf16 v[92:107], a[60:63], v[32:35], v[92:107]
  v_permlane32_swap_b32 v53, v55
  v_mfma_f32_32x32x16_bf16 v[108:123], a[204:207], v[32:35], v[108:123]
  v_permlane32_swap_b32 v56, v58
  ds_read_b128 v[32:35], v14 offset:5120
  s_waitcnt lgkmcnt(5)
  v_mfma_f32_32x32x16_bf16 v[92:107], a[64:67], v[36:39], v[92:107]
  v_permlane32_swap_b32 v57, v59
  v_mfma_f32_32x32x16_bf16 v[108:123], a[208:211], v[36:39], v[108:123]
  buffer_store_dwordx4 v[52:55], v18, s[44:47], s52 offen offset:0
  ds_read_b128 v[36:39], v15 offset:5120
  s_waitcnt lgkmcnt(5)
  v_mfma_f32_32x32x16_bf16 v[92:107], a[68:71], v[40:43], v[92:107]
  buffer_store_dwordx4 v[56:59], v18, s[44:47], s52 offen offset:32
  v_mfma_f32_32x32x16_bf16 v[108:123], a[212:215], v[40:43], v[108:123]
  ds_read_b128 v[40:43], v16 offset:5120
  s_waitcnt lgkmcnt(5)
  v_mfma_f32_32x32x16_bf16 v[92:107], a[72:75], v[20:23], v[92:107]
  v_mfma_f32_32x32x16_bf16 v[108:123], a[216:219], v[20:23], v[108:123]
  ds_read_b128 v[20:23], v13 offset:6144
  s_waitcnt lgkmcnt(5)
  v_mfma_f32_32x32x16_bf16 v[92:107], a[76:79], v[24:27], v[92:107]
  v_mfma_f32_32x32x16_bf16 v[108:123], a[220:223], v[24:27], v[108:123]
  ds_read_b128 v[24:27], v14 offset:6144
  s_waitcnt lgkmcnt(5)
  v_mfma_f32_32x32x16_bf16 v[92:107], a[80:83], v[28:31], v[92:107]
  v_mfma_f32_32x32x16_bf16 v[108:123], a[224:227], v[28:31], v[108:123]
  ds_read_b128 v[28:31], v15 offset:6144
  s_waitcnt lgkmcnt(5)
  v_mfma_f32_32x32x16_bf16 v[92:107], a[84:87], v[32:35], v[92:107]
  v_mfma_f32_32x32x16_bf16 v[108:123], a[228:231], v[32:35], v[108:123]
  ds_read_b128 v[32:35], v16 offset:6144
  s_waitcnt lgkmcnt(5)
  v_mfma_f32_32x32x16_bf16 v[92:107], a[88:91], v[36:39], v[92:107]
  s_mov_b32 s51, s61
  s_mov_b32 s52, s62
  s_add_u32 s61, s61, s53
  s_add_u32 s62, s62, s71
  v_mfma_f32_32x32x16_bf16 v[108:123], a[232:235], v[36:39], v[108:123]
  s_waitcnt vmcnt(17)
  s_barrier
  ds_read_b128 v[36:39], v13 offset:7168
  s_waitcnt lgkmcnt(5)
  v_mfma_f32_32x32x16_bf16 v[92:107], a[92:95], v[40:43], v[92:107]
  v_mfma_f32_32x32x16_bf16 v[108:123], a[236:239], v[40:43], v[108:123]
  s_add_u32 m0, s55, 0
  ds_read_b128 v[40:43], v14 offset:7168
  s_waitcnt lgkmcnt(5)
  v_mfma_f32_32x32x16_bf16 v[92:107], a[96:99], v[20:23], v[92:107]
  buffer_load_dwordx4 v2, s[32:35], s48 offen offset:0 lds
  v_mfma_f32_32x32x16_bf16 v[108:123], a[240:243], v[20:23], v[108:123]
  s_add_u32 m0, s55, 896
  ds_read_b128 v[20:23], v15 offset:7168
  s_waitcnt lgkmcnt(5)
  v_mfma_f32_32x32x16_bf16 v[92:107], a[100:103], v[24:27], v[92:107]
  buffer_load_dwordx4 v2, s[32:35], s48 offen offset:128 lds
  v_mfma_f32_32x32x16_bf16 v[108:123], a[244:247], v[24:27], v[108:123]
  s_add_u32 m0, s55, 1792
  ds_read_b128 v[24:27], v16 offset:7168
  s_waitcnt lgkmcnt(5)
  v_mfma_f32_32x32x16_bf16 v[92:107], a[104:107], v[28:31], v[92:107]
  buffer_load_dwordx4 v2, s[32:35], s48 offen offset:256 lds
  v_mfma_f32_32x32x16_bf16 v[108:123], a[248:251], v[28:31], v[108:123]
  s_add_u32 m0, s55, 2688
  ds_read_b128 v[28:31], v13 offset:8192
  s_waitcnt lgkmcnt(5)
  v_mfma_f32_32x32x16_bf16 v[92:107], a[108:111], v[32:35], v[92:107]
  buffer_load_dwordx4 v2, s[32:35], s48 offen offset:384 lds
  v_mfma_f32_32x32x16_bf16 v[108:123], a[252:255], v[32:35], v[108:123]
  s_add_u32 m0, s55, 3584
  ds_read_b128 v[32:35], v14 offset:8192
  s_waitcnt lgkmcnt(5)
  v_mfma_f32_32x32x16_bf16 v[92:107], a[112:115], v[36:39], v[92:107]
  buffer_load_dwordx4 v2, s[32:35], s48 offen offset:512 lds
  v_mfma_f32_32x32x16_bf16 v[108:123], v[124:127], v[36:39], v[108:123]
  s_add_u32 m0, s55, 4480
  ds_read_b128 v[36:39], v15 offset:8192
  s_waitcnt lgkmcnt(5)
  v_mfma_f32_32x32x16_bf16 v[92:107], a[116:119], v[40:43], v[92:107]
  buffer_load_dwordx4 v2, s[32:35], s48 offen offset:640 lds
  v_mfma_f32_32x32x16_bf16 v[108:123], v[128:131], v[40:43], v[108:123]
  s_add_u32 m0, s55, 5376
  ds_read_b128 v[40:43], v16 offset:8192
  s_waitcnt lgkmcnt(5)
  v_mfma_f32_32x32x16_bf16 v[92:107], a[120:123], v[20:23], v[92:107]
  buffer_load_dwordx4 v2, s[32:35], s48 offen offset:768 lds
  v_mfma_f32_32x32x16_bf16 v[108:123], v[132:135], v[20:23], v[108:123]
  s_add_u32 m0, s55, 6272
  ds_read_b128 v[20:23], v9 offset:0
  s_waitcnt lgkmcnt(5)
  v_mfma_f32_32x32x16_bf16 v[92:107], a[124:127], v[24:27], v[92:107]
  buffer_load_dwordx4 v2, s[32:35], s48 offen offset:896 lds
  v_mfma_f32_32x32x16_bf16 v[108:123], v[136:139], v[24:27], v[108:123]
  s_add_u32 m0, s55, 7168
  ds_read_b128 v[24:27], v10 offset:0
  s_waitcnt lgkmcnt(5)
  v_mfma_f32_32x32x16_bf16 v[92:107], a[128:131], v[28:31], v[92:107]
  buffer_load_dwordx4 v2, s[32:35], s48 offen offset:1024 lds
  v_mfma_f32_32x32x16_bf16 v[108:123], v[140:143], v[28:31], v[108:123]
  ds_read_b128 v[28:31], v11 offset:0
  s_waitcnt lgkmcnt(5)
  v_mfma_f32_32x32x16_bf16 v[92:107], a[132:135], v[32:35], v[92:107]
  s_add_u32 s48, s48, s49
  s_sub_u32 s64, s64, 1
  s_cmp_gt_i32 s64, 0
  s_cselect_b32 s48, s48, 1073741824
  s_add_u32 s65, s65, 9216
  s_cmp_eq_u32 s65, 36864
  s_cselect_b32 s65, 0, s65
  s_add_u32 s55, s54, s65
  v_mfma_f32_32x32x16_bf16 v[108:123], v[144:147], v[32:35], v[108:123]
  ds_read_b128 v[32:35], v12 offset:0
  s_waitcnt lgkmcnt(5)
  v_mfma_f32_32x32x16_bf16 v[92:107], a[136:139], v[36:39], v[92:107]
  v_mfma_f32_32x32x16_bf16 v[108:123], v[148:151], v[36:39], v[108:123]
  ds_read_b128 v[36:39], v9 offset:1024
  s_waitcnt lgkmcnt(5)
  v_mfma_f32_32x32x16_bf16 v[92:107], a[140:143], v[40:43], v[92:107]
  v_mfma_f32_32x32x16_bf16 v[108:123], v[152:155], v[40:43], v[108:123]
  s_sub_u32 s50, s50, 1
  s_cmp_lg_u32 s50, 0
  s_cbranch_scc1 .Lconcat_heads__mha_block__memory_aug_recurrent_mem_tr__prompt_kernelaout_loop
.Lconcat_heads__mha_block__memory_aug_recurrent_mem_tr__prompt_kernelaout_tail1:
  s_nop 7
  s_nop 7
  v_cvt_pk_bf16_f32 v44, v92, v93
  v_cvt_pk_bf16_f32 v45, v94, v95
  v_cvt_pk_bf16_f32 v46, v96, v97
  v_cvt_pk_bf16_f32 v47, v98, v99
  v_cvt_pk_bf16_f32 v48, v100, v101
  v_cvt_pk_bf16_f32 v49, v102, v103
  v_cvt_pk_bf16_f32 v50, v104, v105
  v_cvt_pk_bf16_f32 v51, v106, v107
  s_nop 1
  v_permlane32_swap_b32 v44, v46
  v_permlane32_swap_b32 v45, v47
  v_permlane32_swap_b32 v48, v50
  v_permlane32_swap_b32 v49, v51
  buffer_store_dwordx4 v[44:47], v17, s[44:47], s51 offen offset:0
  buffer_store_dwordx4 v[48:51], v17, s[44:47], s51 offen offset:32
  v_cvt_pk_bf16_f32 v52, v108, v109
  v_cvt_pk_bf16_f32 v53, v110, v111
  v_cvt_pk_bf16_f32 v54, v112, v113
  v_cvt_pk_bf16_f32 v55, v114, v115
  v_cvt_pk_bf16_f32 v56, v116, v117
  v_cvt_pk_bf16_f32 v57, v118, v119
  v_cvt_pk_bf16_f32 v58, v120, v121
  v_cvt_pk_bf16_f32 v59, v122, v123
  s_nop 1
  v_permlane32_swap_b32 v52, v54
  v_permlane32_swap_b32 v53, v55
  v_permlane32_swap_b32 v56, v58
  v_permlane32_swap_b32 v57, v59
  buffer_store_dwordx4 v[52:55], v18, s[44:47], s52 offen offset:0
  buffer_store_dwordx4 v[56:59], v18, s[44:47], s52 offen offset:32
  s_branch .Lconcat_heads__mha_block__memory_aug_recurrent_mem_tr__prompt_kernelaout_done
.Lconcat_heads__mha_block__memory_aug_recurrent_mem_tr__prompt_kernelaout_tail0:
  s_nop 7
  s_nop 7
  v_cvt_pk_bf16_f32 v44, v60, v61
  v_cvt_pk_bf16_f32 v45, v62, v63
  v_cvt_pk_bf16_f32 v46, v64, v65
  v_cvt_pk_bf16_f32 v47, v66, v67
  v_cvt_pk_bf16_f32 v48, v68, v69
  v_cvt_pk_bf16_f32 v49, v70, v71
  v_cvt_pk_bf16_f32 v50, v72, v73
  v_cvt_pk_bf16_f32 v51, v74, v75
  s_nop 1
  v_permlane32_swap_b32 v44, v46
  v_permlane32_swap_b32 v45, v47
  v_permlane32_swap_b32 v48, v50
  v_permlane32_swap_b32 v49, v51
  buffer_store_dwordx4 v[44:47], v17, s[44:47], s51 offen offset:0
  buffer_store_dwordx4 v[48:51], v17, s[44:47], s51 offen offset:32
  v_cvt_pk_bf16_f32 v52, v76, v77
  v_cvt_pk_bf16_f32 v53, v78, v79
  v_cvt_pk_bf16_f32 v54, v80, v81
  v_cvt_pk_bf16_f32 v55, v82, v83
  v_cvt_pk_bf16_f32 v56, v84, v85
  v_cvt_pk_bf16_f32 v57, v86, v87
  v_cvt_pk_bf16_f32 v58, v88, v89
  v_cvt_pk_bf16_f32 v59, v90, v91
  s_nop 1
  v_permlane32_swap_b32 v52, v54
  v_permlane32_swap_b32 v53, v55
  v_permlane32_swap_b32 v56, v58
  v_permlane32_swap_b32 v57, v59
  buffer_store_dwordx4 v[52:55], v18, s[44:47], s52 offen offset:0
  buffer_store_dwordx4 v[56:59], v18, s[44:47], s52 offen offset:32
.Lconcat_heads__mha_block__memory_aug_recurrent_mem_tr__prompt_kernelaout_done:
  s_waitcnt vmcnt(0) lgkmcnt(0)
  s_barrier
  s_branch .Lconcat_heads__mha_block__memory_aug_recurrent_mem_tr__prompt_kernel_end
.Lconcat_heads__mha_block__memory_aug_recurrent_mem_tr__prompt_kernel_rec:
  s_sub_u32 s34, s90, 224
  s_mov_b32 s99, s90
  s_load_dwordx2 s[4:5], s[0:1], 40
  s_load_dwordx2 s[6:7], s[0:1], 48
  s_load_dwordx2 s[8:9], s[0:1], 56
  s_load_dwordx2 s[10:11], s[0:1], 64
  s_load_dwordx2 s[32:33], s[0:1], 32
  s_load_dwordx2 s[28:29], s[0:1], 96
  s_load_dwordx2 s[30:31], s[0:1], 88
  v_lshrrev_b32 v12, 6, v0
  v_and_b32 v31, 63, v0
  v_readfirstlane_b32 s35, v12
  s_waitcnt lgkmcnt(0)
  s_mov_b32 s12, s4
  s_mov_b32 s13, s5
  s_mov_b32 s14, 4718592
  s_mov_b32 s15, 0x00020000
  s_mov_b32 s16, s6
  s_mov_b32 s17, s7
  s_mov_b32 s18, 4718592
  s_mov_b32 s19, 0x00020000
  s_mov_b32 s20, s8
  s_mov_b32 s21, s9
  s_mov_b32 s22, 4718592
  s_mov_b32 s23, 0x00020000
  s_mov_b32 s24, s10
  s_mov_b32 s25, s11
  s_mov_b32 s26, 4718592
  s_mov_b32 s27, 0x00020000
  v_lshrrev_b32 v12, 4, v31
  v_and_b32 v13, 15, v31
  v_and_b32 v14, 1, v12
  v_lshlrev_b32 v14, 1, v14
  v_xor_b32 v14, v13, v14
  v_xor_b32 v15, 0, v14
  v_add_u32 v28, 0, v12
  v_lshlrev_b32 v29, 13, v28
  v_lshlrev_b32 v30, 4, v15
  v_add_u32 v16, v29, v30
  v_mul_u32_u24 v29, 1152, v28
  v_add_u32 v20, v29, v30
  v_lshrrev_b32 v36, 1, v15
  v_and_b32 v36, 1, v36
  v_mul_u32_u24 v36, 73728, v36
  v_add_u32 v29, v29, v36
  v_lshrrev_b32 v36, 2, v15
  v_lshlrev_b32 v36, 1, v36
  v_and_b32 v37, 1, v15
  v_add_u32 v36, v36, v37
  v_lshlrev_b32 v36, 4, v36
  v_add_u32 v29, v29, v36
  v_add_u32 v24, 1024, v29
  v_xor_b32 v15, 4, v14
  v_add_u32 v28, 4, v12
  v_lshlrev_b32 v29, 13, v28
  v_lshlrev_b32 v30, 4, v15
  v_add_u32 v17, v29, v30
  v_mul_u32_u24 v29, 1152, v28
  v_add_u32 v21, v29, v30
  v_lshrrev_b32 v36, 1, v15
  v_and_b32 v36, 1, v36
  v_mul_u32_u24 v36, 73728, v36
  v_add_u32 v29, v29, v36
  v_lshrrev_b32 v36, 2, v15
  v_lshlrev_b32 v36, 1, v36
  v_and_b32 v37, 1, v15
  v_add_u32 v36, v36, v37
  v_lshlrev_b32 v36, 4, v36
  v_add_u32 v29, v29, v36
  v_add_u32 v25, 1024, v29
  v_xor_b32 v15, 8, v14
  v_add_u32 v28, 8, v12
  v_lshlrev_b32 v29, 13, v28
  v_lshlrev_b32 v30, 4, v15
  v_add_u32 v18, v29, v30
  v_mul_u32_u24 v29, 1152, v28
  v_add_u32 v22, v29, v30
  v_lshrrev_b32 v36, 1, v15
  v_and_b32 v36, 1, v36
  v_mul_u32_u24 v36, 73728, v36
  v_add_u32 v29, v29, v36
  v_lshrrev_b32 v36, 2, v15
  v_lshlrev_b32 v36, 1, v36
  v_and_b32 v37, 1, v15
  v_add_u32 v36, v36, v37
  v_lshlrev_b32 v36, 4, v36
  v_add_u32 v29, v29, v36
  v_add_u32 v26, 1024, v29
  v_xor_b32 v15, 12, v14
  v_add_u32 v28, 12, v12
  v_lshlrev_b32 v29, 13, v28
  v_lshlrev_b32 v30, 4, v15
  v_add_u32 v19, v29, v30
  v_mul_u32_u24 v29, 1152, v28
  v_add_u32 v23, v29, v30
  v_lshrrev_b32 v36, 1, v15
  v_and_b32 v36, 1, v36
  v_mul_u32_u24 v36, 73728, v36
  v_add_u32 v29, v29, v36
  v_lshrrev_b32 v36, 2, v15
  v_lshlrev_b32 v36, 1, v36
  v_and_b32 v37, 1, v15
  v_add_u32 v36, v36, v37
  v_lshlrev_b32 v36, 4, v36
  v_add_u32 v29, v29, v36
  v_add_u32 v27, 1024, v29
  s_lshl_b32 s74, s35, 17
  s_lshl_b32 s75, s34, 8
  s_add_u32 s74, s74, s75
  s_mul_i32 s75, s34, 147456
  s_mul_i32 s76, s35, 18432
  s_add_u32 s75, s75, s76
  s_mul_i32 s76, s35, 36864
  s_add_u32 s78, s74, 2097152
  s_add_u32 m0, s76, 0
  s_nop 0
  buffer_load_dwordx4 v16, s[12:15], s78 offen lds
  s_add_u32 m0, s76, 1024
  s_nop 0
  buffer_load_dwordx4 v17, s[12:15], s78 offen lds
  s_add_u32 m0, s76, 2048
  s_nop 0
  buffer_load_dwordx4 v18, s[12:15], s78 offen lds
  s_add_u32 m0, s76, 3072
  s_nop 0
  buffer_load_dwordx4 v19, s[12:15], s78 offen lds
  s_add_u32 s78, s74, 2621440
  s_add_u32 m0, s76, 4096
  s_nop 0
  buffer_load_dwordx4 v16, s[12:15], s78 offen lds
  s_add_u32 m0, s76, 5120
  s_nop 0
  buffer_load_dwordx4 v17, s[12:15], s78 offen lds
  s_add_u32 m0, s76, 6144
  s_nop 0
  buffer_load_dwordx4 v18, s[12:15], s78 offen lds
  s_add_u32 m0, s76, 7168
  s_nop 0
  buffer_load_dwordx4 v19, s[12:15], s78 offen lds
  s_add_u32 s78, s74, 3145728
  s_add_u32 m0, s76, 8192
  s_nop 0
  buffer_load_dwordx4 v16, s[12:15], s78 offen lds
  s_add_u32 m0, s76, 9216
  s_nop 0
  buffer_load_dwordx4 v17, s[12:15], s78 offen lds
  s_add_u32 m0, s76, 10240
  s_nop 0
  buffer_load_dwordx4 v18, s[12:15], s78 offen lds
  s_add_u32 m0, s76, 11264
  s_nop 0
  buffer_load_dwordx4 v19, s[12:15], s78 offen lds
  s_add_u32 s78, s74, 3670016
  s_add_u32 m0, s76, 12288
  s_nop 0
  buffer_load_dwordx4 v16, s[12:15], s78 offen lds
  s_add_u32 m0, s76, 13312
  s_nop 0
  buffer_load_dwordx4 v17, s[12:15], s78 offen lds
  s_add_u32 m0, s76, 14336
  s_nop 0
  buffer_load_dwordx4 v18, s[12:15], s78 offen lds
  s_add_u32 m0, s76, 15360
  s_nop 0
  buffer_load_dwordx4 v19, s[12:15], s78 offen lds
  s_add_u32 s78, s74, 0
  s_add_u32 m0, s76, 16384
  s_nop 0
  buffer_load_dwordx4 v16, s[16:19], s78 offen lds
  s_add_u32 m0, s76, 17408
  s_nop 0
  buffer_load_dwordx4 v17, s[16:19], s78 offen lds
  s_add_u32 m0, s76, 18432
  s_nop 0
  buffer_load_dwordx4 v18, s[16:19], s78 offen lds
  s_add_u32 m0, s76, 19456
  s_nop 0
  buffer_load_dwordx4 v19, s[16:19], s78 offen lds
  s_add_u32 s78, s74, 524288
  s_add_u32 m0, s76, 20480
  s_nop 0
  buffer_load_dwordx4 v16, s[16:19], s78 offen lds
  s_add_u32 m0, s76, 21504
  s_nop 0
  buffer_load_dwordx4 v17, s[16:19], s78 offen lds
  s_add_u32 m0, s76, 22528
  s_nop 0
  buffer_load_dwordx4 v18, s[16:19], s78 offen lds
  s_add_u32 m0, s76, 23552
  s_nop 0
  buffer_load_dwordx4 v19, s[16:19], s78 offen lds
  s_add_u32 s78, s74, 1048576
  s_add_u32 m0, s76, 24576
  s_nop 0
  buffer_load_dwordx4 v16, s[16:19], s78 offen lds
  s_add_u32 m0, s76, 25600
  s_nop 0
  buffer_load_dwordx4 v17, s[16:19], s78 offen lds
  s_add_u32 m0, s76, 26624
  s_nop 0
  buffer_load_dwordx4 v18, s[16:19], s78 offen lds
  s_add_u32 m0, s76, 27648
  s_nop 0
  buffer_load_dwordx4 v19, s[16:19], s78 offen lds
  s_add_u32 s78, s74, 1572864
  s_add_u32 m0, s76, 28672
  s_nop 0
  buffer_load_dwordx4 v16, s[16:19], s78 offen lds
  s_add_u32 m0, s76, 29696
  s_nop 0
  buffer_load_dwordx4 v17, s[16:19], s78 offen lds
  s_add_u32 m0, s76, 30720
  s_nop 0
  buffer_load_dwordx4 v18, s[16:19], s78 offen lds
  s_add_u32 m0, s76, 31744
  s_nop 0
  buffer_load_dwordx4 v19, s[16:19], s78 offen lds
  v_lshrrev_b32 v36, 2, v13
  v_and_b32 v47, 3, v13
  v_lshrrev_b32 v38, 1, v12
  v_and_b32 v39, 1, v12
  v_mul_u32_u24 v40, 36864, v38
  v_lshrrev_b32 v41, 1, v36
  v_and_b32 v42, 1, v36
  v_lshlrev_b32 v43, 3, v41
  v_lshlrev_b32 v44, 2, v39
  v_add_u32 v43, v43, v44
  v_add_u32 v43, v43, v42
  v_lshlrev_b32 v43, 8, v43
  v_add_u32 v40, v40, v43
  v_lshlrev_b32 v43, 1, v42
  v_add_u32 v43, v43, v44
  v_lshlrev_b32 v45, 3, v41
  v_add_u32 v43, v43, v45
  v_lshrrev_b32 v45, 1, v47
  s_lshl_b32 s77, s35, 2
  v_add_u32 v45, s77, v45
  v_xor_b32 v45, v45, v43
  v_lshlrev_b32 v45, 4, v45
  v_and_b32 v46, 1, v47
  v_lshlrev_b32 v46, 3, v46
  v_add_u32 v45, v45, v46
  v_add_u32 v32, v40, v45
  v_xor_b32 v45, 32, v45
  v_add_u32 v33, v40, v45
  v_add_u32 v34, 73728, v32
  v_add_u32 v35, 73728, v33
  v_lshlrev_b32 v0, 4, v31
  v_add_u32 v1, s76, v0
  v_add_u32 v2, 147456, v0
  v_mov_b32 v36, 0x4444
  v_mov_b32 v38, 0xeeee
  v_cmp_gt_u32 vcc, 8, v13
  s_mov_b32 s70, 0x00ff00ff
  s_mov_b32 s71, 0x00ff00ff
  v_cndmask_b32 v3, v38, v36, vcc
  v_and_b32 v36, 7, v13
  v_and_b32 v38, 1, v12
  v_lshlrev_b32 v38, 2, v38
  v_sub_u32 v38, v36, v38
  v_mov_b32 v39, 0x3f80
  v_mov_b32 v40, 0x3f800000
  v_cmp_eq_u32 vcc, 0, v38
  s_nop 1
  v_cndmask_b32 v4, 0, v39, vcc
  v_cmp_eq_u32 vcc, 1, v38
  s_nop 1
  v_cndmask_b32 v4, v4, v40, vcc
  v_cmp_eq_u32 vcc, 2, v38
  s_nop 1
  v_cndmask_b32 v5, 0, v39, vcc
  v_cmp_eq_u32 vcc, 3, v38
  s_nop 1
  v_cndmask_b32 v5, v5, v40, vcc
  v_and_b32 v38, 1, v12
  v_lshlrev_b32 v38, 4, v38
  v_lshrrev_b32 v39, 1, v12
  v_lshlrev_b32 v39, 1, v39
  v_add_u32 v38, v38, v39
  v_lshrrev_b32 v39, 3, v13
  v_add_u32 v38, v38, v39
  s_lshl_b32 s77, s35, 2
  v_add_u32 v38, s77, v38
  v_lshlrev_b32 v38, 7, v38
  v_lshlrev_b32 v36, 4, v36
  v_add_u32 v6, v38, v36
  v_and_b32 v38, 1, v12
  v_lshlrev_b32 v38, 3, v38
  v_lshrrev_b32 v39, 1, v12
  v_lshlrev_b32 v39, 2, v39
  v_add_u32 v38, v38, v39
  v_add_u32 v38, v38, v36
  v_lshrrev_b32 v39, 3, v13
  s_lshl_b32 s77, s35, 1
  s_add_u32 s77, s77, 64
  v_add_u32 v39, s77, v39
  v_lshlrev_b32 v39, 7, v39
  v_add_u32 v7, v39, v38
  s_lshl_b32 s77, s35, 5
  s_add_u32 s77, s77, s34
  s_cmp_lt_u32 s77, 72
  s_cselect_b32 s37, 1, 0
  s_cselect_b64 s[82:83], -1, 0
  s_cselect_b32 s77, s77, 0
  s_and_b64 s[84:85], s[82:83], s[70:71]
  s_lshl_b32 s79, s77, 7
  v_add_u32 v11, s79, v38
  v_lshrrev_b32 v39, 3, v31
  v_mul_u32_u24 v39, 9216, v39
  v_add_u32 v39, v39, v36
  v_add_u32 v8, s79, v39
  v_lshrrev_b32 v39, 1, v12
  v_lshlrev_b32 v39, 7, v39
  v_and_b32 v38, 1, v12
  v_lshlrev_b32 v38, 3, v38
  v_add_u32 v39, v39, v38
  v_add_u32 v39, v39, v36
  v_add_u32 v9, 156672, v39
  v_and_b32 v38, 1, v12
  v_lshlrev_b32 v38, 7, v38
  v_add_u32 v38, v38, v36
  v_add_u32 v10, 162816, v38
  s_mov_b32 s80, 0x3e0293ee
  v_lshrrev_b32 v38, 1, v12
  v_lshlrev_b32 v38, 1, v38
  v_lshrrev_b32 v39, 3, v13
  v_add_u32 v38, v38, v39
  s_lshl_b32 s77, s35, 2
  v_add_u32 v38, s77, v38
  v_lshlrev_b32 v38, 7, v38
  v_and_b32 v39, 7, v13
  v_lshlrev_b32 v39, 4, v39
  v_add_u32 v38, v38, v39
  v_and_b32 v39, 1, v12
  v_lshlrev_b32 v39, 3, v39
  v_add_u32 v6, v38, v39
  s_mov_b32 s100, -1
  s_mov_b32 s101, 0
  s_mov_b32 s84, 0x55555555
  s_mov_b32 s85, 0x55555555
  v_mov_b32 v36, 0xeeee
  v_mov_b32 v38, 0x4444
  v_cndmask_b32 v3, v36, v38, s[84:85]
  v_lshrrev_b32 v36, 1, v13
  v_and_b32 v37, 1, v13
  v_lshlrev_b32 v38, 1, v12
  v_mov_b32 v39, 0x3f803f80
  v_cmp_eq_u32 vcc, v36, v38
  s_nop 1
  v_cndmask_b32 v4, 0, v39, vcc
  v_add_u32 v38, 1, v38
  v_cmp_eq_u32 vcc, v36, v38
  s_nop 1
  v_cndmask_b32 v5, 0, v39, vcc
  v_lshlrev_b32 v38, 5, v36
  v_lshlrev_b32 v39, 3, v12
  v_add_u32 v38, v38, v39
  v_add_u32 v9, 156672, v38
  v_lshlrev_b32 v38, 3, v12
  v_add_u32 v38, v38, v36
  v_lshlrev_b32 v38, 3, v38
  v_add_u32 v10, 162816, v38
  s_lshl_b32 s77, s35, 5
  s_add_u32 s77, s77, s34
  s_cmp_lt_u32 s77, 72
  s_cselect_b32 s77, s77, 0
  s_lshl_b32 s79, s77, 7
  v_and_b32 v38, 7, v13
  v_lshrrev_b32 v39, 2, v38
  v_lshlrev_b32 v39, 6, v39
  v_and_b32 v38, 3, v38
  v_lshlrev_b32 v38, 3, v38
  v_add_u32 v38, v38, v39
  v_lshrrev_b32 v39, 1, v12
  v_lshlrev_b32 v39, 5, v39
  v_add_u32 v38, v38, v39
  v_and_b32 v39, 1, v12
  v_lshlrev_b32 v39, 2, v39
  v_add_u32 v38, v38, v39
  v_add_u32 v11, s79, v38
  v_lshlrev_b32 v7, 2, v31
  s_waitcnt vmcnt(28) lgkmcnt(0)
  s_barrier
  s_add_u32 s78, s74, 2097152
  s_add_u32 m0, s76, 32768
  s_nop 0
  buffer_load_dwordx4 v16, s[16:19], s78 offen lds
  s_add_u32 m0, s76, 33792
  s_nop 0
  buffer_load_dwordx4 v17, s[16:19], s78 offen lds
  s_add_u32 m0, s76, 34816
  s_nop 0
  buffer_load_dwordx4 v18, s[16:19], s78 offen lds
  s_add_u32 m0, s76, 35840
  s_nop 0
  buffer_load_dwordx4 v19, s[16:19], s78 offen lds
  ds_read_b64_tr_b16 v[80:81], v32 offset:0
  ds_read_b64_tr_b16 v[82:83], v32 offset:512
  ds_read_b64_tr_b16 v[84:85], v34 offset:0
  ds_read_b64_tr_b16 v[86:87], v34 offset:512
  ds_read_b64_tr_b16 v[88:89], v33 offset:0
  ds_read_b64_tr_b16 v[90:91], v33 offset:512
  ds_read_b64_tr_b16 v[92:93], v35 offset:0
  ds_read_b64_tr_b16 v[94:95], v35 offset:512
  s_waitcnt vmcnt(28) lgkmcnt(0)
  s_barrier
  s_add_u32 s78, s74, 2621440
  s_add_u32 m0, s76, 0
  s_nop 0
  buffer_load_dwordx4 v16, s[16:19], s78 offen lds
  s_add_u32 m0, s76, 1024
  s_nop 0
  buffer_load_dwordx4 v17, s[16:19], s78 offen lds
  s_add_u32 m0, s76, 2048
  s_nop 0
  buffer_load_dwordx4 v18, s[16:19], s78 offen lds
  s_add_u32 m0, s76, 3072
  s_nop 0
  buffer_load_dwordx4 v19, s[16:19], s78 offen lds
  ds_read_b64_tr_b16 v[96:97], v32 offset:4096
  ds_read_b64_tr_b16 v[98:99], v32 offset:4608
  ds_read_b64_tr_b16 v[100:101], v34 offset:4096
  ds_read_b64_tr_b16 v[102:103], v34 offset:4608
  ds_read_b64_tr_b16 v[104:105], v33 offset:4096
  ds_read_b64_tr_b16 v[106:107], v33 offset:4608
  ds_read_b64_tr_b16 v[108:109], v35 offset:4096
  ds_read_b64_tr_b16 v[110:111], v35 offset:4608
  s_waitcnt vmcnt(28) lgkmcnt(0)
  s_barrier
  s_add_u32 s78, s74, 3145728
  s_add_u32 m0, s76, 4096
  s_nop 0
  buffer_load_dwordx4 v16, s[16:19], s78 offen lds
  s_add_u32 m0, s76, 5120
  s_nop 0
  buffer_load_dwordx4 v17, s[16:19], s78 offen lds
  s_add_u32 m0, s76, 6144
  s_nop 0
  buffer_load_dwordx4 v18, s[16:19], s78 offen lds
  s_add_u32 m0, s76, 7168
  s_nop 0
  buffer_load_dwordx4 v19, s[16:19], s78 offen lds
  ds_read_b64_tr_b16 v[112:113], v32 offset:8192
  ds_read_b64_tr_b16 v[114:115], v32 offset:8704
  ds_read_b64_tr_b16 v[116:117], v34 offset:8192
  ds_read_b64_tr_b16 v[118:119], v34 offset:8704
  ds_read_b64_tr_b16 v[120:121], v33 offset:8192
  ds_read_b64_tr_b16 v[122:123], v33 offset:8704
  ds_read_b64_tr_b16 v[124:125], v35 offset:8192
  ds_read_b64_tr_b16 v[126:127], v35 offset:8704
  s_waitcnt vmcnt(28) lgkmcnt(0)
  s_barrier
  s_add_u32 s78, s74, 3670016
  s_add_u32 m0, s76, 8192
  s_nop 0
  buffer_load_dwordx4 v16, s[16:19], s78 offen lds
  s_add_u32 m0, s76, 9216
  s_nop 0
  buffer_load_dwordx4 v17, s[16:19], s78 offen lds
  s_add_u32 m0, s76, 10240
  s_nop 0
  buffer_load_dwordx4 v18, s[16:19], s78 offen lds
  s_add_u32 m0, s76, 11264
  s_nop 0
  buffer_load_dwordx4 v19, s[16:19], s78 offen lds
  ds_read_b64_tr_b16 v[128:129], v32 offset:12288
  ds_read_b64_tr_b16 v[130:131], v32 offset:12800
  ds_read_b64_tr_b16 v[132:133], v34 offset:12288
  ds_read_b64_tr_b16 v[134:135], v34 offset:12800
  ds_read_b64_tr_b16 v[136:137], v33 offset:12288
  ds_read_b64_tr_b16 v[138:139], v33 offset:12800
  ds_read_b64_tr_b16 v[140:141], v35 offset:12288
  ds_read_b64_tr_b16 v[142:143], v35 offset:12800
  s_waitcnt vmcnt(28) lgkmcnt(0)
  s_barrier
  s_add_u32 s78, s74, 4194304
  s_add_u32 m0, s76, 12288
  s_nop 0
  buffer_load_dwordx4 v16, s[16:19], s78 offen lds
  s_add_u32 m0, s76, 13312
  s_nop 0
  buffer_load_dwordx4 v17, s[16:19], s78 offen lds
  s_add_u32 m0, s76, 14336
  s_nop 0
  buffer_load_dwordx4 v18, s[16:19], s78 offen lds
  s_add_u32 m0, s76, 15360
  s_nop 0
  buffer_load_dwordx4 v19, s[16:19], s78 offen lds
  ds_read_b64_tr_b16 v[144:145], v32 offset:16384
  ds_read_b64_tr_b16 v[146:147], v32 offset:16896
  ds_read_b64_tr_b16 v[148:149], v34 offset:16384
  ds_read_b64_tr_b16 v[150:151], v34 offset:16896
  ds_read_b64_tr_b16 v[152:153], v33 offset:16384
  ds_read_b64_tr_b16 v[154:155], v33 offset:16896
  ds_read_b64_tr_b16 v[156:157], v35 offset:16384
  ds_read_b64_tr_b16 v[158:159], v35 offset:16896
  s_waitcnt vmcnt(28) lgkmcnt(0)
  s_barrier
  s_add_u32 s78, s74, 0
  s_add_u32 m0, s76, 16384
  s_nop 0
  buffer_load_dwordx4 v16, s[20:23], s78 offen lds
  s_add_u32 m0, s76, 17408
  s_nop 0
  buffer_load_dwordx4 v17, s[20:23], s78 offen lds
  s_add_u32 m0, s76, 18432
  s_nop 0
  buffer_load_dwordx4 v18, s[20:23], s78 offen lds
  s_add_u32 m0, s76, 19456
  s_nop 0
  buffer_load_dwordx4 v19, s[20:23], s78 offen lds
  ds_read_b64_tr_b16 v[160:161], v32 offset:20480
  ds_read_b64_tr_b16 v[162:163], v32 offset:20992
  ds_read_b64_tr_b16 v[164:165], v34 offset:20480
  ds_read_b64_tr_b16 v[166:167], v34 offset:20992
  ds_read_b64_tr_b16 v[168:169], v33 offset:20480
  ds_read_b64_tr_b16 v[170:171], v33 offset:20992
  ds_read_b64_tr_b16 v[172:173], v35 offset:20480
  ds_read_b64_tr_b16 v[174:175], v35 offset:20992
  s_waitcnt vmcnt(28) lgkmcnt(0)
  s_barrier
  s_add_u32 s78, s74, 524288
  s_add_u32 m0, s76, 20480
  s_nop 0
  buffer_load_dwordx4 v16, s[20:23], s78 offen lds
  s_add_u32 m0, s76, 21504
  s_nop 0
  buffer_load_dwordx4 v17, s[20:23], s78 offen lds
  s_add_u32 m0, s76, 22528
  s_nop 0
  buffer_load_dwordx4 v18, s[20:23], s78 offen lds
  s_add_u32 m0, s76, 23552
  s_nop 0
  buffer_load_dwordx4 v19, s[20:23], s78 offen lds
  ds_read_b64_tr_b16 v[176:177], v32 offset:24576
  ds_read_b64_tr_b16 v[178:179], v32 offset:25088
  ds_read_b64_tr_b16 v[180:181], v34 offset:24576
  ds_read_b64_tr_b16 v[182:183], v34 offset:25088
  ds_read_b64_tr_b16 v[184:185], v33 offset:24576
  ds_read_b64_tr_b16 v[186:187], v33 offset:25088
  ds_read_b64_tr_b16 v[188:189], v35 offset:24576
  ds_read_b64_tr_b16 v[190:191], v35 offset:25088
  s_waitcnt vmcnt(28) lgkmcnt(0)
  s_barrier
  s_add_u32 s78, s74, 1048576
  s_add_u32 m0, s76, 24576
  s_nop 0
  buffer_load_dwordx4 v16, s[20:23], s78 offen lds
  s_add_u32 m0, s76, 25600
  s_nop 0
  buffer_load_dwordx4 v17, s[20:23], s78 offen lds
  s_add_u32 m0, s76, 26624
  s_nop 0
  buffer_load_dwordx4 v18, s[20:23], s78 offen lds
  s_add_u32 m0, s76, 27648
  s_nop 0
  buffer_load_dwordx4 v19, s[20:23], s78 offen lds
  ds_read_b64_tr_b16 v[192:193], v32 offset:28672
  ds_read_b64_tr_b16 v[194:195], v32 offset:29184
  ds_read_b64_tr_b16 v[196:197], v34 offset:28672
  ds_read_b64_tr_b16 v[198:199], v34 offset:29184
  ds_read_b64_tr_b16 v[200:201], v33 offset:28672
  ds_read_b64_tr_b16 v[202:203], v33 offset:29184
  ds_read_b64_tr_b16 v[204:205], v35 offset:28672
  ds_read_b64_tr_b16 v[206:207], v35 offset:29184
  s_waitcnt vmcnt(28) lgkmcnt(0)
  s_barrier
  v_mov_b32 v59, 64
  global_load_dwordx4 v[60:63], v59, s[30:31] sc1
  s_add_u32 s78, s74, 1572864
  s_add_u32 m0, s76, 28672
  s_nop 0
  buffer_load_dwordx4 v16, s[20:23], s78 offen lds
  s_add_u32 m0, s76, 29696
  s_nop 0
  buffer_load_dwordx4 v17, s[20:23], s78 offen lds
  s_add_u32 m0, s76, 30720
  s_nop 0
  buffer_load_dwordx4 v18, s[20:23], s78 offen lds
  s_add_u32 m0, s76, 31744
  s_nop 0
  buffer_load_dwordx4 v19, s[20:23], s78 offen lds
  ds_read_b64_tr_b16 v[208:209], v32 offset:32768
  ds_read_b64_tr_b16 v[210:211], v32 offset:33280
  ds_read_b64_tr_b16 v[212:213], v34 offset:32768
  ds_read_b64_tr_b16 v[214:215], v34 offset:33280
  ds_read_b64_tr_b16 v[216:217], v33 offset:32768
  ds_read_b64_tr_b16 v[218:219], v33 offset:33280
  ds_read_b64_tr_b16 v[220:221], v35 offset:32768
  ds_read_b64_tr_b16 v[222:223], v35 offset:33280
  s_waitcnt vmcnt(28) lgkmcnt(0)
  s_barrier
  s_add_u32 s78, s74, 2097152
  s_add_u32 m0, s76, 32768
  s_nop 0
  buffer_load_dwordx4 v16, s[20:23], s78 offen lds
  s_add_u32 m0, s76, 33792
  s_nop 0
  buffer_load_dwordx4 v17, s[20:23], s78 offen lds
  s_add_u32 m0, s76, 34816
  s_nop 0
  buffer_load_dwordx4 v18, s[20:23], s78 offen lds
  s_add_u32 m0, s76, 35840
  s_nop 0
  buffer_load_dwordx4 v19, s[20:23], s78 offen lds
  ds_read_b64_tr_b16 v[224:225], v32 offset:0
  ds_read_b64_tr_b16 v[226:227], v32 offset:512
  ds_read_b64_tr_b16 v[228:229], v34 offset:0
  ds_read_b64_tr_b16 v[230:231], v34 offset:512
  ds_read_b64_tr_b16 v[232:233], v33 offset:0
  ds_read_b64_tr_b16 v[234:235], v33 offset:512
  ds_read_b64_tr_b16 v[236:237], v35 offset:0
  ds_read_b64_tr_b16 v[238:239], v35 offset:512
  s_waitcnt vmcnt(28) lgkmcnt(0)
  s_barrier
  s_add_u32 s78, s74, 2621440
  s_add_u32 m0, s76, 0
  s_nop 0
  buffer_load_dwordx4 v16, s[20:23], s78 offen lds
  s_add_u32 m0, s76, 1024
  s_nop 0
  buffer_load_dwordx4 v17, s[20:23], s78 offen lds
  s_add_u32 m0, s76, 2048
  s_nop 0
  buffer_load_dwordx4 v18, s[20:23], s78 offen lds
  s_add_u32 m0, s76, 3072
  s_nop 0
  buffer_load_dwordx4 v19, s[20:23], s78 offen lds
  ds_read_b64_tr_b16 v[240:241], v32 offset:4096
  ds_read_b64_tr_b16 v[242:243], v32 offset:4608
  ds_read_b64_tr_b16 v[244:245], v34 offset:4096
  ds_read_b64_tr_b16 v[246:247], v34 offset:4608
  ds_read_b64_tr_b16 v[248:249], v33 offset:4096
  ds_read_b64_tr_b16 v[250:251], v33 offset:4608
  ds_read_b64_tr_b16 v[252:253], v35 offset:4096
  ds_read_b64_tr_b16 v[254:255], v35 offset:4608
  s_waitcnt vmcnt(28) lgkmcnt(0)
  s_barrier
  s_add_u32 s78, s74, 3145728
  s_add_u32 m0, s76, 4096
  s_nop 0
  buffer_load_dwordx4 v16, s[20:23], s78 offen lds
  s_add_u32 m0, s76, 5120
  s_nop 0
  buffer_load_dwordx4 v17, s[20:23], s78 offen lds
  s_add_u32 m0, s76, 6144
  s_nop 0
  buffer_load_dwordx4 v18, s[20:23], s78 offen lds
  s_add_u32 m0, s76, 7168
  s_nop 0
  buffer_load_dwordx4 v19, s[20:23], s78 offen lds
  ds_read_b64_tr_b16 a[0:1], v32 offset:8192
  ds_read_b64_tr_b16 a[2:3], v32 offset:8704
  ds_read_b64_tr_b16 a[4:5], v34 offset:8192
  ds_read_b64_tr_b16 a[6:7], v34 offset:8704
  ds_read_b64_tr_b16 a[8:9], v33 offset:8192
  ds_read_b64_tr_b16 a[10:11], v33 offset:8704
  ds_read_b64_tr_b16 a[12:13], v35 offset:8192
  ds_read_b64_tr_b16 a[14:15], v35 offset:8704
  s_waitcnt vmcnt(28) lgkmcnt(0)
  s_barrier
  s_add_u32 s78, s74, 3670016
  s_add_u32 m0, s76, 8192
  s_nop 0
  buffer_load_dwordx4 v16, s[20:23], s78 offen lds
  s_add_u32 m0, s76, 9216
  s_nop 0
  buffer_load_dwordx4 v17, s[20:23], s78 offen lds
  s_add_u32 m0, s76, 10240
  s_nop 0
  buffer_load_dwordx4 v18, s[20:23], s78 offen lds
  s_add_u32 m0, s76, 11264
  s_nop 0
  buffer_load_dwordx4 v19, s[20:23], s78 offen lds
  ds_read_b64_tr_b16 a[16:17], v32 offset:12288
  ds_read_b64_tr_b16 a[18:19], v32 offset:12800
  ds_read_b64_tr_b16 a[20:21], v34 offset:12288
  ds_read_b64_tr_b16 a[22:23], v34 offset:12800
  ds_read_b64_tr_b16 a[24:25], v33 offset:12288
  ds_read_b64_tr_b16 a[26:27], v33 offset:12800
  ds_read_b64_tr_b16 a[28:29], v35 offset:12288
  ds_read_b64_tr_b16 a[30:31], v35 offset:12800
  s_waitcnt vmcnt(28) lgkmcnt(0)
  s_barrier
  s_add_u32 s78, s74, 4194304
  s_add_u32 m0, s76, 12288
  s_nop 0
  buffer_load_dwordx4 v16, s[20:23], s78 offen lds
  s_add_u32 m0, s76, 13312
  s_nop 0
  buffer_load_dwordx4 v17, s[20:23], s78 offen lds
  s_add_u32 m0, s76, 14336
  s_nop 0
  buffer_load_dwordx4 v18, s[20:23], s78 offen lds
  s_add_u32 m0, s76, 15360
  s_nop 0
  buffer_load_dwordx4 v19, s[20:23], s78 offen lds
  ds_read_b64_tr_b16 a[32:33], v32 offset:16384
  ds_read_b64_tr_b16 a[34:35], v32 offset:16896
  ds_read_b64_tr_b16 a[36:37], v34 offset:16384
  ds_read_b64_tr_b16 a[38:39], v34 offset:16896
  ds_read_b64_tr_b16 a[40:41], v33 offset:16384
  ds_read_b64_tr_b16 a[42:43], v33 offset:16896
  ds_read_b64_tr_b16 a[44:45], v35 offset:16384
  ds_read_b64_tr_b16 a[46:47], v35 offset:16896
  s_waitcnt vmcnt(28) lgkmcnt(0)
  s_barrier
  s_add_u32 s78, s75, 0
  s_add_u32 m0, s76, 16384
  s_nop 0
  buffer_load_dwordx4 v20, s[24:27], s78 offen lds
  s_add_u32 m0, s76, 17408
  s_nop 0
  buffer_load_dwordx4 v21, s[24:27], s78 offen lds
  s_add_u32 m0, s76, 18432
  s_nop 0
  buffer_load_dwordx4 v22, s[24:27], s78 offen lds
  s_add_u32 m0, s76, 19456
  s_nop 0
  buffer_load_dwordx4 v23, s[24:27], s78 offen lds
  ds_read_b64_tr_b16 a[48:49], v32 offset:20480
  ds_read_b64_tr_b16 a[50:51], v32 offset:20992
  ds_read_b64_tr_b16 a[52:53], v34 offset:20480
  ds_read_b64_tr_b16 a[54:55], v34 offset:20992
  ds_read_b64_tr_b16 a[56:57], v33 offset:20480
  ds_read_b64_tr_b16 a[58:59], v33 offset:20992
  ds_read_b64_tr_b16 a[60:61], v35 offset:20480
  ds_read_b64_tr_b16 a[62:63], v35 offset:20992
  s_waitcnt vmcnt(28) lgkmcnt(0)
  s_barrier
  s_add_u32 s78, s75, 256
  s_add_u32 m0, s76, 20480
  s_nop 0
  buffer_load_dwordx4 v20, s[24:27], s78 offen lds
  s_add_u32 m0, s76, 21504
  s_nop 0
  buffer_load_dwordx4 v21, s[24:27], s78 offen lds
  s_add_u32 m0, s76, 22528
  s_nop 0
  buffer_load_dwordx4 v22, s[24:27], s78 offen lds
  s_add_u32 m0, s76, 23552
  s_nop 0
  buffer_load_dwordx4 v23, s[24:27], s78 offen lds
  ds_read_b64_tr_b16 a[64:65], v32 offset:24576
  ds_read_b64_tr_b16 a[66:67], v32 offset:25088
  ds_read_b64_tr_b16 a[68:69], v34 offset:24576
  ds_read_b64_tr_b16 a[70:71], v34 offset:25088
  ds_read_b64_tr_b16 a[72:73], v33 offset:24576
  ds_read_b64_tr_b16 a[74:75], v33 offset:25088
  ds_read_b64_tr_b16 a[76:77], v35 offset:24576
  ds_read_b64_tr_b16 a[78:79], v35 offset:25088
  s_waitcnt vmcnt(28) lgkmcnt(0)
  s_barrier
  s_mov_b32 s77, 4000000
.sp19:
  v_readfirstlane_b32 s79, v60
  s_cmp_eq_u32 s79, s98
  s_cbranch_scc1 .sp19_ok
  s_cmp_lg_u32 s79, 0
  s_cbranch_scc1 .Lconcat_heads__mha_block__memory_aug_recurrent_mem_tr__prompt_kernel_aband
  global_load_dword v60, v59, s[30:31] sc1
  s_waitcnt vmcnt(0)
  s_sub_u32 s77, s77, 1
  s_cmp_lg_u32 s77, 0
  s_cbranch_scc1 .sp19
  s_branch .Lconcat_heads__mha_block__memory_aug_recurrent_mem_tr__prompt_kernel_aband
.sp19_ok:
  v_readfirstlane_b32 s97, v62
  v_mov_b32 v64, -1
  v_mov_b32 v65, -1
  v_mov_b32 v66, -1
  v_mov_b32 v67, -1
  s_add_u32 s4, s28, 67108864
  s_addc_u32 s5, s29, 0
  s_mul_i32 s77, s35, 294912
  s_mul_i32 s79, s34, 9216
  s_add_u32 s77, s77, s79
  v_add_u32 v68, s77, v0
  global_store_dwordx4 v68, v[64:67], s[4:5]
  v_add_u32 v68, 1024, v68
  global_store_dwordx4 v68, v[64:67], s[4:5]
  v_add_u32 v68, 1024, v68
  global_store_dwordx4 v68, v[64:67], s[4:5]
  v_add_u32 v68, 1024, v68
  global_store_dwordx4 v68, v[64:67], s[4:5]
  v_add_u32 v68, 1024, v68
  global_store_dwordx4 v68, v[64:67], s[4:5]
  v_add_u32 v68, 1024, v68
  global_store_dwordx4 v68, v[64:67], s[4:5]
  v_add_u32 v68, 1024, v68
  global_store_dwordx4 v68, v[64:67], s[4:5]
  v_add_u32 v68, 1024, v68
  global_store_dwordx4 v68, v[64:67], s[4:5]
  v_add_u32 v68, 1024, v68
  global_store_dwordx4 v68, v[64:67], s[4:5]
  v_add_u32 v68, 1024, v68
  s_cmp_lg_u32 s35, 3
  s_cbranch_scc1 .n420
  s_mov_b32 s82, 0xffff
  s_cmp_lt_u32 s34, 8
  s_cselect_b32 s82, 0xffffff, s82
  s_mov_b32 s83, 0
  v_lshrrev_b32 v68, 7, v0
  v_lshlrev_b32 v68, 12, v68
  v_and_b32 v69, 0x70, v0
  v_add_u32 v68, v68, v69
  s_lshl_b32 s77, s34, 7
  s_add_u32 s77, s77, 1179648
  v_add_u32 v68, s77, v68
  s_mov_b64 exec, s[82:83]
  global_store_dwordx4 v68, v[64:67], s[4:5]
  v_add_u32 v68, 9216, v68
  global_store_dwordx4 v68, v[64:67], s[4:5]
  v_add_u32 v68, 9216, v68
  global_store_dwordx4 v68, v[64:67], s[4:5]
  v_add_u32 v68, 9216, v68
  global_store_dwordx4 v68, v[64:67], s[4:5]
  v_add_u32 v68, 9216, v68
  s_mov_b64 exec, -1
.n420:
  s_add_u32 s78, s75, 768
  s_add_u32 m0, s76, 24576
  s_nop 0
  buffer_load_dwordx4 v20, s[24:27], s78 offen lds
  s_add_u32 m0, s76, 25600
  s_nop 0
  buffer_load_dwordx4 v21, s[24:27], s78 offen lds
  s_add_u32 m0, s76, 26624
  s_nop 0
  buffer_load_dwordx4 v22, s[24:27], s78 offen lds
  s_add_u32 m0, s76, 27648
  s_nop 0
  buffer_load_dwordx4 v23, s[24:27], s78 offen lds
  ds_read_b64_tr_b16 a[80:81], v32 offset:28672
  ds_read_b64_tr_b16 a[82:83], v32 offset:29184
  ds_read_b64_tr_b16 a[84:85], v34 offset:28672
  ds_read_b64_tr_b16 a[86:87], v34 offset:29184
  ds_read_b64_tr_b16 a[88:89], v33 offset:28672
  ds_read_b64_tr_b16 a[90:91], v33 offset:29184
  ds_read_b64_tr_b16 a[92:93], v35 offset:28672
  ds_read_b64_tr_b16 a[94:95], v35 offset:29184
  s_waitcnt vmcnt(28) lgkmcnt(0)
  s_barrier
  s_add_u32 s78, s75, 73984
  s_add_u32 m0, s76, 28672
  s_nop 0
  buffer_load_dwordx4 v20, s[24:27], s78 offen lds
  s_add_u32 m0, s76, 29696
  s_nop 0
  buffer_load_dwordx4 v21, s[24:27], s78 offen lds
  s_add_u32 m0, s76, 30720
  s_nop 0
  buffer_load_dwordx4 v22, s[24:27], s78 offen lds
  s_add_u32 m0, s76, 31744
  s_nop 0
  buffer_load_dwordx4 v23, s[24:27], s78 offen lds
  ds_read_b64_tr_b16 a[96:97], v32 offset:32768
  ds_read_b64_tr_b16 a[98:99], v32 offset:33280
  ds_read_b64_tr_b16 a[100:101], v34 offset:32768
  ds_read_b64_tr_b16 a[102:103], v34 offset:33280
  ds_read_b64_tr_b16 a[104:105], v33 offset:32768
  ds_read_b64_tr_b16 a[106:107], v33 offset:33280
  ds_read_b64_tr_b16 a[108:109], v35 offset:32768
  ds_read_b64_tr_b16 a[110:111], v35 offset:33280
  s_waitcnt vmcnt(28) lgkmcnt(0)
  s_barrier
  s_mov_b32 s78, s75
  s_add_u32 m0, s76, 32768
  s_nop 0
  buffer_load_dwordx4 v24, s[24:27], s78 offen lds
  s_add_u32 m0, s76, 33792
  s_nop 0
  buffer_load_dwordx4 v25, s[24:27], s78 offen lds
  s_add_u32 m0, s76, 34816
  s_nop 0
  buffer_load_dwordx4 v26, s[24:27], s78 offen lds
  s_add_u32 m0, s76, 35840
  s_nop 0
  buffer_load_dwordx4 v27, s[24:27], s78 offen lds
  ds_read_b64_tr_b16 a[112:113], v32 offset:0
  ds_read_b64_tr_b16 a[114:115], v32 offset:512
  ds_read_b64_tr_b16 a[116:117], v34 offset:0
  ds_read_b64_tr_b16 a[118:119], v34 offset:512
  ds_read_b64_tr_b16 a[120:121], v33 offset:0
  ds_read_b64_tr_b16 a[122:123], v33 offset:512
  ds_read_b64_tr_b16 a[124:125], v35 offset:0
  ds_read_b64_tr_b16 a[126:127], v35 offset:512
  s_waitcnt vmcnt(28) lgkmcnt(0)
  s_barrier
  s_add_u32 s78, s74, 0
  s_add_u32 m0, s76, 0
  s_nop 0
  buffer_load_dwordx4 v16, s[12:15], s78 offen lds
  s_add_u32 m0, s76, 1024
  s_nop 0
  buffer_load_dwordx4 v17, s[12:15], s78 offen lds
  s_add_u32 m0, s76, 2048
  s_nop 0
  buffer_load_dwordx4 v18, s[12:15], s78 offen lds
  s_add_u32 m0, s76, 3072
  s_nop 0
  buffer_load_dwordx4 v19, s[12:15], s78 offen lds
  ds_read_b64_tr_b16 a[128:129], v32 offset:4096
  ds_read_b64_tr_b16 a[130:131], v32 offset:4608
  ds_read_b64_tr_b16 a[132:133], v34 offset:4096
  ds_read_b64_tr_b16 a[134:135], v34 offset:4608
  ds_read_b64_tr_b16 a[136:137], v33 offset:4096
  ds_read_b64_tr_b16 a[138:139], v33 offset:4608
  ds_read_b64_tr_b16 a[140:141], v35 offset:4096
  ds_read_b64_tr_b16 a[142:143], v35 offset:4608
  s_waitcnt vmcnt(28) lgkmcnt(0)
  s_barrier
  s_add_u32 s78, s74, 524288
  s_add_u32 m0, s76, 4096
  s_nop 0
  buffer_load_dwordx4 v16, s[12:15], s78 offen lds
  s_add_u32 m0, s76, 5120
  s_nop 0
  buffer_load_dwordx4 v17, s[12:15], s78 offen lds
  s_add_u32 m0, s76, 6144
  s_nop 0
  buffer_load_dwordx4 v18, s[12:15], s78 offen lds
  s_add_u32 m0, s76, 7168
  s_nop 0
  buffer_load_dwordx4 v19, s[12:15], s78 offen lds
  ds_read_b64_tr_b16 a[144:145], v32 offset:8192
  ds_read_b64_tr_b16 a[146:147], v32 offset:8704
  ds_read_b64_tr_b16 a[148:149], v34 offset:8192
  ds_read_b64_tr_b16 a[150:151], v34 offset:8704
  ds_read_b64_tr_b16 a[152:153], v33 offset:8192
  ds_read_b64_tr_b16 a[154:155], v33 offset:8704
  ds_read_b64_tr_b16 a[156:157], v35 offset:8192
  ds_read_b64_tr_b16 a[158:159], v35 offset:8704
  s_waitcnt vmcnt(28) lgkmcnt(0)
  s_barrier
  s_add_u32 s78, s74, 1048576
  s_add_u32 m0, s76, 8192
  s_nop 0
  buffer_load_dwordx4 v16, s[12:15], s78 offen lds
  s_add_u32 m0, s76, 9216
  s_nop 0
  buffer_load_dwordx4 v17, s[12:15], s78 offen lds
  s_add_u32 m0, s76, 10240
  s_nop 0
  buffer_load_dwordx4 v18, s[12:15], s78 offen lds
  s_add_u32 m0, s76, 11264
  s_nop 0
  buffer_load_dwordx4 v19, s[12:15], s78 offen lds
  ds_read_b64_tr_b16 a[160:161], v32 offset:12288
  ds_read_b64_tr_b16 a[162:163], v32 offset:12800
  ds_read_b64_tr_b16 a[164:165], v34 offset:12288
  ds_read_b64_tr_b16 a[166:167], v34 offset:12800
  ds_read_b64_tr_b16 a[168:169], v33 offset:12288
  ds_read_b64_tr_b16 a[170:171], v33 offset:12800
  ds_read_b64_tr_b16 a[172:173], v35 offset:12288
  ds_read_b64_tr_b16 a[174:175], v35 offset:12800
  s_waitcnt vmcnt(28) lgkmcnt(0)
  s_barrier
  s_add_u32 s78, s74, 1572864
  s_add_u32 m0, s76, 12288
  s_nop 0
  buffer_load_dwordx4 v16, s[12:15], s78 offen lds
  s_add_u32 m0, s76, 13312
  s_nop 0
  buffer_load_dwordx4 v17, s[12:15], s78 offen lds
  s_add_u32 m0, s76, 14336
  s_nop 0
  buffer_load_dwordx4 v18, s[12:15], s78 offen lds
  s_add_u32 m0, s76, 15360
  s_nop 0
  buffer_load_dwordx4 v19, s[12:15], s78 offen lds
  ds_read_b64_tr_b16 a[176:177], v32 offset:16384
  ds_read_b64_tr_b16 a[178:179], v32 offset:16896
  ds_read_b64_tr_b16 a[180:181], v34 offset:16384
  ds_read_b64_tr_b16 a[182:183], v34 offset:16896
  ds_read_b64_tr_b16 a[184:185], v33 offset:16384
  ds_read_b64_tr_b16 a[186:187], v33 offset:16896
  ds_read_b64_tr_b16 a[188:189], v35 offset:16384
  ds_read_b64_tr_b16 a[190:191], v35 offset:16896
  s_waitcnt vmcnt(28) lgkmcnt(0)
  s_barrier
  s_add_u32 s78, s74, 4194304
  s_add_u32 m0, s76, 16384
  s_nop 0
  buffer_load_dwordx4 v16, s[12:15], s78 offen lds
  s_add_u32 m0, s76, 17408
  s_nop 0
  buffer_load_dwordx4 v17, s[12:15], s78 offen lds
  s_add_u32 m0, s76, 18432
  s_nop 0
  buffer_load_dwordx4 v18, s[12:15], s78 offen lds
  s_add_u32 m0, s76, 19456
  s_nop 0
  buffer_load_dwordx4 v19, s[12:15], s78 offen lds
  ds_read_b64_tr_b16 a[192:193], v32 offset:20480
  ds_read_b64_tr_b16 a[194:195], v32 offset:20992
  ds_read_b64_tr_b16 a[196:197], v34 offset:20480
  ds_read_b64_tr_b16 a[198:199], v34 offset:20992
  ds_read_b64_tr_b16 a[200:201], v33 offset:20480
  ds_read_b64_tr_b16 a[202:203], v33 offset:20992
  ds_read_b64_tr_b16 a[204:205], v35 offset:20480
  ds_read_b64_tr_b16 a[206:207], v35 offset:20992
  s_waitcnt vmcnt(28) lgkmcnt(0)
  s_barrier
  s_add_u32 s78, s75, 73728
  s_add_u32 m0, s76, 20480
  s_nop 0
  buffer_load_dwordx4 v20, s[24:27], s78 offen lds
  s_add_u32 m0, s76, 21504
  s_nop 0
  buffer_load_dwordx4 v21, s[24:27], s78 offen lds
  s_add_u32 m0, s76, 22528
  s_nop 0
  buffer_load_dwordx4 v22, s[24:27], s78 offen lds
  s_add_u32 m0, s76, 23552
  s_nop 0
  buffer_load_dwordx4 v23, s[24:27], s78 offen lds
  ds_read_b64_tr_b16 a[208:209], v32 offset:24576
  ds_read_b64_tr_b16 a[210:211], v32 offset:25088
  ds_read_b64_tr_b16 a[212:213], v34 offset:24576
  ds_read_b64_tr_b16 a[214:215], v34 offset:25088
  ds_read_b64_tr_b16 a[216:217], v33 offset:24576
  ds_read_b64_tr_b16 a[218:219], v33 offset:25088
  ds_read_b64_tr_b16 a[220:221], v35 offset:24576
  ds_read_b64_tr_b16 a[222:223], v35 offset:25088
  s_waitcnt vmcnt(28) lgkmcnt(0)
  s_barrier
  s_cmp_lg_u32 s35, 0
  s_cbranch_scc1 .ar21
  v_mov_b32 v64, 76
  v_mov_b32 v65, 1
  s_mov_b64 exec, 1
  global_atomic_add v64, v65, s[30:31]
  s_mov_b64 exec, -1
.ar21:
  s_add_u32 s78, s75, 512
  s_add_u32 m0, s76, 24576
  s_nop 0
  buffer_load_dwordx4 v20, s[24:27], s78 offen lds
  s_add_u32 m0, s76, 25600
  s_nop 0
  buffer_load_dwordx4 v21, s[24:27], s78 offen lds
  s_add_u32 m0, s76, 26624
  s_nop 0
  buffer_load_dwordx4 v22, s[24:27], s78 offen lds
  s_add_u32 m0, s76, 27648
  s_nop 0
  buffer_load_dwordx4 v23, s[24:27], s78 offen lds
  ds_read_b64_tr_b16 a[224:225], v32 offset:28672
  ds_read_b64_tr_b16 a[226:227], v32 offset:29184
  ds_read_b64_tr_b16 a[228:229], v34 offset:28672
  ds_read_b64_tr_b16 a[230:231], v34 offset:29184
  ds_read_b64_tr_b16 a[232:233], v33 offset:28672
  ds_read_b64_tr_b16 a[234:235], v33 offset:29184
  ds_read_b64_tr_b16 a[236:237], v35 offset:28672
  ds_read_b64_tr_b16 a[238:239], v35 offset:29184
  s_waitcnt vmcnt(28) lgkmcnt(0)
  s_barrier
  s_add_u32 s78, s75, 74240
  s_add_u32 m0, s76, 28672
  s_nop 0
  buffer_load_dwordx4 v20, s[24:27], s78 offen lds
  s_add_u32 m0, s76, 29696
  s_nop 0
  buffer_load_dwordx4 v21, s[24:27], s78 offen lds
  s_add_u32 m0, s76, 30720
  s_nop 0
  buffer_load_dwordx4 v22, s[24:27], s78 offen lds
  s_add_u32 m0, s76, 31744
  s_nop 0
  buffer_load_dwordx4 v23, s[24:27], s78 offen lds
  ds_read_b64_tr_b16 a[240:241], v32 offset:32768
  ds_read_b64_tr_b16 a[242:243], v32 offset:33280
  ds_read_b64_tr_b16 a[244:245], v34 offset:32768
  ds_read_b64_tr_b16 a[246:247], v34 offset:33280
  ds_read_b64_tr_b16 a[248:249], v33 offset:32768
  ds_read_b64_tr_b16 a[250:251], v33 offset:33280
  ds_read_b64_tr_b16 a[252:253], v35 offset:32768
  ds_read_b64_tr_b16 a[254:255], v35 offset:33280
  s_waitcnt vmcnt(28) lgkmcnt(0)
  s_barrier
  s_add_u32 s78, s75, 74496
  s_add_u32 m0, s76, 32768
  s_nop 0
  buffer_load_dwordx4 v20, s[24:27], s78 offen lds
  s_add_u32 m0, s76, 33792
  s_nop 0
  buffer_load_dwordx4 v21, s[24:27], s78 offen lds
  s_add_u32 m0, s76, 34816
  s_nop 0
  buffer_load_dwordx4 v22, s[24:27], s78 offen lds
  s_add_u32 m0, s76, 35840
  s_nop 0
  buffer_load_dwordx4 v23, s[24:27], s78 offen lds
  ds_read_b64_tr_b16 v[48:49], v32 offset:0
  ds_read_b64_tr_b16 v[50:51], v32 offset:512
  ds_read_b64_tr_b16 v[52:53], v34 offset:0
  ds_read_b64_tr_b16 v[54:55], v34 offset:512
  ds_read_b64_tr_b16 v[56:57], v33 offset:0
  ds_read_b64_tr_b16 v[58:59], v33 offset:512
  ds_read_b64_tr_b16 v[60:61], v35 offset:0
  ds_read_b64_tr_b16 v[62:63], v35 offset:512
  s_waitcnt lgkmcnt(0)
  s_barrier
  ds_write_b128 v1, v[48:51] offset:0
  ds_write_b128 v1, v[52:55] offset:1024
  ds_write_b128 v1, v[56:59] offset:2048
  ds_write_b128 v1, v[60:63] offset:3072
  s_waitcnt vmcnt(28) lgkmcnt(0)
  s_barrier
  v_mov_b32 v20, 0
  v_mov_b32 v21, 0
  v_mov_b32 v22, 0
  v_mov_b32 v23, 0
  v_lshrrev_b32 v24, 4, v0
  v_and_b32 v25, 15, v24
  v_lshrrev_b32 v26, 1, v25
  v_mul_u32_u24 v26, 1152, v26
  v_and_b32 v25, 1, v25
  v_lshrrev_b32 v24, 4, v24
  v_lshlrev_b32 v24, 1, v24
  v_add_u32 v24, v24, v25
  v_lshlrev_b32 v24, 4, v24
  v_add_u32 v24, v24, v26
  s_lshl_b32 s74, s35, 7
  v_add_u32 v25, s74, v24
  global_load_dwordx4 v[12:15], v25, s[32:33]
  global_load_dwordx4 v[16:19], v25, s[32:33] offset:512
  s_lshl_b32 s74, s35, 5
  s_add_u32 s74, s74, 1024
  v_add_u32 v25, s74, v24
  s_mov_b64 exec, 0xffff
  global_load_dwordx4 v[20:23], v25, s[32:33]
  s_mov_b64 exec, -1
  v_lshlrev_b32 v66, 3, v0
  s_lshl_b32 s77, s34, 2
  s_add_u32 s77, s77, 69992448
  v_add_u32 v66, s77, v66
  s_mov_b64 exec, 3
  global_load_dword v65, v66, s[28:29] sc1
  s_mov_b64 exec, -1
  ds_read_b64_tr_b16 v[48:49], v32 offset:4096
  ds_read_b64_tr_b16 v[50:51], v32 offset:4608
  ds_read_b64_tr_b16 v[52:53], v34 offset:4096
  ds_read_b64_tr_b16 v[54:55], v34 offset:4608
  ds_read_b64_tr_b16 v[56:57], v33 offset:4096
  ds_read_b64_tr_b16 v[58:59], v33 offset:4608
  ds_read_b64_tr_b16 v[60:61], v35 offset:4096
  ds_read_b64_tr_b16 v[62:63], v35 offset:4608
  s_waitcnt lgkmcnt(0)
  s_barrier
  ds_write_b128 v1, v[48:51] offset:4096
  ds_write_b128 v1, v[52:55] offset:5120
  ds_write_b128 v1, v[56:59] offset:6144
  ds_write_b128 v1, v[60:63] offset:7168
  s_waitcnt vmcnt(24) lgkmcnt(0)
  s_barrier
  ds_read_b64_tr_b16 v[48:49], v32 offset:8192
  ds_read_b64_tr_b16 v[50:51], v32 offset:8704
  ds_read_b64_tr_b16 v[52:53], v34 offset:8192
  ds_read_b64_tr_b16 v[54:55], v34 offset:8704
  ds_read_b64_tr_b16 v[56:57], v33 offset:8192
  ds_read_b64_tr_b16 v[58:59], v33 offset:8704
  ds_read_b64_tr_b16 v[60:61], v35 offset:8192
  ds_read_b64_tr_b16 v[62:63], v35 offset:8704
  s_waitcnt lgkmcnt(0)
  s_barrier
  ds_write_b128 v1, v[48:51] offset:8192
  ds_write_b128 v1, v[52:55] offset:9216
  ds_write_b128 v1, v[56:59] offset:10240
  ds_write_b128 v1, v[60:63] offset:11264
  s_waitcnt vmcnt(20) lgkmcnt(0)
  s_barrier
  ds_read_b64_tr_b16 v[48:49], v32 offset:12288
  ds_read_b64_tr_b16 v[50:51], v32 offset:12800
  ds_read_b64_tr_b16 v[52:53], v34 offset:12288
  ds_read_b64_tr_b16 v[54:55], v34 offset:12800
  ds_read_b64_tr_b16 v[56:57], v33 offset:12288
  ds_read_b64_tr_b16 v[58:59], v33 offset:12800
  ds_read_b64_tr_b16 v[60:61], v35 offset:12288
  ds_read_b64_tr_b16 v[62:63], v35 offset:12800
  s_waitcnt lgkmcnt(0)
  s_barrier
  ds_write_b128 v1, v[48:51] offset:12288
  ds_write_b128 v1, v[52:55] offset:13312
  ds_write_b128 v1, v[56:59] offset:14336
  ds_write_b128 v1, v[60:63] offset:15360
  s_waitcnt vmcnt(16) lgkmcnt(0)
  s_barrier
  ds_read_b64_tr_b16 v[48:49], v32 offset:16384
  ds_read_b64_tr_b16 v[50:51], v32 offset:16896
  ds_read_b64_tr_b16 v[52:53], v34 offset:16384
  ds_read_b64_tr_b16 v[54:55], v34 offset:16896
  ds_read_b64_tr_b16 v[56:57], v33 offset:16384
  ds_read_b64_tr_b16 v[58:59], v33 offset:16896
  ds_read_b64_tr_b16 v[60:61], v35 offset:16384
  ds_read_b64_tr_b16 v[62:63], v35 offset:16896
  s_waitcnt lgkmcnt(0)
  s_barrier
  ds_write_b128 v1, v[48:51] offset:16384
  ds_write_b128 v1, v[52:55] offset:17408
  ds_write_b128 v1, v[56:59] offset:18432
  ds_write_b128 v1, v[60:63] offset:19456
  s_waitcnt vmcnt(12) lgkmcnt(0)
  s_barrier
  ds_read_b64_tr_b16 v[48:49], v32 offset:20480
  ds_read_b64_tr_b16 v[50:51], v32 offset:20992
  ds_read_b64_tr_b16 v[52:53], v34 offset:20480
  ds_read_b64_tr_b16 v[54:55], v34 offset:20992
  ds_read_b64_tr_b16 v[56:57], v33 offset:20480
  ds_read_b64_tr_b16 v[58:59], v33 offset:20992
  ds_read_b64_tr_b16 v[60:61], v35 offset:20480
  ds_read_b64_tr_b16 v[62:63], v35 offset:20992
  s_waitcnt lgkmcnt(0)
  s_barrier
  ds_write_b128 v1, v[48:51] offset:20480
  ds_write_b128 v1, v[52:55] offset:21504
  ds_write_b128 v1, v[56:59] offset:22528
  ds_write_b128 v1, v[60:63] offset:23552
  s_waitcnt vmcnt(8) lgkmcnt(0)
  s_barrier
  v_mov_b32 v66, 76
  global_load_dword v64, v66, s[30:31] sc1
  ds_read_b64_tr_b16 v[48:49], v32 offset:24576
  ds_read_b64_tr_b16 v[50:51], v32 offset:25088
  ds_read_b64_tr_b16 v[52:53], v34 offset:24576
  ds_read_b64_tr_b16 v[54:55], v34 offset:25088
  ds_read_b64_tr_b16 v[56:57], v33 offset:24576
  ds_read_b64_tr_b16 v[58:59], v33 offset:25088
  ds_read_b64_tr_b16 v[60:61], v35 offset:24576
  ds_read_b64_tr_b16 v[62:63], v35 offset:25088
  s_waitcnt lgkmcnt(0)
  s_barrier
  ds_write_b128 v1, v[48:51] offset:24576
  ds_write_b128 v1, v[52:55] offset:25600
  ds_write_b128 v1, v[56:59] offset:26624
  ds_write_b128 v1, v[60:63] offset:27648
  s_waitcnt vmcnt(4) lgkmcnt(0)
  s_barrier
  ds_read_b64_tr_b16 v[48:49], v32 offset:28672
  ds_read_b64_tr_b16 v[50:51], v32 offset:29184
  ds_read_b64_tr_b16 v[52:53], v34 offset:28672
  ds_read_b64_tr_b16 v[54:55], v34 offset:29184
  ds_read_b64_tr_b16 v[56:57], v33 offset:28672
  ds_read_b64_tr_b16 v[58:59], v33 offset:29184
  ds_read_b64_tr_b16 v[60:61], v35 offset:28672
  ds_read_b64_tr_b16 v[62:63], v35 offset:29184
  s_waitcnt lgkmcnt(0)
  s_barrier
  ds_write_b128 v1, v[48:51] offset:28672
  ds_write_b128 v1, v[52:55] offset:29696
  ds_write_b128 v1, v[56:59] offset:30720
  ds_write_b128 v1, v[60:63] offset:31744
  s_waitcnt vmcnt(0) lgkmcnt(0)
  s_barrier
  ds_read_b64_tr_b16 v[48:49], v32 offset:32768
  ds_read_b64_tr_b16 v[50:51], v32 offset:33280
  ds_read_b64_tr_b16 v[52:53], v34 offset:32768
  ds_read_b64_tr_b16 v[54:55], v34 offset:33280
  ds_read_b64_tr_b16 v[56:57], v33 offset:32768
  ds_read_b64_tr_b16 v[58:59], v33 offset:33280
  ds_read_b64_tr_b16 v[60:61], v35 offset:32768
  ds_read_b64_tr_b16 v[62:63], v35 offset:33280
  s_waitcnt lgkmcnt(0)
  s_barrier
  ds_write_b128 v1, v[48:51] offset:32768
  ds_write_b128 v1, v[52:55] offset:33792
  ds_write_b128 v1, v[56:59] offset:34816
  ds_write_b128 v1, v[60:63] offset:35840
  s_waitcnt lgkmcnt(0)
  s_mov_b32 s36, 0
  s_add_u32 s40, s28, 67108864
  s_addc_u32 s41, s29, 0
  s_mov_b32 s42, 2097152
  s_mov_b32 s43, 0x00020000
  s_mov_b32 s44, s28
  s_mov_b32 s45, s29
  s_mov_b32 s46, 0x10000000
  s_mov_b32 s47, 0x00020000
  s_mov_b32 s48, 0
  s_mov_b32 s49, 1057792
  s_mul_i32 s67, s34, 9216
  s_lshl_b32 s74, s34, 14
  s_lshl_b32 s75, s35, 11
  s_add_u32 s64, s74, s75
  s_add_u32 s64, s64, 0
  s_add_u32 s65, s64, 8192
  s_lshl_b32 s74, s34, 13
  s_add_u32 s66, s74, s75
  s_add_u32 s66, s66, 50331648
  s_mov_b32 s69, 0
  s_mov_b32 s73, 0
  s_mov_b32 s90, 1073741824
  s_lshl_b32 s74, s34, 2
  s_add_u32 s91, s74, 69992448
  s_lshl_b32 s56, s35, 10
  s_lshl_b32 s57, s35, 8
  s_add_u32 s57, s57, 8192
  s_mov_b32 s88, s80
  s_mov_b32 s89, s80
  s_mov_b64 s[38:39], 0
  s_add_u32 s91, s91, 256
  s_waitcnt vmcnt(0)
  v_readfirstlane_b32 s76, v64
  s_cmp_ge_u32 s76, 32
  s_cbranch_scc1 .Lconcat_heads__mha_block__memory_aug_recurrent_mem_tr__prompt_kernelrec_e1
  v_mov_b32 v24, 76
  s_mov_b32 s75, 2000000
.Lconcat_heads__mha_block__memory_aug_recurrent_mem_tr__prompt_kernelrec_e0:
  global_load_dword v25, v24, s[30:31] sc1
  s_waitcnt vmcnt(0)
  v_readfirstlane_b32 s76, v25
  s_sub_u32 s75, s75, 1
  s_cmp_eq_u32 s75, 0
  s_cbranch_scc1 .Lconcat_heads__mha_block__memory_aug_recurrent_mem_tr__prompt_kernelrec_e1
  s_cmp_lt_u32 s76, 32
  s_cbranch_scc1 .Lconcat_heads__mha_block__memory_aug_recurrent_mem_tr__prompt_kernelrec_e0
.Lconcat_heads__mha_block__memory_aug_recurrent_mem_tr__prompt_kernelrec_e1:
  s_cmp_eq_u32 s97, 0
  s_cbranch_scc1 .Lconcat_heads__mha_block__memory_aug_recurrent_mem_tr__prompt_kernelrec_e2
  s_mov_b64 exec, 3
  v_cmp_eq_u32 vcc, 0, v65
  s_mov_b64 exec, -1
  s_cbranch_vccz .Lconcat_heads__mha_block__memory_aug_recurrent_mem_tr__prompt_kernelrec_e3
.Lconcat_heads__mha_block__memory_aug_recurrent_mem_tr__prompt_kernelrec_e2:
  v_mov_b32 v24, 72
  s_mov_b32 s95, 4000000
.ww22:
  global_load_dword v25, v24, s[30:31] sc1
  s_waitcnt vmcnt(0)
  v_readfirstlane_b32 s94, v25
  s_cmp_lg_u32 s94, 0
  s_cbranch_scc1 .ww22_ok
  s_sleep 1
  s_sub_u32 s95, s95, 1
  s_cmp_lg_u32 s95, 0
  s_cbranch_scc1 .ww22
.ww22_ok:
  v_lshlrev_b32 v24, 3, v0
  v_add_u32 v24, s91, v24
  v_subrev_u32 v24, 256, v24
  s_mov_b32 s95, 4000000
  s_mov_b32 exec_lo, 0x3
  s_mov_b32 exec_hi, 0x0
.wm23:
  global_load_dword v25, v24, s[28:29] sc1
  s_waitcnt vmcnt(0)
  v_cmp_eq_u32 vcc, 0, v25
  s_cbranch_vccz .wm23_ok
  s_sleep 1
  s_sub_u32 s95, s95, 1
  s_cmp_lg_u32 s95, 0
  s_cbranch_scc1 .wm23
.wm23_ok:
  s_mov_b64 exec, -1
.Lconcat_heads__mha_block__memory_aug_recurrent_mem_tr__prompt_kernelrec_e3:
  s_cmp_eq_u32 s35, 1
  s_cbranch_scc1 .Lconcat_heads__mha_block__memory_aug_recurrent_mem_tr__prompt_kernelrec_w1
  s_cmp_eq_u32 s35, 2
  s_cbranch_scc1 .Lconcat_heads__mha_block__memory_aug_recurrent_mem_tr__prompt_kernelrec_w2
  s_cmp_eq_u32 s35, 3
  s_cbranch_scc1 .Lconcat_heads__mha_block__memory_aug_recurrent_mem_tr__prompt_kernelrec_w3
.Lconcat_heads__mha_block__memory_aug_recurrent_mem_tr__prompt_kernelrec_w0:
  s_add_u32 s58, s64, 524288
  s_mov_b32 m0, 158720
  ds_read_b128 v[56:59], v1 offset:0
  ds_read_b128 v[60:63], v1 offset:1024
  ds_read_b128 v[64:67], v1 offset:2048
  ds_read_b128 v[68:71], v1 offset:3072
  v_mov_b64 v[32:33], 0
  v_mov_b64 v[34:35], 0
  v_mov_b64 v[36:37], 0
  v_mov_b64 v[38:39], 0
  v_mov_b64 v[40:41], 0
  v_mov_b64 v[42:43], 0
  v_mov_b64 v[44:45], 0
  s_mov_b32 s68, 400000
  s_waitcnt lgkmcnt(0)
  s_branch .Lconcat_heads__mha_block__memory_aug_recurrent_mem_tr__prompt_kernelrec_w0_g0
.Lconcat_heads__mha_block__memory_aug_recurrent_mem_tr__prompt_kernelrec_w0_gl:
  s_mov_b64 exec, vcc
  buffer_load_dwordx4 v[12:15], v0, s[40:43], s61 offen sc1
  buffer_load_dwordx4 v[16:19], v0, s[40:43], s62 offen sc1
  buffer_load_dwordx4 v[20:23], v46, s[40:43], s63 offen sc1
  s_mov_b64 exec, -1
  s_add_u32 s73, s73, 1
  s_sub_u32 s68, s68, 1
  s_cmp_eq_u32 s68, 0
  s_cbranch_scc1 .Lconcat_heads__mha_block__memory_aug_recurrent_mem_tr__prompt_kernelrec_w0_exit
  s_waitcnt vmcnt(3)
.Lconcat_heads__mha_block__memory_aug_recurrent_mem_tr__prompt_kernelrec_w0_g0:
  v_max3_u32 v24, v12, v13, v14
  v_max3_u32 v26, v15, v16, v17
  v_max3_u32 v24, v24, v18, v19
  v_max3_u32 v26, v26, v20, v21
  v_max3_u32 v24, v24, v22, v23
  v_max_u32 v24, v24, v26
  v_cmp_eq_u32 vcc, -1, v24
  s_cbranch_vccnz .Lconcat_heads__mha_block__memory_aug_recurrent_mem_tr__prompt_kernelrec_w0_gl
  ds_write_b128 v2, v[12:15] offset:0
  ds_write_b128 v2, v[16:19] offset:4096
  s_mov_b64 exec, 0xffff
  ds_write_b128 v2, v[20:23] offset:8192
  s_mov_b64 exec, -1
.Lconcat_heads__mha_block__memory_aug_recurrent_mem_tr__prompt_kernelrec_w0_have:
  v_mov_b64 v[46:47], 0
  buffer_load_dwordx4 v[48:51], v0, s[44:47], s64 offen sc1
  s_waitcnt lgkmcnt(3)
  v_smfmac_f32_16x16x64_bf16 v[36:39], v[12:15], v[64:71], v3
  ds_read_b128 v[64:67], v1 offset:18432
  ds_read_b128 v[68:71], v1 offset:19456
  buffer_load_dwordx4 v[52:55], v0, s[44:47], s64 offen offset:1024 sc1
  v_smfmac_f32_16x16x64_bf16 v[32:35], v[12:15], v[56:63], v3
  ds_read_b128 v[56:59], v1 offset:16384
  ds_read_b128 v[60:63], v1 offset:17408
  s_add_u32 s76, s36, 3
  v_smfmac_f32_16x16x64_bf16 v[36:39], v[16:19], v[88:95], v3
  s_and_b32 s76, s76, 3
  s_mul_i32 s77, s76, 294912
  v_mov_b64 v[72:73], -1
  v_smfmac_f32_16x16x64_bf16 v[32:35], v[16:19], v[80:87], v3
  s_add_u32 s59, s77, s67
  s_add_u32 s78, s59, 4096
  s_waitcnt lgkmcnt(4)
  s_barrier
  ds_read_b128 v[24:27], v2 offset:8192
  ds_read_b128 v[28:31], v2 offset:5120
  ds_read_b128 v[76:79], v2 offset:1024
  v_smfmac_f32_16x16x64_bf16 v[40:43], v[12:15], v[144:151], v3
  s_and_b32 s74, s36, 3
  s_mul_i32 s48, s74, 294912
  v_mov_b64 v[74:75], -1
  v_smfmac_f32_16x16x64_bf16 v[44:47], v[12:15], v[152:159], v3
  buffer_store_dwordx4 v[72:75], v0, s[40:43], s59 offen offset:0
  v_smfmac_f32_16x16x64_bf16 v[40:43], v[16:19], v[208:215], v3
  buffer_store_dwordx4 v[72:75], v0, s[40:43], s78 offen offset:0
  v_smfmac_f32_16x16x64_bf16 v[44:47], v[16:19], v[216:223], v3
  s_add_u32 s50, s48, s67
  s_add_u32 s81, s50, 8192
  s_add_u32 s51, s50, 4096
  s_add_u32 s75, s36, 1
  s_and_b32 s75, s75, 3
  s_mul_i32 s75, s75, 9216
  s_add_u32 s49, s75, 1179648
  s_add_u32 s61, s49, s56
  s_add_u32 s62, s61, 4096
  s_waitcnt lgkmcnt(2)
  v_smfmac_f32_16x16x64_bf16 v[36:39], v[24:27], v[64:71], v3
  ds_read_b128 v[64:67], v1 offset:6144
  ds_read_b128 v[68:71], v1 offset:7168
  v_smfmac_f32_16x16x64_bf16 v[32:35], v[24:27], v[56:63], v3
  ds_read_b128 v[56:59], v1 offset:4096
  ds_read_b128 v[60:63], v1 offset:5120
  v_smfmac_f32_16x16x64_bf16 v[40:43], v[24:27], a[16:23], v3
  s_add_u32 s63, s49, s57
  s_add_u32 s52, s48, 0
  v_smfmac_f32_16x16x64_bf16 v[44:47], v[24:27], a[24:31], v3
  ds_read_b128 v[24:27], v2 offset:6144
  s_add_u32 s53, s48, 73728
  s_waitcnt lgkmcnt(6)
  v_smfmac_f32_16x16x64_bf16 v[36:39], v[28:31], v[104:111], v3
  s_add_u32 s54, s48, 147456
  s_add_u32 s55, s48, 221184
  v_smfmac_f32_16x16x64_bf16 v[32:35], v[28:31], v[96:103], v3
  v_smfmac_f32_16x16x64_bf16 v[40:43], v[28:31], v[224:231], v3
  v_smfmac_f32_16x16x64_bf16 v[44:47], v[28:31], v[232:239], v3
  ds_read_b128 v[28:31], v2 offset:2048
  s_waitcnt lgkmcnt(6)
  v_smfmac_f32_16x16x64_bf16 v[40:43], v[76:79], v[160:167], v3
  s_waitcnt lgkmcnt(4)
  v_smfmac_f32_16x16x64_bf16 v[36:39], v[76:79], v[64:71], v3
  ds_read_b128 v[64:67], v1 offset:10240
  ds_read_b128 v[68:71], v1 offset:11264
  v_smfmac_f32_16x16x64_bf16 v[44:47], v[76:79], v[168:175], v3
  s_waitcnt lgkmcnt(4)
  v_smfmac_f32_16x16x64_bf16 v[32:35], v[76:79], v[56:63], v3
  ds_read_b128 v[56:59], v1 offset:8192
  ds_read_b128 v[60:63], v1 offset:9216
  s_waitcnt lgkmcnt(5)
  v_smfmac_f32_16x16x64_bf16 v[36:39], v[24:27], v[120:127], v3
  ds_read_b128 v[76:79], v2 offset:7168
  v_smfmac_f32_16x16x64_bf16 v[32:35], v[24:27], v[112:119], v3
  v_smfmac_f32_16x16x64_bf16 v[40:43], v[24:27], v[240:247], v3
  v_smfmac_f32_16x16x64_bf16 v[44:47], v[24:27], v[248:255], v3
  ds_read_b128 v[24:27], v2 offset:3072
  s_waitcnt lgkmcnt(6)
  v_smfmac_f32_16x16x64_bf16 v[40:43], v[28:31], v[176:183], v3
  v_smfmac_f32_16x16x64_bf16 v[44:47], v[28:31], v[184:191], v3
  s_waitcnt lgkmcnt(4)
  v_smfmac_f32_16x16x64_bf16 v[36:39], v[28:31], v[64:71], v3
  ds_read_b128 v[64:67], v1 offset:14336
  ds_read_b128 v[68:71], v1 offset:15360
  s_waitcnt lgkmcnt(4)
  v_smfmac_f32_16x16x64_bf16 v[32:35], v[28:31], v[56:63], v3
  ds_read_b128 v[56:59], v1 offset:12288
  ds_read_b128 v[60:63], v1 offset:13312
  s_waitcnt lgkmcnt(5)
  v_smfmac_f32_16x16x64_bf16 v[36:39], v[76:79], v[136:143], v3
  v_smfmac_f32_16x16x64_bf16 v[32:35], v[76:79], v[128:135], v3
  v_smfmac_f32_16x16x64_bf16 v[40:43], v[76:79], a[0:7], v3
  v_smfmac_f32_16x16x64_bf16 v[44:47], v[76:79], a[8:15], v3
  s_waitcnt lgkmcnt(4)
  v_smfmac_f32_16x16x64_bf16 v[40:43], v[24:27], v[192:199], v3
  v_smfmac_f32_16x16x64_bf16 v[44:47], v[24:27], v[200:207], v3
  s_waitcnt lgkmcnt(2)
  v_smfmac_f32_16x16x64_bf16 v[36:39], v[24:27], v[64:71], v3
  buffer_load_dwordx4 v[64:67], v0, s[44:47], s65 offen sc1
  buffer_load_dwordx4 v[68:71], v0, s[44:47], s65 offen offset:1024 sc1
  s_waitcnt vmcnt(7)
  v_cvt_pk_bf16_f32 v16, v40, v41
  v_cvt_pk_bf16_f32 v17, v42, v43
  s_waitcnt lgkmcnt(0)
  v_smfmac_f32_16x16x64_bf16 v[32:35], v[24:27], v[56:63], v3
  s_nop 0
  v_cvt_pk_bf16_f32 v14, v36, v37
  v_cvt_pk_bf16_f32 v15, v38, v39
  v_cvt_pk_bf16_f32 v18, v44, v45
  v_cvt_pk_bf16_f32 v19, v46, v47
  s_nop 2
  v_cvt_pk_bf16_f32 v12, v32, v33
  v_cvt_pk_bf16_f32 v13, v34, v35
  v_mfma_f32_16x16x16_bf16 v[36:39], v[14:15], v[4:5], 0
  v_mov_b64 v[56:57], 0
  v_mov_b64 v[58:59], 0
  v_mov_b64 v[60:61], 0
  v_mfma_f32_16x16x16_bf16 v[32:35], v[12:13], v[4:5], 0
  v_mov_b64 v[62:63], 0
  v_smfmac_f32_16x16x64_bf16 v[56:59], v[28:31], a[64:71], v3
  v_cvt_pk_bf16_f32 v14, v36, v37
  v_mfma_f32_16x16x16_bf16 v[40:43], v[16:17], v[4:5], 0
  v_cvt_pk_bf16_f32 v12, v32, v33
  v_cvt_pk_bf16_f32 v13, v34, v35
  v_cvt_pk_bf16_f32 v15, v38, v39
  v_mfma_f32_16x16x16_bf16 v[44:47], v[18:19], v[4:5], 0
  s_waitcnt vmcnt(5)
  v_mfma_f32_16x16x32_bf16 v[36:39], v[48:51], v[12:15], 0
  v_cvt_pk_bf16_f32 v16, v40, v41
  v_cvt_pk_bf16_f32 v17, v42, v43
  s_nop 1
  v_cvt_pk_bf16_f32 v18, v44, v45
  v_cvt_pk_bf16_f32 v19, v46, v47
  s_waitcnt vmcnt(4)
  v_mfma_f32_16x16x32_bf16 v[40:43], v[52:55], v[12:15], 0
  buffer_store_dwordx4 v[16:19], v0, s[44:47], s66 offen sc1
  v_mfma_f32_16x16x32_bf16 v[32:35], v[16:19], v[12:15], 0
  s_nop 3
  v_cndmask_b32 v36, v40, v36, s[84:85]
  v_cndmask_b32 v37, v41, v37, s[84:85]
  v_cndmask_b32 v38, v42, v38, s[84:85]
  v_cndmask_b32 v39, v43, v39, s[84:85]
  ds_write_b128 v2, v[36:39] offset:11264
  s_mov_b64 exec, s[84:85]
  ds_write2_b32 v10, v32, v34 offset0:0 offset1:1
  s_mov_b64 exec, -1
  v_smfmac_f32_16x16x64_bf16 v[60:63], v[28:31], a[72:79], v3
  ds_read_b128 v[28:31], v2 offset:0
  ds_read_b128 v[20:23], v2 offset:4096
  v_smfmac_f32_16x16x64_bf16 v[56:59], v[76:79], a[144:151], v3
  v_smfmac_f32_16x16x64_bf16 v[60:63], v[76:79], a[152:159], v3
  ds_read_b128 v[76:79], v1 offset:25600
  v_smfmac_f32_16x16x64_bf16 v[56:59], v[24:27], a[80:87], v3
  v_smfmac_f32_16x16x64_bf16 v[60:63], v[24:27], a[88:95], v3
  ds_read_b128 v[24:27], v2 offset:8192
  v_mov_b64 v[16:17], 0
  v_mov_b64 v[18:19], 0
  s_waitcnt lgkmcnt(4)
  s_barrier
  ds_read_b128 v[40:43], v2 offset:12288
  ds_read_b128 v[44:47], v2 offset:13312
  ds_read_b128 v[48:51], v2 offset:14336
  ds_read_b64 v[52:53], v10 offset:256
  ds_read_b64 v[72:73], v10 offset:512
  ds_read_b64 v[12:13], v10 offset:768
  s_waitcnt lgkmcnt(9)
  v_smfmac_f32_16x16x64_bf16 v[56:59], v[28:31], a[32:39], v3
  v_smfmac_f32_16x16x64_bf16 v[60:63], v[28:31], a[40:47], v3
  ds_read_b128 v[28:31], v2 offset:5120
  s_waitcnt lgkmcnt(9)
  v_smfmac_f32_16x16x64_bf16 v[56:59], v[20:23], a[96:103], v3
  v_smfmac_f32_16x16x64_bf16 v[60:63], v[20:23], a[104:111], v3
  ds_read_b128 v[20:23], v2 offset:1024
  s_waitcnt lgkmcnt(8)
  v_smfmac_f32_16x16x64_bf16 v[56:59], v[24:27], a[160:167], v3
  v_smfmac_f32_16x16x64_bf16 v[60:63], v[24:27], a[168:175], v3
  ds_read_b128 v[24:27], v2 offset:6144
  s_waitcnt lgkmcnt(8)
  v_add_f32 v36, v36, v40
  v_add_f32 v37, v37, v41
  v_add_f32 v38, v38, v42
  v_add_f32 v39, v39, v43
  s_waitcnt lgkmcnt(6)
  v_pk_add_f32 v[44:45], v[44:45], v[48:49]
  v_pk_add_f32 v[46:47], v[46:47], v[50:51]
  v_pk_add_f32 v[36:37], v[36:37], v[44:45]
  v_pk_add_f32 v[38:39], v[38:39], v[46:47]
  s_waitcnt lgkmcnt(4)
  v_pk_add_f32 v[52:53], v[52:53], v[72:73]
  s_waitcnt lgkmcnt(3)
  v_add_f32 v32, v32, v12
  v_add_f32 v34, v34, v13
  v_add_f32 v32, v32, v52
  v_add_f32 v34, v34, v53
  v_max3_f32 v72, v36, v37, v38
  v_max3_f32 v73, v39, v32, v34
  v_max_f32 v72, v72, v73
  s_waitcnt lgkmcnt(2)
  v_smfmac_f32_16x16x64_bf16 v[56:59], v[28:31], a[112:119], v3
  v_max_f32_dpp v72, v72, v72 quad_perm:[1,0,3,2] row_mask:0xf bank_mask:0xf
  v_mov_b32 v73, v72
  v_smfmac_f32_16x16x64_bf16 v[60:63], v[28:31], a[120:127], v3
  s_nop 0
  v_permlane16_swap_b32 v72, v73
  v_max_f32 v72, v72, v73
  v_mov_b32 v73, v72
  s_waitcnt lgkmcnt(1)
  v_smfmac_f32_16x16x64_bf16 v[56:59], v[20:23], a[48:55], v3
  v_permlane32_swap_b32 v72, v73
  v_max_f32 v72, v72, v73
  v_mul_f32 v72, s80, v72
  v_fma_f32 v36, v36, s88, -v72
  v_fma_f32 v37, v37, s88, -v72
  v_pk_fma_f32 v[38:39], v[38:39], s[88:89], v[72:73] op_sel_hi:[1,1,0] neg_lo:[0,0,1] neg_hi:[0,0,1]
  v_fma_f32 v32, v32, s80, -v72
  v_fma_f32 v34, v34, s80, -v72
  v_exp_f32 v36, v36
  v_exp_f32 v37, v37
  v_exp_f32 v38, v38
  v_exp_f32 v39, v39
  v_smfmac_f32_16x16x64_bf16 v[60:63], v[20:23], a[56:63], v3
  v_exp_f32 v32, v32
  v_exp_f32 v34, v34
  v_add_f32 v73, v36, v37
  v_add_f32 v74, v38, v39
  v_add_f32 v75, v32, v34
  v_add_f32 v73, v73, v74
  s_waitcnt lgkmcnt(0)
  v_smfmac_f32_16x16x64_bf16 v[56:59], v[24:27], a[128:135], v3
  v_smfmac_f32_16x16x64_bf16 v[60:63], v[24:27], a[136:143], v3
  v_fmac_f32 v73, 0.5, v75
  v_cvt_pk_bf16_f32 v40, v36, v37
  v_cvt_pk_bf16_f32 v41, v38, v39
  v_add_f32_dpp v73, v73, v73 quad_perm:[1,0,3,2] row_mask:0xf bank_mask:0xf
  v_mov_b32_dpp v42, v40 quad_perm:[1,0,3,2] row_mask:0xf bank_mask:0xf
  v_mov_b32_dpp v43, v41 quad_perm:[1,0,3,2] row_mask:0xf bank_mask:0xf
  v_mov_b32 v74, v73
  s_waitcnt vmcnt(2)
  v_mfma_f32_16x16x32_bf16 v[52:55], v[64:67], v[40:43], 0
  ds_read_b128 v[64:67], v1 offset:22528
  v_permlane16_swap_b32 v73, v74
  s_waitcnt vmcnt(1)
  v_mfma_f32_16x16x32_bf16 v[12:15], v[68:71], v[40:43], 0
  ds_read_b128 v[68:71], v1 offset:23552
  v_cvt_pk_bf16_f32 v44, v32, v32
  v_cvt_pk_bf16_f32 v45, v34, v34
  v_cvt_pk_bf16_f32 v48, v56, v57
  v_cvt_pk_bf16_f32 v49, v58, v59
  v_cvt_pk_bf16_f32 v50, v60, v61
  v_cvt_pk_bf16_f32 v51, v62, v63
  v_add_f32 v73, v73, v74
  v_mov_b32 v74, v73
  v_mfma_f32_16x16x16_bf16 v[52:55], v[48:49], v[44:45], v[52:55]
  buffer_store_dwordx4 v[48:51], v0, s[44:47], s66 offen offset:1024 sc1
  s_cmp_eq_u32 s36, 63
  s_cbranch_scc1 .Lconcat_heads__mha_block__memory_aug_recurrent_mem_tr__prompt_kernelrec_w0_exit
  v_mfma_f32_16x16x16_bf16 v[12:15], v[50:51], v[44:45], v[12:15]
  v_permlane32_swap_b32 v73, v74
  v_add_f32 v73, v73, v74
  v_rcp_f32 v72, v73
  ds_read_b128 v[56:59], v1 offset:20480
  v_mul_f32 v52, v52, v72
  v_mul_f32 v53, v53, v72
  v_pk_mul_f32 v[54:55], v[54:55], v[72:73] op_sel_hi:[1,0]
  s_nop 0
  v_pk_mul_f32 v[12:13], v[12:13], v[72:73] op_sel_hi:[1,0]
  v_pk_mul_f32 v[14:15], v[14:15], v[72:73] op_sel_hi:[1,0]
  v_cvt_pk_bf16_f32 v44, v52, v53
  v_cvt_pk_bf16_f32 v45, v54, v55
  v_cvt_pk_bf16_f32 v46, v12, v13
  v_cvt_pk_bf16_f32 v47, v14, v15
  s_mov_b64 exec, s[84:85]
  ds_write_b64 v9, v[44:45] offset:0
  ds_write_b64 v9, v[46:47] offset:256
  s_mov_b64 exec, -1
  ds_read_b128 v[60:63], v1 offset:21504
  v_mov_b64 v[12:13], 0
  v_mov_b64 v[14:15], 0
  ds_read_b128 v[72:75], v1 offset:24576
  v_mov_b64 v[28:29], 0
  v_mov_b64 v[30:31], 0
  v_mov_b64 v[32:33], 0
  v_mov_b64 v[34:35], 0
  v_mov_b64 v[44:45], 0
  v_mov_b64 v[46:47], 0
  s_waitcnt lgkmcnt(2)
  s_barrier
  ds_read_b128 v[48:51], v2 offset:9216
  ds_read_b128 v[52:55], v2 offset:10240
  v_mov_b64 v[20:21], 0
  v_mov_b64 v[22:23], 0
  v_mov_b64 v[24:25], 0
  v_mov_b64 v[26:27], 0
  v_mov_b64 v[36:37], 0
  v_mov_b64 v[38:39], 0
  v_mov_b64 v[40:41], 0
  v_mov_b64 v[42:43], 0
  s_waitcnt lgkmcnt(1)
  v_smfmac_f32_16x16x64_bf16 v[12:15], v[48:51], a[176:183], v3
  v_smfmac_f32_16x16x64_bf16 v[16:19], v[48:51], a[184:191], v3
  s_waitcnt lgkmcnt(0)
  v_smfmac_f32_16x16x64_bf16 v[12:15], v[52:55], v[56:63], v3
  ds_read_b128 v[56:59], v1 offset:26624
  ds_read_b128 v[60:63], v1 offset:27648
  v_smfmac_f32_16x16x64_bf16 v[16:19], v[52:55], v[64:71], v3
  ds_read_b128 v[64:67], v1 offset:28672
  ds_read_b128 v[68:71], v1 offset:29696
  v_smfmac_f32_16x16x64_bf16 v[28:31], v[48:51], v[72:79], v3
  ds_read_b128 v[72:75], v1 offset:30720
  ds_read_b128 v[76:79], v1 offset:31744
  v_smfmac_f32_16x16x64_bf16 v[44:47], v[48:51], a[240:247], v3
  v_smfmac_f32_16x16x64_bf16 v[44:47], v[52:55], a[248:255], v3
  v_smfmac_f32_16x16x64_bf16 v[20:23], v[48:51], a[192:199], v3
  v_smfmac_f32_16x16x64_bf16 v[24:27], v[48:51], a[200:207], v3
  v_smfmac_f32_16x16x64_bf16 v[20:23], v[52:55], a[224:231], v3
  v_add_f32 v44, v44, v45
  v_add_f32 v46, v46, v47
  v_smfmac_f32_16x16x64_bf16 v[24:27], v[52:55], a[232:239], v3
  s_waitcnt lgkmcnt(4)
  v_smfmac_f32_16x16x64_bf16 v[32:35], v[48:51], v[56:63], v3
  ds_read_b128 v[56:59], v1 offset:32768
  ds_read_b128 v[60:63], v1 offset:33792
  v_cvt_pk_bf16_f32 v44, v44, v46
  s_waitcnt lgkmcnt(4)
  v_smfmac_f32_16x16x64_bf16 v[28:31], v[52:55], v[64:71], v3
  ds_read_b128 v[64:67], v1 offset:34816
  ds_read_b128 v[68:71], v1 offset:35840
  v_add_f32 v12, v12, v13
  v_add_f32 v14, v14, v15
  v_smfmac_f32_16x16x64_bf16 v[36:39], v[48:51], a[208:215], v3
  buffer_store_dword v44, v7, s[40:43], s81 offen offset:0
  v_cvt_pk_bf16_f32 v12, v12, v14
  v_add_f32 v16, v16, v17
  v_add_f32 v18, v18, v19
  s_waitcnt lgkmcnt(4)
  v_smfmac_f32_16x16x64_bf16 v[32:35], v[52:55], v[72:79], v3
  buffer_store_dword v12, v7, s[40:43], s50 offen offset:0
  v_smfmac_f32_16x16x64_bf16 v[40:43], v[48:51], a[216:223], v3
  v_cvt_pk_bf16_f32 v16, v16, v18
  v_add_f32 v20, v20, v21
  v_add_f32 v22, v22, v23
  buffer_store_dword v16, v7, s[40:43], s50 offen offset:256
  v_cvt_pk_bf16_f32 v20, v20, v22
  v_add_f32 v24, v24, v25
  v_add_f32 v26, v26, v27
  s_waitcnt lgkmcnt(2)
  v_smfmac_f32_16x16x64_bf16 v[36:39], v[52:55], v[56:63], v3
  buffer_store_dword v20, v7, s[40:43], s50 offen offset:2048
  v_cvt_pk_bf16_f32 v24, v24, v26
  v_add_f32 v28, v28, v29
  v_add_f32 v30, v30, v31
  buffer_store_dword v24, v7, s[40:43], s50 offen offset:2304
  s_waitcnt lgkmcnt(0)
  v_smfmac_f32_16x16x64_bf16 v[40:43], v[52:55], v[64:71], v3
  v_cvt_pk_bf16_f32 v28, v28, v30
  v_add_f32 v32, v32, v33
  v_add_f32 v34, v34, v35
  buffer_store_dword v28, v7, s[40:43], s51 offen offset:0
  v_cvt_pk_bf16_f32 v32, v32, v34
  v_add_f32 v36, v36, v37
  v_add_f32 v38, v38, v39
  buffer_store_dword v32, v7, s[40:43], s51 offen offset:256
  v_cvt_pk_bf16_f32 v36, v36, v38
  v_add_f32 v40, v40, v41
  v_add_f32 v42, v42, v43
  buffer_store_dword v36, v7, s[40:43], s51 offen offset:2048
  v_cvt_pk_bf16_f32 v40, v40, v42
  buffer_store_dword v40, v7, s[40:43], s51 offen offset:2304
  s_cmp_eq_u32 s36, 63
  s_cbranch_scc1 .Lconcat_heads__mha_block__memory_aug_recurrent_mem_tr__prompt_kernelrec_w0_exit
  s_nop 7
  s_nop 7
  s_nop 7
  s_nop 7
  s_nop 7
  s_nop 7
  s_nop 1
  buffer_load_dwordx4 v[12:15], v8, s[40:43], s52 offen sc1
  buffer_load_dwordx4 v[16:19], v8, s[40:43], s53 offen sc1
  buffer_load_dwordx4 v[20:23], v8, s[40:43], s54 offen sc1
  buffer_load_dwordx4 v[24:27], v8, s[40:43], s55 offen sc1
  v_lshrrev_b32 v36, 4, v0
  v_and_b32 v37, 1, v36
  v_lshlrev_b32 v37, 4, v37
  v_mov_b32 v38, 0x3f80
  v_lshlrev_b32 v37, v37, v38
  v_bfe_u32 v36, v36, 1, 2
  v_cmp_eq_u32 vcc, 0, v36
  s_nop 1
  v_cndmask_b32 v28, 0, v37, vcc
  v_cmp_eq_u32 vcc, 1, v36
  s_nop 1
  v_cndmask_b32 v29, 0, v37, vcc
  v_cmp_eq_u32 vcc, 2, v36
  s_nop 1
  v_cndmask_b32 v30, 0, v37, vcc
  v_cmp_eq_u32 vcc, 3, v36
  s_nop 1
  v_cndmask_b32 v31, 0, v37, vcc
  s_add_u32 s64, s64, 524288
  s_add_u32 s65, s65, 524288
  s_add_u32 s66, s66, 262144
  s_mov_b32 s68, 400000
  s_lshl_b32 s74, s35, 31
  s_and_b32 s74, s74, 0x1800
  s_add_u32 s58, s64, 524288
  s_add_u32 s58, s58, s74
  s_cmp_ge_u32 s36, 62
  s_cselect_b32 s58, 1073741824, s58
  s_lshl_b32 s74, s36, 7
  s_lshl_b32 s75, s34, 2
  s_add_u32 s74, s74, s75
  s_add_u32 s90, s74, 70008832
  s_min_u32 s75, s36, 60
  s_lshl_b32 s75, s75, 7
  s_lshl_b32 s74, s34, 2
  s_add_u32 s74, s74, s75
  s_add_u32 s91, s74, 69992832
  ds_read_b128 v[56:59], v1 offset:0
  ds_read_b128 v[60:63], v1 offset:1024
  ds_read_b128 v[64:67], v1 offset:2048
  ds_read_b128 v[68:71], v1 offset:3072
  v_mov_b64 v[36:37], 0
  v_mov_b64 v[38:39], 0
  v_mov_b64 v[40:41], 0
  v_mov_b64 v[42:43], 0
  v_mov_b64 v[44:45], 0
  v_and_b32 v46, 0xf0, v0
  s_mov_b64 s[76:77], -1
.Lconcat_heads__mha_block__memory_aug_recurrent_mem_tr__prompt_kernelrec_w0_pl:
  s_mov_b64 exec, s[76:77]
  buffer_load_dwordx4 v[12:15], v8, s[40:43], s52 offen sc1
  buffer_load_dwordx4 v[16:19], v8, s[40:43], s53 offen sc1
  buffer_load_dwordx4 v[20:23], v8, s[40:43], s54 offen sc1
  buffer_load_dwordx4 v[24:27], v8, s[40:43], s55 offen sc1
  s_mov_b64 exec, -1
  s_add_u32 s69, s69, 1
  s_sub_u32 s68, s68, 1
  s_cmp_eq_u32 s68, 0
  s_cbranch_scc1 .Lconcat_heads__mha_block__memory_aug_recurrent_mem_tr__prompt_kernelrec_w0_exit
  s_waitcnt vmcnt(7)
  v_mfma_f32_16x16x32_bf16 v[32:35], v[28:31], v[12:15], 0
  s_waitcnt vmcnt(6)
  v_mfma_f32_16x16x32_bf16 v[32:35], v[28:31], v[16:19], v[32:35]
  s_waitcnt vmcnt(5)
  v_mfma_f32_16x16x32_bf16 v[32:35], v[28:31], v[20:23], v[32:35]
  s_waitcnt vmcnt(4)
  v_mfma_f32_16x16x32_bf16 v[32:35], v[28:31], v[24:27], v[32:35]
  v_max3_u32 v48, v12, v13, v14
  v_max3_u32 v49, v15, v16, v17
  v_max3_u32 v48, v48, v18, v19
  v_max3_u32 v49, v49, v20, v21
  v_max3_u32 v48, v48, v22, v23
  v_max3_u32 v49, v49, v24, v25
  v_max3_u32 v48, v48, v26, v27
  v_max_u32 v48, v48, v49
  v_cmp_eq_u32 s[76:77], -1, v48
  v_add_f32_dpp v32, v32, v32 row_ror:8 row_mask:0xf bank_mask:0xf
  v_add_f32_dpp v33, v33, v33 row_ror:8 row_mask:0xf bank_mask:0xf
  v_add_f32_dpp v34, v34, v34 row_ror:8 row_mask:0xf bank_mask:0xf
  v_add_f32_dpp v35, v35, v35 row_ror:8 row_mask:0xf bank_mask:0xf
  v_cmp_u_f32 vcc, v32, v32
  s_cbranch_vccnz .Lconcat_heads__mha_block__memory_aug_recurrent_mem_tr__prompt_kernelrec_w0_pl
.Lconcat_heads__mha_block__memory_aug_recurrent_mem_tr__prompt_kernelrec_w0_pub:
  v_cvt_pk_bf16_f32 v28, v32, v34
  v_cvt_pk_bf16_f32 v29, v33, v35
  v_cndmask_b32 v28, v29, v28, s[100:101]
  s_mov_b64 exec, s[70:71]
  buffer_store_dword v28, v11, s[40:43], s49 offen
  s_mov_b64 exec, -1
  v_mov_b64 v[32:33], 0
  v_mov_b64 v[34:35], 0
  s_branch .Lconcat_heads__mha_block__memory_aug_recurrent_mem_tr__prompt_kernelrec_w0_gpre
.Lconcat_heads__mha_block__memory_aug_recurrent_mem_tr__prompt_kernelrec_w0_nojob:
.Lconcat_heads__mha_block__memory_aug_recurrent_mem_tr__prompt_kernelrec_w0_gpre:
  buffer_load_dwordx4 v[12:15], v0, s[40:43], s61 offen sc1
  buffer_load_dwordx4 v[16:19], v0, s[40:43], s62 offen sc1
  buffer_load_dwordx4 v[20:23], v46, s[40:43], s63 offen sc1
  s_add_u32 s36, s36, 1
  s_nop 7
  s_nop 7
  s_nop 7
  s_nop 0
  s_mov_b64 vcc, -1
  s_branch .Lconcat_heads__mha_block__memory_aug_recurrent_mem_tr__prompt_kernelrec_w0_gl
.Lconcat_heads__mha_block__memory_aug_recurrent_mem_tr__prompt_kernelrec_w0_exit:
  s_branch .Lconcat_heads__mha_block__memory_aug_recurrent_mem_tr__prompt_kernelrec_done
.Lconcat_heads__mha_block__memory_aug_recurrent_mem_tr__prompt_kernelrec_w1:
  s_add_u32 s58, s64, 524288
  s_mov_b32 m0, 159744
  ds_read_b128 v[56:59], v1 offset:4096
  ds_read_b128 v[60:63], v1 offset:5120
  ds_read_b128 v[64:67], v1 offset:6144
  ds_read_b128 v[68:71], v1 offset:7168
  v_mov_b64 v[32:33], 0
  v_mov_b64 v[34:35], 0
  v_mov_b64 v[36:37], 0
  v_mov_b64 v[38:39], 0
  v_mov_b64 v[40:41], 0
  v_mov_b64 v[42:43], 0
  v_mov_b64 v[44:45], 0
  s_mov_b32 s68, 400000
  s_waitcnt lgkmcnt(0)
  s_branch .Lconcat_heads__mha_block__memory_aug_recurrent_mem_tr__prompt_kernelrec_w1_g0
.Lconcat_heads__mha_block__memory_aug_recurrent_mem_tr__prompt_kernelrec_w1_gl:
  s_mov_b64 exec, vcc
  buffer_load_dwordx4 v[12:15], v0, s[40:43], s61 offen sc1
  buffer_load_dwordx4 v[16:19], v0, s[40:43], s62 offen sc1
  buffer_load_dwordx4 v[20:23], v46, s[40:43], s63 offen sc1
  s_mov_b64 exec, -1
  s_add_u32 s73, s73, 1
  s_sub_u32 s68, s68, 1
  s_cmp_eq_u32 s68, 0
  s_cbranch_scc1 .Lconcat_heads__mha_block__memory_aug_recurrent_mem_tr__prompt_kernelrec_w1_exit
  s_waitcnt vmcnt(3)
.Lconcat_heads__mha_block__memory_aug_recurrent_mem_tr__prompt_kernelrec_w1_g0:
  v_max3_u32 v24, v12, v13, v14
  v_max3_u32 v26, v15, v16, v17
  v_max3_u32 v24, v24, v18, v19
  v_max3_u32 v26, v26, v20, v21
  v_max3_u32 v24, v24, v22, v23
  v_max_u32 v24, v24, v26
  v_cmp_eq_u32 vcc, -1, v24
  s_cbranch_vccnz .Lconcat_heads__mha_block__memory_aug_recurrent_mem_tr__prompt_kernelrec_w1_gl
  ds_write_b128 v2, v[12:15] offset:1024
  ds_write_b128 v2, v[16:19] offset:5120
  s_mov_b64 exec, 0xffff
  ds_write_b128 v2, v[20:23] offset:8448
  s_mov_b64 exec, -1
.Lconcat_heads__mha_block__memory_aug_recurrent_mem_tr__prompt_kernelrec_w1_have:
  v_mov_b64 v[46:47], 0
  buffer_load_dwordx4 v[48:51], v0, s[44:47], s64 offen sc1
  s_waitcnt lgkmcnt(3)
  v_smfmac_f32_16x16x64_bf16 v[36:39], v[12:15], v[64:71], v3
  ds_read_b128 v[64:67], v1 offset:18432
  ds_read_b128 v[68:71], v1 offset:19456
  buffer_load_dwordx4 v[52:55], v0, s[44:47], s64 offen offset:1024 sc1
  v_smfmac_f32_16x16x64_bf16 v[32:35], v[12:15], v[56:63], v3
  ds_read_b128 v[56:59], v1 offset:16384
  ds_read_b128 v[60:63], v1 offset:17408
  s_add_u32 s76, s36, 3
  v_smfmac_f32_16x16x64_bf16 v[36:39], v[16:19], v[104:111], v3
  s_and_b32 s76, s76, 3
  s_mul_i32 s77, s76, 294912
  v_mov_b64 v[72:73], -1
  v_smfmac_f32_16x16x64_bf16 v[32:35], v[16:19], v[96:103], v3
  s_add_u32 s59, s77, s67
  s_add_u32 s78, s59, 4096
  s_waitcnt lgkmcnt(4)
  s_barrier
  ds_read_b128 v[24:27], v2 offset:8192
  ds_read_b128 v[28:31], v2 offset:4096
  ds_read_b128 v[76:79], v2 offset:0
  v_smfmac_f32_16x16x64_bf16 v[40:43], v[12:15], v[160:167], v3
  s_and_b32 s74, s36, 3
  s_mul_i32 s48, s74, 294912
  v_mov_b64 v[74:75], -1
  v_smfmac_f32_16x16x64_bf16 v[44:47], v[12:15], v[168:175], v3
  buffer_store_dwordx4 v[72:75], v0, s[40:43], s59 offen offset:1024
  v_smfmac_f32_16x16x64_bf16 v[40:43], v[16:19], v[224:231], v3
  buffer_store_dwordx4 v[72:75], v0, s[40:43], s78 offen offset:1024
  v_smfmac_f32_16x16x64_bf16 v[44:47], v[16:19], v[232:239], v3
  s_add_u32 s50, s48, s67
  s_add_u32 s81, s50, 8192
  s_add_u32 s51, s50, 4096
  s_add_u32 s75, s36, 1
  s_and_b32 s75, s75, 3
  s_mul_i32 s75, s75, 9216
  s_add_u32 s49, s75, 1179648
  s_add_u32 s61, s49, s56
  s_add_u32 s62, s61, 4096
  s_waitcnt lgkmcnt(2)
  v_smfmac_f32_16x16x64_bf16 v[36:39], v[24:27], v[64:71], v3
  ds_read_b128 v[64:67], v1 offset:2048
  ds_read_b128 v[68:71], v1 offset:3072
  v_smfmac_f32_16x16x64_bf16 v[32:35], v[24:27], v[56:63], v3
  ds_read_b128 v[56:59], v1 offset:0
  ds_read_b128 v[60:63], v1 offset:1024
  v_smfmac_f32_16x16x64_bf16 v[40:43], v[24:27], a[16:23], v3
  s_add_u32 s63, s49, s57
  s_add_u32 s52, s48, 0
  v_smfmac_f32_16x16x64_bf16 v[44:47], v[24:27], a[24:31], v3
  ds_read_b128 v[24:27], v2 offset:6144
  s_add_u32 s53, s48, 73728
  s_waitcnt lgkmcnt(6)
  v_smfmac_f32_16x16x64_bf16 v[36:39], v[28:31], v[88:95], v3
  s_add_u32 s54, s48, 147456
  s_add_u32 s55, s48, 221184
  v_smfmac_f32_16x16x64_bf16 v[32:35], v[28:31], v[80:87], v3
  v_smfmac_f32_16x16x64_bf16 v[40:43], v[28:31], v[208:215], v3
  v_smfmac_f32_16x16x64_bf16 v[44:47], v[28:31], v[216:223], v3
  ds_read_b128 v[28:31], v2 offset:2048
  s_waitcnt lgkmcnt(6)
  v_smfmac_f32_16x16x64_bf16 v[40:43], v[76:79], v[144:151], v3
  s_waitcnt lgkmcnt(4)
  v_smfmac_f32_16x16x64_bf16 v[36:39], v[76:79], v[64:71], v3
  ds_read_b128 v[64:67], v1 offset:10240
  ds_read_b128 v[68:71], v1 offset:11264
  v_smfmac_f32_16x16x64_bf16 v[44:47], v[76:79], v[152:159], v3
  s_waitcnt lgkmcnt(4)
  v_smfmac_f32_16x16x64_bf16 v[32:35], v[76:79], v[56:63], v3
  ds_read_b128 v[56:59], v1 offset:8192
  ds_read_b128 v[60:63], v1 offset:9216
  s_waitcnt lgkmcnt(5)
  v_smfmac_f32_16x16x64_bf16 v[36:39], v[24:27], v[120:127], v3
  ds_read_b128 v[76:79], v2 offset:7168
  v_smfmac_f32_16x16x64_bf16 v[32:35], v[24:27], v[112:119], v3
  v_smfmac_f32_16x16x64_bf16 v[40:43], v[24:27], v[240:247], v3
  v_smfmac_f32_16x16x64_bf16 v[44:47], v[24:27], v[248:255], v3
  ds_read_b128 v[24:27], v2 offset:3072
  s_waitcnt lgkmcnt(6)
  v_smfmac_f32_16x16x64_bf16 v[40:43], v[28:31], v[176:183], v3
  v_smfmac_f32_16x16x64_bf16 v[44:47], v[28:31], v[184:191], v3
  s_waitcnt lgkmcnt(4)
  v_smfmac_f32_16x16x64_bf16 v[36:39], v[28:31], v[64:71], v3
  ds_read_b128 v[64:67], v1 offset:14336
  ds_read_b128 v[68:71], v1 offset:15360
  s_waitcnt lgkmcnt(4)
  v_smfmac_f32_16x16x64_bf16 v[32:35], v[28:31], v[56:63], v3
  ds_read_b128 v[56:59], v1 offset:12288
  ds_read_b128 v[60:63], v1 offset:13312
  s_waitcnt lgkmcnt(5)
  v_smfmac_f32_16x16x64_bf16 v[36:39], v[76:79], v[136:143], v3
  v_smfmac_f32_16x16x64_bf16 v[32:35], v[76:79], v[128:135], v3
  v_smfmac_f32_16x16x64_bf16 v[40:43], v[76:79], a[0:7], v3
  v_smfmac_f32_16x16x64_bf16 v[44:47], v[76:79], a[8:15], v3
  s_waitcnt lgkmcnt(4)
  v_smfmac_f32_16x16x64_bf16 v[40:43], v[24:27], v[192:199], v3
  v_smfmac_f32_16x16x64_bf16 v[44:47], v[24:27], v[200:207], v3
  s_waitcnt lgkmcnt(2)
  v_smfmac_f32_16x16x64_bf16 v[36:39], v[24:27], v[64:71], v3
  buffer_load_dwordx4 v[64:67], v0, s[44:47], s65 offen sc1
  buffer_load_dwordx4 v[68:71], v0, s[44:47], s65 offen offset:1024 sc1
  s_waitcnt vmcnt(7)
  v_cvt_pk_bf16_f32 v16, v40, v41
  v_cvt_pk_bf16_f32 v17, v42, v43
  s_waitcnt lgkmcnt(0)
  v_smfmac_f32_16x16x64_bf16 v[32:35], v[24:27], v[56:63], v3
  s_nop 0
  v_cvt_pk_bf16_f32 v14, v36, v37
  v_cvt_pk_bf16_f32 v15, v38, v39
  v_cvt_pk_bf16_f32 v18, v44, v45
  v_cvt_pk_bf16_f32 v19, v46, v47
  s_nop 2
  v_cvt_pk_bf16_f32 v12, v32, v33
  v_cvt_pk_bf16_f32 v13, v34, v35
  v_mfma_f32_16x16x16_bf16 v[36:39], v[14:15], v[4:5], 0
  v_mov_b64 v[56:57], 0
  v_mov_b64 v[58:59], 0
  v_mov_b64 v[60:61], 0
  v_mfma_f32_16x16x16_bf16 v[32:35], v[12:13], v[4:5], 0
  v_mov_b64 v[62:63], 0
  v_smfmac_f32_16x16x64_bf16 v[56:59], v[28:31], a[64:71], v3
  v_cvt_pk_bf16_f32 v14, v36, v37
  v_mfma_f32_16x16x16_bf16 v[40:43], v[16:17], v[4:5], 0
  v_cvt_pk_bf16_f32 v12, v32, v33
  v_cvt_pk_bf16_f32 v13, v34, v35
  v_cvt_pk_bf16_f32 v15, v38, v39
  v_mfma_f32_16x16x16_bf16 v[44:47], v[18:19], v[4:5], 0
  s_waitcnt vmcnt(5)
  v_mfma_f32_16x16x32_bf16 v[36:39], v[48:51], v[12:15], 0
  v_cvt_pk_bf16_f32 v16, v40, v41
  v_cvt_pk_bf16_f32 v17, v42, v43
  s_nop 1
  v_cvt_pk_bf16_f32 v18, v44, v45
  v_cvt_pk_bf16_f32 v19, v46, v47
  s_waitcnt vmcnt(4)
  v_mfma_f32_16x16x32_bf16 v[40:43], v[52:55], v[12:15], 0
  buffer_store_dwordx4 v[16:19], v0, s[44:47], s66 offen sc1
  v_mfma_f32_16x16x32_bf16 v[32:35], v[16:19], v[12:15], 0
  s_nop 3
  v_cndmask_b32 v36, v40, v36, s[84:85]
  v_cndmask_b32 v37, v41, v37, s[84:85]
  v_cndmask_b32 v38, v42, v38, s[84:85]
  v_cndmask_b32 v39, v43, v39, s[84:85]
  ds_write_b128 v2, v[36:39] offset:12288
  s_mov_b64 exec, s[84:85]
  ds_write2_b32 v10, v32, v34 offset0:64 offset1:65
  s_mov_b64 exec, -1
  v_smfmac_f32_16x16x64_bf16 v[60:63], v[28:31], a[72:79], v3
  ds_read_b128 v[28:31], v2 offset:1024
  ds_read_b128 v[20:23], v2 offset:5120
  v_smfmac_f32_16x16x64_bf16 v[56:59], v[76:79], a[144:151], v3
  v_smfmac_f32_16x16x64_bf16 v[60:63], v[76:79], a[152:159], v3
  ds_read_b128 v[76:79], v1 offset:25600
  v_smfmac_f32_16x16x64_bf16 v[56:59], v[24:27], a[80:87], v3
  v_smfmac_f32_16x16x64_bf16 v[60:63], v[24:27], a[88:95], v3
  ds_read_b128 v[24:27], v2 offset:8192
  v_mov_b64 v[16:17], 0
  v_mov_b64 v[18:19], 0
  s_waitcnt lgkmcnt(4)
  s_barrier
  ds_read_b128 v[40:43], v2 offset:11264
  ds_read_b128 v[44:47], v2 offset:13312
  ds_read_b128 v[48:51], v2 offset:14336
  ds_read_b64 v[52:53], v10 offset:0
  ds_read_b64 v[72:73], v10 offset:512
  ds_read_b64 v[12:13], v10 offset:768
  s_waitcnt lgkmcnt(9)
  v_smfmac_f32_16x16x64_bf16 v[56:59], v[28:31], a[48:55], v3
  v_smfmac_f32_16x16x64_bf16 v[60:63], v[28:31], a[56:63], v3
  ds_read_b128 v[28:31], v2 offset:4096
  s_waitcnt lgkmcnt(9)
  v_smfmac_f32_16x16x64_bf16 v[56:59], v[20:23], a[112:119], v3
  v_smfmac_f32_16x16x64_bf16 v[60:63], v[20:23], a[120:127], v3
  ds_read_b128 v[20:23], v2 offset:0
  s_waitcnt lgkmcnt(8)
  v_smfmac_f32_16x16x64_bf16 v[56:59], v[24:27], a[160:167], v3
  v_smfmac_f32_16x16x64_bf16 v[60:63], v[24:27], a[168:175], v3
  ds_read_b128 v[24:27], v2 offset:6144
  s_waitcnt lgkmcnt(8)
  v_add_f32 v36, v36, v40
  v_add_f32 v37, v37, v41
  v_add_f32 v38, v38, v42
  v_add_f32 v39, v39, v43
  s_waitcnt lgkmcnt(6)
  v_pk_add_f32 v[44:45], v[44:45], v[48:49]
  v_pk_add_f32 v[46:47], v[46:47], v[50:51]
  v_pk_add_f32 v[36:37], v[36:37], v[44:45]
  v_pk_add_f32 v[38:39], v[38:39], v[46:47]
  s_waitcnt lgkmcnt(4)
  v_pk_add_f32 v[52:53], v[52:53], v[72:73]
  s_waitcnt lgkmcnt(3)
  v_add_f32 v32, v32, v12
  v_add_f32 v34, v34, v13
  v_add_f32 v32, v32, v52
  v_add_f32 v34, v34, v53
  v_max3_f32 v72, v36, v37, v38
  v_max3_f32 v73, v39, v32, v34
  v_max_f32 v72, v72, v73
  s_waitcnt lgkmcnt(2)
  v_smfmac_f32_16x16x64_bf16 v[56:59], v[28:31], a[96:103], v3
  v_max_f32_dpp v72, v72, v72 quad_perm:[1,0,3,2] row_mask:0xf bank_mask:0xf
  v_mov_b32 v73, v72
  v_smfmac_f32_16x16x64_bf16 v[60:63], v[28:31], a[104:111], v3
  s_nop 0
  v_permlane16_swap_b32 v72, v73
  v_max_f32 v72, v72, v73
  v_mov_b32 v73, v72
  s_waitcnt lgkmcnt(1)
  v_smfmac_f32_16x16x64_bf16 v[56:59], v[20:23], a[32:39], v3
  v_permlane32_swap_b32 v72, v73
  v_max_f32 v72, v72, v73
  v_mul_f32 v72, s80, v72
  v_fma_f32 v36, v36, s88, -v72
  v_fma_f32 v37, v37, s88, -v72
  v_pk_fma_f32 v[38:39], v[38:39], s[88:89], v[72:73] op_sel_hi:[1,1,0] neg_lo:[0,0,1] neg_hi:[0,0,1]
  v_fma_f32 v32, v32, s80, -v72
  v_fma_f32 v34, v34, s80, -v72
  v_exp_f32 v36, v36
  v_exp_f32 v37, v37
  v_exp_f32 v38, v38
  v_exp_f32 v39, v39
  v_smfmac_f32_16x16x64_bf16 v[60:63], v[20:23], a[40:47], v3
  v_exp_f32 v32, v32
  v_exp_f32 v34, v34
  v_add_f32 v73, v36, v37
  v_add_f32 v74, v38, v39
  v_add_f32 v75, v32, v34
  v_add_f32 v73, v73, v74
  s_waitcnt lgkmcnt(0)
  v_smfmac_f32_16x16x64_bf16 v[56:59], v[24:27], a[128:135], v3
  v_smfmac_f32_16x16x64_bf16 v[60:63], v[24:27], a[136:143], v3
  v_fmac_f32 v73, 0.5, v75
  v_cvt_pk_bf16_f32 v40, v36, v37
  v_cvt_pk_bf16_f32 v41, v38, v39
  v_add_f32_dpp v73, v73, v73 quad_perm:[1,0,3,2] row_mask:0xf bank_mask:0xf
  v_mov_b32_dpp v42, v40 quad_perm:[1,0,3,2] row_mask:0xf bank_mask:0xf
  v_mov_b32_dpp v43, v41 quad_perm:[1,0,3,2] row_mask:0xf bank_mask:0xf
  v_mov_b32 v74, v73
  s_waitcnt vmcnt(2)
  v_mfma_f32_16x16x32_bf16 v[52:55], v[64:67], v[40:43], 0
  ds_read_b128 v[64:67], v1 offset:22528
  v_permlane16_swap_b32 v73, v74
  s_waitcnt vmcnt(1)
  v_mfma_f32_16x16x32_bf16 v[12:15], v[68:71], v[40:43], 0
  ds_read_b128 v[68:71], v1 offset:23552
  v_cvt_pk_bf16_f32 v44, v32, v32
  v_cvt_pk_bf16_f32 v45, v34, v34
  v_cvt_pk_bf16_f32 v48, v56, v57
  v_cvt_pk_bf16_f32 v49, v58, v59
  v_cvt_pk_bf16_f32 v50, v60, v61
  v_cvt_pk_bf16_f32 v51, v62, v63
  v_add_f32 v73, v73, v74
  v_mov_b32 v74, v73
  v_mfma_f32_16x16x16_bf16 v[52:55], v[48:49], v[44:45], v[52:55]
  buffer_store_dwordx4 v[48:51], v0, s[44:47], s66 offen offset:1024 sc1
  s_cmp_eq_u32 s36, 63
  s_cbranch_scc1 .Lconcat_heads__mha_block__memory_aug_recurrent_mem_tr__prompt_kernelrec_w1_exit
  v_mfma_f32_16x16x16_bf16 v[12:15], v[50:51], v[44:45], v[12:15]
  v_permlane32_swap_b32 v73, v74
  v_add_f32 v73, v73, v74
  v_rcp_f32 v72, v73
  ds_read_b128 v[56:59], v1 offset:20480
  v_mul_f32 v52, v52, v72
  v_mul_f32 v53, v53, v72
  v_pk_mul_f32 v[54:55], v[54:55], v[72:73] op_sel_hi:[1,0]
  s_nop 0
  v_pk_mul_f32 v[12:13], v[12:13], v[72:73] op_sel_hi:[1,0]
  v_pk_mul_f32 v[14:15], v[14:15], v[72:73] op_sel_hi:[1,0]
  v_cvt_pk_bf16_f32 v44, v52, v53
  v_cvt_pk_bf16_f32 v45, v54, v55
  v_cvt_pk_bf16_f32 v46, v12, v13
  v_cvt_pk_bf16_f32 v47, v14, v15
  s_mov_b64 exec, s[84:85]
  ds_write_b64 v9, v[44:45] offset:512
  ds_write_b64 v9, v[46:47] offset:768
  s_mov_b64 exec, -1
  ds_read_b128 v[60:63], v1 offset:21504
  v_mov_b64 v[12:13], 0
  v_mov_b64 v[14:15], 0
  ds_read_b128 v[72:75], v1 offset:24576
  v_mov_b64 v[28:29], 0
  v_mov_b64 v[30:31], 0
  v_mov_b64 v[32:33], 0
  v_mov_b64 v[34:35], 0
  v_mov_b64 v[44:45], 0
  v_mov_b64 v[46:47], 0
  s_waitcnt lgkmcnt(2)
  s_barrier
  ds_read_b128 v[48:51], v2 offset:9216
  ds_read_b128 v[52:55], v2 offset:10240
  v_mov_b64 v[20:21], 0
  v_mov_b64 v[22:23], 0
  v_mov_b64 v[24:25], 0
  v_mov_b64 v[26:27], 0
  v_mov_b64 v[36:37], 0
  v_mov_b64 v[38:39], 0
  v_mov_b64 v[40:41], 0
  v_mov_b64 v[42:43], 0
  s_waitcnt lgkmcnt(1)
  v_smfmac_f32_16x16x64_bf16 v[12:15], v[48:51], a[176:183], v3
  v_smfmac_f32_16x16x64_bf16 v[16:19], v[48:51], a[184:191], v3
  s_waitcnt lgkmcnt(0)
  v_smfmac_f32_16x16x64_bf16 v[12:15], v[52:55], v[56:63], v3
  ds_read_b128 v[56:59], v1 offset:26624
  ds_read_b128 v[60:63], v1 offset:27648
  v_smfmac_f32_16x16x64_bf16 v[16:19], v[52:55], v[64:71], v3
  ds_read_b128 v[64:67], v1 offset:28672
  ds_read_b128 v[68:71], v1 offset:29696
  v_smfmac_f32_16x16x64_bf16 v[28:31], v[48:51], v[72:79], v3
  ds_read_b128 v[72:75], v1 offset:30720
  ds_read_b128 v[76:79], v1 offset:31744
  v_smfmac_f32_16x16x64_bf16 v[44:47], v[48:51], a[240:247], v3
  v_smfmac_f32_16x16x64_bf16 v[44:47], v[52:55], a[248:255], v3
  v_smfmac_f32_16x16x64_bf16 v[20:23], v[48:51], a[192:199], v3
  v_smfmac_f32_16x16x64_bf16 v[24:27], v[48:51], a[200:207], v3
  v_smfmac_f32_16x16x64_bf16 v[20:23], v[52:55], a[224:231], v3
  v_add_f32 v44, v44, v45
  v_add_f32 v46, v46, v47
  v_smfmac_f32_16x16x64_bf16 v[24:27], v[52:55], a[232:239], v3
  s_waitcnt lgkmcnt(4)
  v_smfmac_f32_16x16x64_bf16 v[32:35], v[48:51], v[56:63], v3
  ds_read_b128 v[56:59], v1 offset:32768
  ds_read_b128 v[60:63], v1 offset:33792
  v_cvt_pk_bf16_f32 v44, v44, v46
  s_waitcnt lgkmcnt(4)
  v_smfmac_f32_16x16x64_bf16 v[28:31], v[52:55], v[64:71], v3
  ds_read_b128 v[64:67], v1 offset:34816
  ds_read_b128 v[68:71], v1 offset:35840
  v_add_f32 v12, v12, v13
  v_add_f32 v14, v14, v15
  v_smfmac_f32_16x16x64_bf16 v[36:39], v[48:51], a[208:215], v3
  buffer_store_dword v44, v7, s[40:43], s81 offen offset:256
  v_cvt_pk_bf16_f32 v12, v12, v14
  v_add_f32 v16, v16, v17
  v_add_f32 v18, v18, v19
  s_waitcnt lgkmcnt(4)
  v_smfmac_f32_16x16x64_bf16 v[32:35], v[52:55], v[72:79], v3
  buffer_store_dword v12, v7, s[40:43], s50 offen offset:512
  v_smfmac_f32_16x16x64_bf16 v[40:43], v[48:51], a[216:223], v3
  v_cvt_pk_bf16_f32 v16, v16, v18
  v_add_f32 v20, v20, v21
  v_add_f32 v22, v22, v23
  buffer_store_dword v16, v7, s[40:43], s50 offen offset:768
  v_cvt_pk_bf16_f32 v20, v20, v22
  v_add_f32 v24, v24, v25
  v_add_f32 v26, v26, v27
  s_waitcnt lgkmcnt(2)
  v_smfmac_f32_16x16x64_bf16 v[36:39], v[52:55], v[56:63], v3
  buffer_store_dword v20, v7, s[40:43], s50 offen offset:2560
  v_cvt_pk_bf16_f32 v24, v24, v26
  v_add_f32 v28, v28, v29
  v_add_f32 v30, v30, v31
  buffer_store_dword v24, v7, s[40:43], s50 offen offset:2816
  s_waitcnt lgkmcnt(0)
  v_smfmac_f32_16x16x64_bf16 v[40:43], v[52:55], v[64:71], v3
  v_cvt_pk_bf16_f32 v28, v28, v30
  v_add_f32 v32, v32, v33
  v_add_f32 v34, v34, v35
  buffer_store_dword v28, v7, s[40:43], s51 offen offset:512
  v_cvt_pk_bf16_f32 v32, v32, v34
  v_add_f32 v36, v36, v37
  v_add_f32 v38, v38, v39
  buffer_store_dword v32, v7, s[40:43], s51 offen offset:768
  v_cvt_pk_bf16_f32 v36, v36, v38
  v_add_f32 v40, v40, v41
  v_add_f32 v42, v42, v43
  buffer_store_dword v36, v7, s[40:43], s51 offen offset:2560
  v_cvt_pk_bf16_f32 v40, v40, v42
  buffer_store_dword v40, v7, s[40:43], s51 offen offset:2816
  s_cmp_eq_u32 s36, 63
  s_cbranch_scc1 .Lconcat_heads__mha_block__memory_aug_recurrent_mem_tr__prompt_kernelrec_w1_exit
  s_nop 7
  s_nop 7
  s_nop 7
  s_nop 7
  s_nop 7
  s_nop 7
  s_nop 1
  buffer_load_dwordx4 v[12:15], v8, s[40:43], s52 offen sc1
  buffer_load_dwordx4 v[16:19], v8, s[40:43], s53 offen sc1
  buffer_load_dwordx4 v[20:23], v8, s[40:43], s54 offen sc1
  buffer_load_dwordx4 v[24:27], v8, s[40:43], s55 offen sc1
  v_lshrrev_b32 v36, 4, v0
  v_and_b32 v37, 1, v36
  v_lshlrev_b32 v37, 4, v37
  v_mov_b32 v38, 0x3f80
  v_lshlrev_b32 v37, v37, v38
  v_bfe_u32 v36, v36, 1, 2
  v_cmp_eq_u32 vcc, 0, v36
  s_nop 1
  v_cndmask_b32 v28, 0, v37, vcc
  v_cmp_eq_u32 vcc, 1, v36
  s_nop 1
  v_cndmask_b32 v29, 0, v37, vcc
  v_cmp_eq_u32 vcc, 2, v36
  s_nop 1
  v_cndmask_b32 v30, 0, v37, vcc
  v_cmp_eq_u32 vcc, 3, v36
  s_nop 1
  v_cndmask_b32 v31, 0, v37, vcc
  s_add_u32 s64, s64, 524288
  s_add_u32 s65, s65, 524288
  s_add_u32 s66, s66, 262144
  s_mov_b32 s68, 400000
  s_lshl_b32 s74, s35, 31
  s_and_b32 s74, s74, 0x1800
  s_add_u32 s58, s64, 524288
  s_add_u32 s58, s58, s74
  s_cmp_ge_u32 s36, 62
  s_cselect_b32 s58, 1073741824, s58
  s_lshl_b32 s74, s36, 7
  s_lshl_b32 s75, s34, 2
  s_add_u32 s74, s74, s75
  s_add_u32 s90, s74, 70008832
  s_min_u32 s75, s36, 60
  s_lshl_b32 s75, s75, 7
  s_lshl_b32 s74, s34, 2
  s_add_u32 s74, s74, s75
  s_add_u32 s91, s74, 69992832
  ds_read_b128 v[56:59], v1 offset:4096
  ds_read_b128 v[60:63], v1 offset:5120
  ds_read_b128 v[64:67], v1 offset:6144
  ds_read_b128 v[68:71], v1 offset:7168
  v_mov_b64 v[36:37], 0
  v_mov_b64 v[38:39], 0
  v_mov_b64 v[40:41], 0
  v_mov_b64 v[42:43], 0
  v_mov_b64 v[44:45], 0
  v_and_b32 v46, 0xf0, v0
  s_mov_b64 s[76:77], -1
.Lconcat_heads__mha_block__memory_aug_recurrent_mem_tr__prompt_kernelrec_w1_pl:
  s_mov_b64 exec, s[76:77]
  buffer_load_dwordx4 v[12:15], v8, s[40:43], s52 offen sc1
  buffer_load_dwordx4 v[16:19], v8, s[40:43], s53 offen sc1
  buffer_load_dwordx4 v[20:23], v8, s[40:43], s54 offen sc1
  buffer_load_dwordx4 v[24:27], v8, s[40:43], s55 offen sc1
  s_mov_b64 exec, -1
  s_add_u32 s69, s69, 1
  s_sub_u32 s68, s68, 1
  s_cmp_eq_u32 s68, 0
  s_cbranch_scc1 .Lconcat_heads__mha_block__memory_aug_recurrent_mem_tr__prompt_kernelrec_w1_exit
  s_waitcnt vmcnt(7)
  v_mfma_f32_16x16x32_bf16 v[32:35], v[28:31], v[12:15], 0
  s_waitcnt vmcnt(6)
  v_mfma_f32_16x16x32_bf16 v[32:35], v[28:31], v[16:19], v[32:35]
  s_waitcnt vmcnt(5)
  v_mfma_f32_16x16x32_bf16 v[32:35], v[28:31], v[20:23], v[32:35]
  s_waitcnt vmcnt(4)
  v_mfma_f32_16x16x32_bf16 v[32:35], v[28:31], v[24:27], v[32:35]
  v_max3_u32 v48, v12, v13, v14
  v_max3_u32 v49, v15, v16, v17
  v_max3_u32 v48, v48, v18, v19
  v_max3_u32 v49, v49, v20, v21
  v_max3_u32 v48, v48, v22, v23
  v_max3_u32 v49, v49, v24, v25
  v_max3_u32 v48, v48, v26, v27
  v_max_u32 v48, v48, v49
  v_cmp_eq_u32 s[76:77], -1, v48
  v_add_f32_dpp v32, v32, v32 row_ror:8 row_mask:0xf bank_mask:0xf
  v_add_f32_dpp v33, v33, v33 row_ror:8 row_mask:0xf bank_mask:0xf
  v_add_f32_dpp v34, v34, v34 row_ror:8 row_mask:0xf bank_mask:0xf
  v_add_f32_dpp v35, v35, v35 row_ror:8 row_mask:0xf bank_mask:0xf
  v_cmp_u_f32 vcc, v32, v32
  s_cbranch_vccnz .Lconcat_heads__mha_block__memory_aug_recurrent_mem_tr__prompt_kernelrec_w1_pl
.Lconcat_heads__mha_block__memory_aug_recurrent_mem_tr__prompt_kernelrec_w1_pub:
  v_cvt_pk_bf16_f32 v28, v32, v34
  v_cvt_pk_bf16_f32 v29, v33, v35
  v_cndmask_b32 v28, v29, v28, s[100:101]
  s_mov_b64 exec, s[70:71]
  buffer_store_dword v28, v11, s[40:43], s49 offen
  s_mov_b64 exec, -1
  v_mov_b64 v[32:33], 0
  v_mov_b64 v[34:35], 0
  s_branch .Lconcat_heads__mha_block__memory_aug_recurrent_mem_tr__prompt_kernelrec_w1_gpre
.Lconcat_heads__mha_block__memory_aug_recurrent_mem_tr__prompt_kernelrec_w1_nojob:
.Lconcat_heads__mha_block__memory_aug_recurrent_mem_tr__prompt_kernelrec_w1_gpre:
  buffer_load_dwordx4 v[12:15], v0, s[40:43], s61 offen sc1
  buffer_load_dwordx4 v[16:19], v0, s[40:43], s62 offen sc1
  buffer_load_dwordx4 v[20:23], v46, s[40:43], s63 offen sc1
  s_add_u32 s36, s36, 1
  s_nop 7
  s_nop 7
  s_nop 7
  s_nop 0
  s_mov_b64 vcc, -1
  s_branch .Lconcat_heads__mha_block__memory_aug_recurrent_mem_tr__prompt_kernelrec_w1_gl
.Lconcat_heads__mha_block__memory_aug_recurrent_mem_tr__prompt_kernelrec_w1_exit:
  s_branch .Lconcat_heads__mha_block__memory_aug_recurrent_mem_tr__prompt_kernelrec_done
.Lconcat_heads__mha_block__memory_aug_recurrent_mem_tr__prompt_kernelrec_w2:
  s_add_u32 s58, s64, 524288
  s_mov_b32 m0, 160768
  ds_read_b128 v[56:59], v1 offset:8192
  ds_read_b128 v[60:63], v1 offset:9216
  ds_read_b128 v[64:67], v1 offset:10240
  ds_read_b128 v[68:71], v1 offset:11264
  v_mov_b64 v[32:33], 0
  v_mov_b64 v[34:35], 0
  v_mov_b64 v[36:37], 0
  v_mov_b64 v[38:39], 0
  v_mov_b64 v[40:41], 0
  v_mov_b64 v[42:43], 0
  v_mov_b64 v[44:45], 0
  s_mov_b32 s68, 400000
  s_waitcnt lgkmcnt(0)
  s_branch .Lconcat_heads__mha_block__memory_aug_recurrent_mem_tr__prompt_kernelrec_w2_g0
.Lconcat_heads__mha_block__memory_aug_recurrent_mem_tr__prompt_kernelrec_w2_gl:
  s_mov_b64 exec, vcc
  buffer_load_dwordx4 v[12:15], v0, s[40:43], s61 offen sc1
  buffer_load_dwordx4 v[16:19], v0, s[40:43], s62 offen sc1
  buffer_load_dwordx4 v[20:23], v46, s[40:43], s63 offen sc1
  s_mov_b64 exec, -1
  s_add_u32 s73, s73, 1
  s_sub_u32 s68, s68, 1
  s_cmp_eq_u32 s68, 0
  s_cbranch_scc1 .Lconcat_heads__mha_block__memory_aug_recurrent_mem_tr__prompt_kernelrec_w2_exit
  s_waitcnt vmcnt(3)
.Lconcat_heads__mha_block__memory_aug_recurrent_mem_tr__prompt_kernelrec_w2_g0:
  v_max3_u32 v24, v12, v13, v14
  v_max3_u32 v26, v15, v16, v17
  v_max3_u32 v24, v24, v18, v19
  v_max3_u32 v26, v26, v20, v21
  v_max3_u32 v24, v24, v22, v23
  v_max_u32 v24, v24, v26
  v_cmp_eq_u32 vcc, -1, v24
  s_cbranch_vccnz .Lconcat_heads__mha_block__memory_aug_recurrent_mem_tr__prompt_kernelrec_w2_gl
  ds_write_b128 v2, v[12:15] offset:2048
  ds_write_b128 v2, v[16:19] offset:6144
  s_mov_b64 exec, 0xffff
  ds_write_b128 v2, v[20:23] offset:8704
  s_mov_b64 exec, -1
.Lconcat_heads__mha_block__memory_aug_recurrent_mem_tr__prompt_kernelrec_w2_have:
  v_mov_b64 v[46:47], 0
  buffer_load_dwordx4 v[48:51], v0, s[44:47], s64 offen sc1
  s_waitcnt lgkmcnt(3)
  v_smfmac_f32_16x16x64_bf16 v[36:39], v[12:15], v[64:71], v3
  ds_read_b128 v[64:67], v1 offset:18432
  ds_read_b128 v[68:71], v1 offset:19456
  buffer_load_dwordx4 v[52:55], v0, s[44:47], s64 offen offset:1024 sc1
  v_smfmac_f32_16x16x64_bf16 v[32:35], v[12:15], v[56:63], v3
  ds_read_b128 v[56:59], v1 offset:16384
  ds_read_b128 v[60:63], v1 offset:17408
  s_add_u32 s76, s36, 3
  v_smfmac_f32_16x16x64_bf16 v[36:39], v[16:19], v[120:127], v3
  s_and_b32 s76, s76, 3
  s_mul_i32 s77, s76, 294912
  v_mov_b64 v[72:73], -1
  v_smfmac_f32_16x16x64_bf16 v[32:35], v[16:19], v[112:119], v3
  s_add_u32 s59, s77, s67
  s_add_u32 s78, s59, 4096
  s_waitcnt lgkmcnt(4)
  s_barrier
  ds_read_b128 v[24:27], v2 offset:8192
  ds_read_b128 v[28:31], v2 offset:4096
  ds_read_b128 v[76:79], v2 offset:0
  v_smfmac_f32_16x16x64_bf16 v[40:43], v[12:15], v[176:183], v3
  s_add_u32 s79, s59, 8192
  s_and_b32 s74, s36, 3
  v_mov_b64 v[74:75], -1
  v_smfmac_f32_16x16x64_bf16 v[44:47], v[12:15], v[184:191], v3
  buffer_store_dwordx4 v[72:75], v0, s[40:43], s59 offen offset:2048
  v_smfmac_f32_16x16x64_bf16 v[40:43], v[16:19], v[240:247], v3
  buffer_store_dwordx4 v[72:75], v0, s[40:43], s78 offen offset:2048
  v_smfmac_f32_16x16x64_bf16 v[44:47], v[16:19], v[248:255], v3
  buffer_store_dwordx4 v[72:75], v0, s[40:43], s79 offen
  s_mul_i32 s48, s74, 294912
  s_add_u32 s50, s48, s67
  s_add_u32 s81, s50, 8192
  s_add_u32 s51, s50, 4096
  s_waitcnt lgkmcnt(2)
  v_smfmac_f32_16x16x64_bf16 v[36:39], v[24:27], v[64:71], v3
  ds_read_b128 v[64:67], v1 offset:2048
  ds_read_b128 v[68:71], v1 offset:3072
  v_smfmac_f32_16x16x64_bf16 v[32:35], v[24:27], v[56:63], v3
  ds_read_b128 v[56:59], v1 offset:0
  ds_read_b128 v[60:63], v1 offset:1024
  v_smfmac_f32_16x16x64_bf16 v[40:43], v[24:27], a[16:23], v3
  s_add_u32 s75, s36, 1
  s_and_b32 s75, s75, 3
  v_smfmac_f32_16x16x64_bf16 v[44:47], v[24:27], a[24:31], v3
  ds_read_b128 v[24:27], v2 offset:5120
  s_mul_i32 s75, s75, 9216
  s_waitcnt lgkmcnt(6)
  v_smfmac_f32_16x16x64_bf16 v[36:39], v[28:31], v[88:95], v3
  s_add_u32 s49, s75, 1179648
  s_add_u32 s61, s49, s56
  v_smfmac_f32_16x16x64_bf16 v[32:35], v[28:31], v[80:87], v3
  s_add_u32 s62, s61, 4096
  s_add_u32 s63, s49, s57
  v_smfmac_f32_16x16x64_bf16 v[40:43], v[28:31], v[208:215], v3
  s_add_u32 s52, s48, 0
  s_add_u32 s53, s48, 73728
  v_smfmac_f32_16x16x64_bf16 v[44:47], v[28:31], v[216:223], v3
  ds_read_b128 v[28:31], v2 offset:1024
  s_add_u32 s54, s48, 147456
  s_waitcnt lgkmcnt(6)
  v_smfmac_f32_16x16x64_bf16 v[40:43], v[76:79], v[144:151], v3
  s_add_u32 s55, s48, 221184
  s_waitcnt lgkmcnt(4)
  v_smfmac_f32_16x16x64_bf16 v[36:39], v[76:79], v[64:71], v3
  ds_read_b128 v[64:67], v1 offset:6144
  ds_read_b128 v[68:71], v1 offset:7168
  v_smfmac_f32_16x16x64_bf16 v[44:47], v[76:79], v[152:159], v3
  s_waitcnt lgkmcnt(4)
  v_smfmac_f32_16x16x64_bf16 v[32:35], v[76:79], v[56:63], v3
  ds_read_b128 v[56:59], v1 offset:4096
  ds_read_b128 v[60:63], v1 offset:5120
  s_waitcnt lgkmcnt(5)
  v_smfmac_f32_16x16x64_bf16 v[36:39], v[24:27], v[104:111], v3
  ds_read_b128 v[76:79], v2 offset:7168
  v_smfmac_f32_16x16x64_bf16 v[32:35], v[24:27], v[96:103], v3
  v_smfmac_f32_16x16x64_bf16 v[40:43], v[24:27], v[224:231], v3
  v_smfmac_f32_16x16x64_bf16 v[44:47], v[24:27], v[232:239], v3
  ds_read_b128 v[24:27], v2 offset:3072
  s_waitcnt lgkmcnt(6)
  v_smfmac_f32_16x16x64_bf16 v[40:43], v[28:31], v[160:167], v3
  v_smfmac_f32_16x16x64_bf16 v[44:47], v[28:31], v[168:175], v3
  s_waitcnt lgkmcnt(4)
  v_smfmac_f32_16x16x64_bf16 v[36:39], v[28:31], v[64:71], v3
  ds_read_b128 v[64:67], v1 offset:14336
  ds_read_b128 v[68:71], v1 offset:15360
  s_waitcnt lgkmcnt(4)
  v_smfmac_f32_16x16x64_bf16 v[32:35], v[28:31], v[56:63], v3
  ds_read_b128 v[56:59], v1 offset:12288
  ds_read_b128 v[60:63], v1 offset:13312
  s_waitcnt lgkmcnt(5)
  v_smfmac_f32_16x16x64_bf16 v[36:39], v[76:79], v[136:143], v3
  v_smfmac_f32_16x16x64_bf16 v[32:35], v[76:79], v[128:135], v3
  v_smfmac_f32_16x16x64_bf16 v[40:43], v[76:79], a[0:7], v3
  v_smfmac_f32_16x16x64_bf16 v[44:47], v[76:79], a[8:15], v3
  s_waitcnt lgkmcnt(4)
  v_smfmac_f32_16x16x64_bf16 v[40:43], v[24:27], v[192:199], v3
  v_smfmac_f32_16x16x64_bf16 v[44:47], v[24:27], v[200:207], v3
  s_waitcnt lgkmcnt(2)
  v_smfmac_f32_16x16x64_bf16 v[36:39], v[24:27], v[64:71], v3
  buffer_load_dwordx4 v[64:67], v0, s[44:47], s65 offen sc1
  buffer_load_dwordx4 v[68:71], v0, s[44:47], s65 offen offset:1024 sc1
  s_waitcnt vmcnt(8)
  v_cvt_pk_bf16_f32 v16, v40, v41
  v_cvt_pk_bf16_f32 v17, v42, v43
  s_waitcnt lgkmcnt(0)
  v_smfmac_f32_16x16x64_bf16 v[32:35], v[24:27], v[56:63], v3
  s_nop 0
  v_cvt_pk_bf16_f32 v14, v36, v37
  v_cvt_pk_bf16_f32 v15, v38, v39
  v_cvt_pk_bf16_f32 v18, v44, v45
  v_cvt_pk_bf16_f32 v19, v46, v47
  s_nop 2
  v_cvt_pk_bf16_f32 v12, v32, v33
  v_cvt_pk_bf16_f32 v13, v34, v35
  v_mfma_f32_16x16x16_bf16 v[36:39], v[14:15], v[4:5], 0
  v_mov_b64 v[56:57], 0
  v_mov_b64 v[58:59], 0
  v_mov_b64 v[60:61], 0
  v_mfma_f32_16x16x16_bf16 v[32:35], v[12:13], v[4:5], 0
  v_mov_b64 v[62:63], 0
  v_smfmac_f32_16x16x64_bf16 v[56:59], v[28:31], a[48:55], v3
  v_cvt_pk_bf16_f32 v14, v36, v37
  v_mfma_f32_16x16x16_bf16 v[40:43], v[16:17], v[4:5], 0
  v_cvt_pk_bf16_f32 v12, v32, v33
  v_cvt_pk_bf16_f32 v13, v34, v35
  v_cvt_pk_bf16_f32 v15, v38, v39
  v_mfma_f32_16x16x16_bf16 v[44:47], v[18:19], v[4:5], 0
  s_waitcnt vmcnt(6)
  v_mfma_f32_16x16x32_bf16 v[36:39], v[48:51], v[12:15], 0
  v_cvt_pk_bf16_f32 v16, v40, v41
  v_cvt_pk_bf16_f32 v17, v42, v43
  s_nop 1
  v_cvt_pk_bf16_f32 v18, v44, v45
  v_cvt_pk_bf16_f32 v19, v46, v47
  s_waitcnt vmcnt(5)
  v_mfma_f32_16x16x32_bf16 v[40:43], v[52:55], v[12:15], 0
  buffer_store_dwordx4 v[16:19], v0, s[44:47], s66 offen sc1
  v_mfma_f32_16x16x32_bf16 v[32:35], v[16:19], v[12:15], 0
  s_nop 3
  v_cndmask_b32 v36, v40, v36, s[84:85]
  v_cndmask_b32 v37, v41, v37, s[84:85]
  v_cndmask_b32 v38, v42, v38, s[84:85]
  v_cndmask_b32 v39, v43, v39, s[84:85]
  ds_write_b128 v2, v[36:39] offset:13312
  s_mov_b64 exec, s[84:85]
  ds_write2_b32 v10, v32, v34 offset0:128 offset1:129
  s_mov_b64 exec, -1
  v_smfmac_f32_16x16x64_bf16 v[60:63], v[28:31], a[56:63], v3
  ds_read_b128 v[28:31], v2 offset:2048
  ds_read_b128 v[20:23], v2 offset:6144
  v_smfmac_f32_16x16x64_bf16 v[56:59], v[76:79], a[144:151], v3
  v_smfmac_f32_16x16x64_bf16 v[60:63], v[76:79], a[152:159], v3
  ds_read_b128 v[76:79], v1 offset:25600
  v_smfmac_f32_16x16x64_bf16 v[56:59], v[24:27], a[80:87], v3
  v_smfmac_f32_16x16x64_bf16 v[60:63], v[24:27], a[88:95], v3
  ds_read_b128 v[24:27], v2 offset:8192
  v_mov_b64 v[16:17], 0
  v_mov_b64 v[18:19], 0
  s_waitcnt lgkmcnt(4)
  s_barrier
  ds_read_b128 v[40:43], v2 offset:11264
  ds_read_b128 v[44:47], v2 offset:12288
  ds_read_b128 v[48:51], v2 offset:14336
  ds_read_b64 v[52:53], v10 offset:0
  ds_read_b64 v[72:73], v10 offset:256
  ds_read_b64 v[12:13], v10 offset:768
  s_waitcnt lgkmcnt(9)
  v_smfmac_f32_16x16x64_bf16 v[56:59], v[28:31], a[64:71], v3
  v_smfmac_f32_16x16x64_bf16 v[60:63], v[28:31], a[72:79], v3
  ds_read_b128 v[28:31], v2 offset:4096
  s_waitcnt lgkmcnt(9)
  v_smfmac_f32_16x16x64_bf16 v[56:59], v[20:23], a[128:135], v3
  v_smfmac_f32_16x16x64_bf16 v[60:63], v[20:23], a[136:143], v3
  ds_read_b128 v[20:23], v2 offset:0
  s_waitcnt lgkmcnt(8)
  v_smfmac_f32_16x16x64_bf16 v[56:59], v[24:27], a[160:167], v3
  v_smfmac_f32_16x16x64_bf16 v[60:63], v[24:27], a[168:175], v3
  ds_read_b128 v[24:27], v2 offset:5120
  s_waitcnt lgkmcnt(8)
  v_add_f32 v36, v36, v40
  v_add_f32 v37, v37, v41
  v_add_f32 v38, v38, v42
  v_add_f32 v39, v39, v43
  s_waitcnt lgkmcnt(6)
  v_pk_add_f32 v[44:45], v[44:45], v[48:49]
  v_pk_add_f32 v[46:47], v[46:47], v[50:51]
  v_pk_add_f32 v[36:37], v[36:37], v[44:45]
  v_pk_add_f32 v[38:39], v[38:39], v[46:47]
  s_waitcnt lgkmcnt(4)
  v_pk_add_f32 v[52:53], v[52:53], v[72:73]
  s_waitcnt lgkmcnt(3)
  v_add_f32 v32, v32, v12
  v_add_f32 v34, v34, v13
  v_add_f32 v32, v32, v52
  v_add_f32 v34, v34, v53
  v_max3_f32 v72, v36, v37, v38
  v_max3_f32 v73, v39, v32, v34
  v_max_f32 v72, v72, v73
  s_waitcnt lgkmcnt(2)
  v_smfmac_f32_16x16x64_bf16 v[56:59], v[28:31], a[96:103], v3
  v_max_f32_dpp v72, v72, v72 quad_perm:[1,0,3,2] row_mask:0xf bank_mask:0xf
  v_mov_b32 v73, v72
  v_smfmac_f32_16x16x64_bf16 v[60:63], v[28:31], a[104:111], v3
  s_nop 0
  v_permlane16_swap_b32 v72, v73
  v_max_f32 v72, v72, v73
  v_mov_b32 v73, v72
  s_waitcnt lgkmcnt(1)
  v_smfmac_f32_16x16x64_bf16 v[56:59], v[20:23], a[32:39], v3
  v_permlane32_swap_b32 v72, v73
  v_max_f32 v72, v72, v73
  v_mul_f32 v72, s80, v72
  v_fma_f32 v36, v36, s88, -v72
  v_fma_f32 v37, v37, s88, -v72
  v_pk_fma_f32 v[38:39], v[38:39], s[88:89], v[72:73] op_sel_hi:[1,1,0] neg_lo:[0,0,1] neg_hi:[0,0,1]
  v_fma_f32 v32, v32, s80, -v72
  v_fma_f32 v34, v34, s80, -v72
  v_exp_f32 v36, v36
  v_exp_f32 v37, v37
  v_exp_f32 v38, v38
  v_exp_f32 v39, v39
  v_smfmac_f32_16x16x64_bf16 v[60:63], v[20:23], a[40:47], v3
  v_exp_f32 v32, v32
  v_exp_f32 v34, v34
  v_add_f32 v73, v36, v37
  v_add_f32 v74, v38, v39
  v_add_f32 v75, v32, v34
  v_add_f32 v73, v73, v74
  s_waitcnt lgkmcnt(0)
  v_smfmac_f32_16x16x64_bf16 v[56:59], v[24:27], a[112:119], v3
  v_smfmac_f32_16x16x64_bf16 v[60:63], v[24:27], a[120:127], v3
  v_fmac_f32 v73, 0.5, v75
  v_cvt_pk_bf16_f32 v40, v36, v37
  v_cvt_pk_bf16_f32 v41, v38, v39
  v_add_f32_dpp v73, v73, v73 quad_perm:[1,0,3,2] row_mask:0xf bank_mask:0xf
  v_mov_b32_dpp v42, v40 quad_perm:[1,0,3,2] row_mask:0xf bank_mask:0xf
  v_mov_b32_dpp v43, v41 quad_perm:[1,0,3,2] row_mask:0xf bank_mask:0xf
  v_mov_b32 v74, v73
  s_waitcnt vmcnt(2)
  v_mfma_f32_16x16x32_bf16 v[52:55], v[64:67], v[40:43], 0
  ds_read_b128 v[64:67], v1 offset:22528
  v_permlane16_swap_b32 v73, v74
  s_waitcnt vmcnt(1)
  v_mfma_f32_16x16x32_bf16 v[12:15], v[68:71], v[40:43], 0
  ds_read_b128 v[68:71], v1 offset:23552
  v_cvt_pk_bf16_f32 v44, v32, v32
  v_cvt_pk_bf16_f32 v45, v34, v34
  v_cvt_pk_bf16_f32 v48, v56, v57
  v_cvt_pk_bf16_f32 v49, v58, v59
  v_cvt_pk_bf16_f32 v50, v60, v61
  v_cvt_pk_bf16_f32 v51, v62, v63
  v_add_f32 v73, v73, v74
  v_mov_b32 v74, v73
  v_mfma_f32_16x16x16_bf16 v[52:55], v[48:49], v[44:45], v[52:55]
  buffer_store_dwordx4 v[48:51], v0, s[44:47], s66 offen offset:1024 sc1
  s_cmp_eq_u32 s36, 63
  s_cbranch_scc1 .Lconcat_heads__mha_block__memory_aug_recurrent_mem_tr__prompt_kernelrec_w2_exit
  v_mfma_f32_16x16x16_bf16 v[12:15], v[50:51], v[44:45], v[12:15]
  v_permlane32_swap_b32 v73, v74
  v_add_f32 v73, v73, v74
  v_rcp_f32 v72, v73
  ds_read_b128 v[56:59], v1 offset:20480
  v_mul_f32 v52, v52, v72
  v_mul_f32 v53, v53, v72
  v_pk_mul_f32 v[54:55], v[54:55], v[72:73] op_sel_hi:[1,0]
  s_nop 0
  v_pk_mul_f32 v[12:13], v[12:13], v[72:73] op_sel_hi:[1,0]
  v_pk_mul_f32 v[14:15], v[14:15], v[72:73] op_sel_hi:[1,0]
  v_cvt_pk_bf16_f32 v44, v52, v53
  v_cvt_pk_bf16_f32 v45, v54, v55
  v_cvt_pk_bf16_f32 v46, v12, v13
  v_cvt_pk_bf16_f32 v47, v14, v15
  s_mov_b64 exec, s[84:85]
  ds_write_b64 v9, v[44:45] offset:1024
  ds_write_b64 v9, v[46:47] offset:1280
  s_mov_b64 exec, -1
  ds_read_b128 v[60:63], v1 offset:21504
  v_mov_b64 v[12:13], 0
  v_mov_b64 v[14:15], 0
  ds_read_b128 v[72:75], v1 offset:24576
  v_mov_b64 v[28:29], 0
  v_mov_b64 v[30:31], 0
  v_mov_b64 v[32:33], 0
  v_mov_b64 v[34:35], 0
  v_mov_b64 v[44:45], 0
  v_mov_b64 v[46:47], 0
  s_waitcnt lgkmcnt(2)
  s_barrier
  ds_read_b128 v[48:51], v2 offset:9216
  ds_read_b128 v[52:55], v2 offset:10240
  v_mov_b64 v[20:21], 0
  v_mov_b64 v[22:23], 0
  v_mov_b64 v[24:25], 0
  v_mov_b64 v[26:27], 0
  v_mov_b64 v[36:37], 0
  v_mov_b64 v[38:39], 0
  v_mov_b64 v[40:41], 0
  v_mov_b64 v[42:43], 0
  s_waitcnt lgkmcnt(1)
  v_smfmac_f32_16x16x64_bf16 v[12:15], v[48:51], a[176:183], v3
  v_smfmac_f32_16x16x64_bf16 v[16:19], v[48:51], a[184:191], v3
  s_waitcnt lgkmcnt(0)
  v_smfmac_f32_16x16x64_bf16 v[12:15], v[52:55], v[56:63], v3
  ds_read_b128 v[56:59], v1 offset:26624
  ds_read_b128 v[60:63], v1 offset:27648
  v_smfmac_f32_16x16x64_bf16 v[16:19], v[52:55], v[64:71], v3
  ds_read_b128 v[64:67], v1 offset:28672
  ds_read_b128 v[68:71], v1 offset:29696
  v_smfmac_f32_16x16x64_bf16 v[28:31], v[48:51], v[72:79], v3
  ds_read_b128 v[72:75], v1 offset:30720
  ds_read_b128 v[76:79], v1 offset:31744
  v_smfmac_f32_16x16x64_bf16 v[44:47], v[48:51], a[240:247], v3
  v_smfmac_f32_16x16x64_bf16 v[44:47], v[52:55], a[248:255], v3
  v_smfmac_f32_16x16x64_bf16 v[20:23], v[48:51], a[192:199], v3
  v_smfmac_f32_16x16x64_bf16 v[24:27], v[48:51], a[200:207], v3
  v_smfmac_f32_16x16x64_bf16 v[20:23], v[52:55], a[224:231], v3
  v_add_f32 v44, v44, v45
  v_add_f32 v46, v46, v47
  v_smfmac_f32_16x16x64_bf16 v[24:27], v[52:55], a[232:239], v3
  s_waitcnt lgkmcnt(4)
  v_smfmac_f32_16x16x64_bf16 v[32:35], v[48:51], v[56:63], v3
  ds_read_b128 v[56:59], v1 offset:32768
  ds_read_b128 v[60:63], v1 offset:33792
  v_cvt_pk_bf16_f32 v44, v44, v46
  s_waitcnt lgkmcnt(4)
  v_smfmac_f32_16x16x64_bf16 v[28:31], v[52:55], v[64:71], v3
  ds_read_b128 v[64:67], v1 offset:34816
  ds_read_b128 v[68:71], v1 offset:35840
  v_add_f32 v12, v12, v13
  v_add_f32 v14, v14, v15
  v_smfmac_f32_16x16x64_bf16 v[36:39], v[48:51], a[208:215], v3
  buffer_store_dword v44, v7, s[40:43], s81 offen offset:512
  v_cvt_pk_bf16_f32 v12, v12, v14
  v_add_f32 v16, v16, v17
  v_add_f32 v18, v18, v19
  s_waitcnt lgkmcnt(4)
  v_smfmac_f32_16x16x64_bf16 v[32:35], v[52:55], v[72:79], v3
  buffer_store_dword v12, v7, s[40:43], s50 offen offset:1024
  v_smfmac_f32_16x16x64_bf16 v[40:43], v[48:51], a[216:223], v3
  v_cvt_pk_bf16_f32 v16, v16, v18
  v_add_f32 v20, v20, v21
  v_add_f32 v22, v22, v23
  buffer_store_dword v16, v7, s[40:43], s50 offen offset:1280
  v_cvt_pk_bf16_f32 v20, v20, v22
  v_add_f32 v24, v24, v25
  v_add_f32 v26, v26, v27
  s_waitcnt lgkmcnt(2)
  v_smfmac_f32_16x16x64_bf16 v[36:39], v[52:55], v[56:63], v3
  buffer_store_dword v20, v7, s[40:43], s50 offen offset:3072
  v_cvt_pk_bf16_f32 v24, v24, v26
  v_add_f32 v28, v28, v29
  v_add_f32 v30, v30, v31
  buffer_store_dword v24, v7, s[40:43], s50 offen offset:3328
  s_waitcnt lgkmcnt(0)
  v_smfmac_f32_16x16x64_bf16 v[40:43], v[52:55], v[64:71], v3
  v_cvt_pk_bf16_f32 v28, v28, v30
  v_add_f32 v32, v32, v33
  v_add_f32 v34, v34, v35
  buffer_store_dword v28, v7, s[40:43], s51 offen offset:1024
  v_cvt_pk_bf16_f32 v32, v32, v34
  v_add_f32 v36, v36, v37
  v_add_f32 v38, v38, v39
  buffer_store_dword v32, v7, s[40:43], s51 offen offset:1280
  v_cvt_pk_bf16_f32 v36, v36, v38
  v_add_f32 v40, v40, v41
  v_add_f32 v42, v42, v43
  buffer_store_dword v36, v7, s[40:43], s51 offen offset:3072
  v_cvt_pk_bf16_f32 v40, v40, v42
  buffer_store_dword v40, v7, s[40:43], s51 offen offset:3328
  s_cmp_eq_u32 s36, 63
  s_cbranch_scc1 .Lconcat_heads__mha_block__memory_aug_recurrent_mem_tr__prompt_kernelrec_w2_exit
  s_cmp_eq_u32 s37, 0
  s_cbranch_scc1 .Lconcat_heads__mha_block__memory_aug_recurrent_mem_tr__prompt_kernelrec_w2_nojob
  s_nop 7
  s_nop 7
  s_nop 7
  s_nop 7
  s_nop 7
  s_nop 7
  s_nop 1
  buffer_load_dwordx4 v[12:15], v8, s[40:43], s52 offen sc1
  buffer_load_dwordx4 v[16:19], v8, s[40:43], s53 offen sc1
  buffer_load_dwordx4 v[20:23], v8, s[40:43], s54 offen sc1
  buffer_load_dwordx4 v[24:27], v8, s[40:43], s55 offen sc1
  v_lshrrev_b32 v36, 4, v0
  v_and_b32 v37, 1, v36
  v_lshlrev_b32 v37, 4, v37
  v_mov_b32 v38, 0x3f80
  v_lshlrev_b32 v37, v37, v38
  v_bfe_u32 v36, v36, 1, 2
  v_cmp_eq_u32 vcc, 0, v36
  s_nop 1
  v_cndmask_b32 v28, 0, v37, vcc
  v_cmp_eq_u32 vcc, 1, v36
  s_nop 1
  v_cndmask_b32 v29, 0, v37, vcc
  v_cmp_eq_u32 vcc, 2, v36
  s_nop 1
  v_cndmask_b32 v30, 0, v37, vcc
  v_cmp_eq_u32 vcc, 3, v36
  s_nop 1
  v_cndmask_b32 v31, 0, v37, vcc
  s_add_u32 s64, s64, 524288
  s_add_u32 s65, s65, 524288
  s_add_u32 s66, s66, 262144
  s_mov_b32 s68, 400000
  s_lshl_b32 s74, s35, 31
  s_and_b32 s74, s74, 0x1800
  s_add_u32 s58, s64, 524288
  s_add_u32 s58, s58, s74
  s_cmp_ge_u32 s36, 62
  s_cselect_b32 s58, 1073741824, s58
  s_lshl_b32 s74, s36, 7
  s_lshl_b32 s75, s34, 2
  s_add_u32 s74, s74, s75
  s_add_u32 s90, s74, 70008832
  s_min_u32 s75, s36, 60
  s_lshl_b32 s75, s75, 7
  s_lshl_b32 s74, s34, 2
  s_add_u32 s74, s74, s75
  s_add_u32 s91, s74, 69992832
  ds_read_b128 v[56:59], v1 offset:8192
  ds_read_b128 v[60:63], v1 offset:9216
  ds_read_b128 v[64:67], v1 offset:10240
  ds_read_b128 v[68:71], v1 offset:11264
  v_mov_b64 v[36:37], 0
  v_mov_b64 v[38:39], 0
  v_mov_b64 v[40:41], 0
  v_mov_b64 v[42:43], 0
  v_mov_b64 v[44:45], 0
  v_and_b32 v46, 0xf0, v0
  s_mov_b64 s[76:77], -1
.Lconcat_heads__mha_block__memory_aug_recurrent_mem_tr__prompt_kernelrec_w2_pl:
  s_mov_b64 exec, s[76:77]
  buffer_load_dwordx4 v[12:15], v8, s[40:43], s52 offen sc1
  buffer_load_dwordx4 v[16:19], v8, s[40:43], s53 offen sc1
  buffer_load_dwordx4 v[20:23], v8, s[40:43], s54 offen sc1
  buffer_load_dwordx4 v[24:27], v8, s[40:43], s55 offen sc1
  s_mov_b64 exec, -1
  s_add_u32 s69, s69, 1
  s_sub_u32 s68, s68, 1
  s_cmp_eq_u32 s68, 0
  s_cbranch_scc1 .Lconcat_heads__mha_block__memory_aug_recurrent_mem_tr__prompt_kernelrec_w2_exit
  s_waitcnt vmcnt(7)
  v_mfma_f32_16x16x32_bf16 v[32:35], v[28:31], v[12:15], 0
  s_waitcnt vmcnt(6)
  v_mfma_f32_16x16x32_bf16 v[32:35], v[28:31], v[16:19], v[32:35]
  s_waitcnt vmcnt(5)
  v_mfma_f32_16x16x32_bf16 v[32:35], v[28:31], v[20:23], v[32:35]
  s_waitcnt vmcnt(4)
  v_mfma_f32_16x16x32_bf16 v[32:35], v[28:31], v[24:27], v[32:35]
  v_max3_u32 v48, v12, v13, v14
  v_max3_u32 v49, v15, v16, v17
  v_max3_u32 v48, v48, v18, v19
  v_max3_u32 v49, v49, v20, v21
  v_max3_u32 v48, v48, v22, v23
  v_max3_u32 v49, v49, v24, v25
  v_max3_u32 v48, v48, v26, v27
  v_max_u32 v48, v48, v49
  v_cmp_eq_u32 s[76:77], -1, v48
  v_add_f32_dpp v32, v32, v32 row_ror:8 row_mask:0xf bank_mask:0xf
  v_add_f32_dpp v33, v33, v33 row_ror:8 row_mask:0xf bank_mask:0xf
  v_add_f32_dpp v34, v34, v34 row_ror:8 row_mask:0xf bank_mask:0xf
  v_add_f32_dpp v35, v35, v35 row_ror:8 row_mask:0xf bank_mask:0xf
  v_cmp_u_f32 vcc, v32, v32
  s_cbranch_vccnz .Lconcat_heads__mha_block__memory_aug_recurrent_mem_tr__prompt_kernelrec_w2_pl
.Lconcat_heads__mha_block__memory_aug_recurrent_mem_tr__prompt_kernelrec_w2_pub:
  v_cvt_pk_bf16_f32 v28, v32, v34
  v_cvt_pk_bf16_f32 v29, v33, v35
  v_cndmask_b32 v28, v29, v28, s[100:101]
  s_mov_b64 exec, s[70:71]
  buffer_store_dword v28, v11, s[40:43], s49 offen
  s_mov_b64 exec, -1
  v_mov_b64 v[32:33], 0
  v_mov_b64 v[34:35], 0
  s_branch .Lconcat_heads__mha_block__memory_aug_recurrent_mem_tr__prompt_kernelrec_w2_gpre
.Lconcat_heads__mha_block__memory_aug_recurrent_mem_tr__prompt_kernelrec_w2_nojob:
  s_add_u32 s64, s64, 524288
  s_add_u32 s65, s65, 524288
  s_add_u32 s66, s66, 262144
  s_mov_b32 s68, 400000
  s_lshl_b32 s74, s35, 31
  s_and_b32 s74, s74, 0x1800
  s_add_u32 s58, s64, 524288
  s_add_u32 s58, s58, s74
  s_cmp_ge_u32 s36, 62
  s_cselect_b32 s58, 1073741824, s58
  s_lshl_b32 s74, s36, 7
  s_lshl_b32 s75, s34, 2
  s_add_u32 s74, s74, s75
  s_add_u32 s90, s74, 70008832
  s_min_u32 s75, s36, 60
  s_lshl_b32 s75, s75, 7
  s_lshl_b32 s74, s34, 2
  s_add_u32 s74, s74, s75
  s_add_u32 s91, s74, 69992832
  ds_read_b128 v[56:59], v1 offset:8192
  ds_read_b128 v[60:63], v1 offset:9216
  ds_read_b128 v[64:67], v1 offset:10240
  ds_read_b128 v[68:71], v1 offset:11264
  v_mov_b64 v[32:33], 0
  v_mov_b64 v[34:35], 0
  v_mov_b64 v[36:37], 0
  v_mov_b64 v[38:39], 0
  v_mov_b64 v[40:41], 0
  v_mov_b64 v[42:43], 0
  v_mov_b64 v[44:45], 0
  v_and_b32 v46, 0xf0, v0
  s_nop 7
  s_nop 7
  s_nop 7
  s_nop 7
  s_nop 7
  s_nop 7
  s_nop 7
  s_nop 7
  s_nop 7
  s_nop 7
  s_nop 7
  s_nop 7
  s_nop 7
  s_nop 7
  s_nop 7
  s_nop 7
  s_nop 7
  s_nop 7
  s_nop 7
  s_nop 7
  s_nop 7
  s_nop 6
.Lconcat_heads__mha_block__memory_aug_recurrent_mem_tr__prompt_kernelrec_w2_gpre:
  buffer_load_dwordx4 v[12:15], v0, s[40:43], s61 offen sc1
  buffer_load_dwordx4 v[16:19], v0, s[40:43], s62 offen sc1
  buffer_load_dwordx4 v[20:23], v46, s[40:43], s63 offen sc1
  s_add_u32 s36, s36, 1
  s_nop 7
  s_nop 7
  s_nop 7
  s_nop 0
  s_mov_b64 vcc, -1
  s_branch .Lconcat_heads__mha_block__memory_aug_recurrent_mem_tr__prompt_kernelrec_w2_gl
.Lconcat_heads__mha_block__memory_aug_recurrent_mem_tr__prompt_kernelrec_w2_exit:
  s_branch .Lconcat_heads__mha_block__memory_aug_recurrent_mem_tr__prompt_kernelrec_done
.Lconcat_heads__mha_block__memory_aug_recurrent_mem_tr__prompt_kernelrec_w3:
  s_add_u32 s58, s64, 524288
  s_mov_b32 m0, 161792
  ds_read_b128 v[56:59], v1 offset:12288
  ds_read_b128 v[60:63], v1 offset:13312
  ds_read_b128 v[64:67], v1 offset:14336
  ds_read_b128 v[68:71], v1 offset:15360
  v_mov_b64 v[32:33], 0
  v_mov_b64 v[34:35], 0
  v_mov_b64 v[36:37], 0
  v_mov_b64 v[38:39], 0
  v_mov_b64 v[40:41], 0
  v_mov_b64 v[42:43], 0
  v_mov_b64 v[44:45], 0
  v_mov_b32 v11, 1
  s_mov_b32 s68, 400000
  s_waitcnt lgkmcnt(0)
  s_branch .Lconcat_heads__mha_block__memory_aug_recurrent_mem_tr__prompt_kernelrec_w3_g0
.Lconcat_heads__mha_block__memory_aug_recurrent_mem_tr__prompt_kernelrec_w3_gl:
  s_mov_b64 exec, vcc
  buffer_load_dwordx4 v[12:15], v0, s[40:43], s61 offen sc1
  buffer_load_dwordx4 v[16:19], v0, s[40:43], s62 offen sc1
  buffer_load_dwordx4 v[20:23], v46, s[40:43], s63 offen sc1
  s_mov_b64 exec, -1
  s_add_u32 s73, s73, 1
  s_sub_u32 s68, s68, 1
  s_cmp_eq_u32 s68, 0
  s_cbranch_scc1 .Lconcat_heads__mha_block__memory_aug_recurrent_mem_tr__prompt_kernelrec_w3_exit
  s_waitcnt vmcnt(3)
.Lconcat_heads__mha_block__memory_aug_recurrent_mem_tr__prompt_kernelrec_w3_g0:
  v_max3_u32 v24, v12, v13, v14
  v_max3_u32 v26, v15, v16, v17
  v_max3_u32 v24, v24, v18, v19
  v_max3_u32 v26, v26, v20, v21
  v_max3_u32 v24, v24, v22, v23
  v_max_u32 v24, v24, v26
  v_cmp_eq_u32 vcc, -1, v24
  s_cbranch_vccnz .Lconcat_heads__mha_block__memory_aug_recurrent_mem_tr__prompt_kernelrec_w3_gl
  ds_write_b128 v2, v[12:15] offset:3072
  ds_write_b128 v2, v[16:19] offset:7168
  s_mov_b64 exec, 0xffff
  ds_write_b128 v2, v[20:23] offset:8960
  s_mov_b64 exec, -1
.Lconcat_heads__mha_block__memory_aug_recurrent_mem_tr__prompt_kernelrec_w3_have:
  v_mov_b64 v[46:47], 0
  buffer_load_dwordx4 v[48:51], v0, s[44:47], s64 offen sc1
  s_waitcnt lgkmcnt(3)
  v_smfmac_f32_16x16x64_bf16 v[36:39], v[12:15], v[64:71], v3
  ds_read_b128 v[64:67], v1 offset:18432
  ds_read_b128 v[68:71], v1 offset:19456
  buffer_load_dwordx4 v[52:55], v0, s[44:47], s64 offen offset:1024 sc1
  v_smfmac_f32_16x16x64_bf16 v[32:35], v[12:15], v[56:63], v3
  ds_read_b128 v[56:59], v1 offset:16384
  ds_read_b128 v[60:63], v1 offset:17408
  v_lshrrev_b32 v6, 7, v0
  v_smfmac_f32_16x16x64_bf16 v[36:39], v[16:19], v[136:143], v3
  s_add_u32 s76, s36, 3
  s_and_b32 s76, s76, 3
  v_lshlrev_b32 v6, 12, v6
  v_smfmac_f32_16x16x64_bf16 v[32:35], v[16:19], v[128:135], v3
  s_mul_i32 s77, s76, 294912
  s_add_u32 s59, s77, s67
  s_waitcnt lgkmcnt(4)
  s_barrier
  ds_read_b128 v[24:27], v2 offset:8192
  ds_read_b128 v[28:31], v2 offset:4096
  ds_read_b128 v[76:79], v2 offset:0
  v_smfmac_f32_16x16x64_bf16 v[40:43], v[12:15], v[192:199], v3
  s_add_u32 s78, s59, 4096
  s_mul_i32 s77, s76, 9216
  v_and_b32 v72, 0x70, v0
  v_smfmac_f32_16x16x64_bf16 v[44:47], v[12:15], v[200:207], v3
  s_lshl_b32 s76, s34, 7
  s_add_u32 s77, s77, s76
  v_add_u32 v6, v6, v72
  v_smfmac_f32_16x16x64_bf16 v[40:43], v[16:19], a[0:7], v3
  s_add_u32 s87, s77, 1179648
  s_and_b32 s74, s36, 3
  v_mov_b64 v[72:73], -1
  v_smfmac_f32_16x16x64_bf16 v[44:47], v[16:19], a[8:15], v3
  s_mul_i32 s48, s74, 294912
  s_add_u32 s50, s48, s67
  v_mov_b64 v[74:75], -1
  buffer_store_dwordx4 v[72:75], v0, s[40:43], s59 offen offset:3072
  buffer_store_dwordx4 v[72:75], v0, s[40:43], s78 offen offset:3072
  s_waitcnt lgkmcnt(2)
  v_smfmac_f32_16x16x64_bf16 v[36:39], v[24:27], v[64:71], v3
  ds_read_b128 v[64:67], v1 offset:2048
  ds_read_b128 v[68:71], v1 offset:3072
  v_smfmac_f32_16x16x64_bf16 v[32:35], v[24:27], v[56:63], v3
  ds_read_b128 v[56:59], v1 offset:0
  ds_read_b128 v[60:63], v1 offset:1024
  v_smfmac_f32_16x16x64_bf16 v[40:43], v[24:27], a[16:23], v3
  s_mov_b64 exec, s[82:83]
  buffer_store_dwordx4 v[72:75], v6, s[40:43], s87 offen
  s_mov_b64 exec, -1
  v_smfmac_f32_16x16x64_bf16 v[44:47], v[24:27], a[24:31], v3
  ds_read_b128 v[24:27], v2 offset:5120
  s_add_u32 s81, s50, 8192
  s_waitcnt lgkmcnt(6)
  v_smfmac_f32_16x16x64_bf16 v[36:39], v[28:31], v[88:95], v3
  s_add_u32 s51, s50, 4096
  s_add_u32 s75, s36, 1
  v_smfmac_f32_16x16x64_bf16 v[32:35], v[28:31], v[80:87], v3
  s_and_b32 s75, s75, 3
  s_mul_i32 s75, s75, 9216
  v_smfmac_f32_16x16x64_bf16 v[40:43], v[28:31], v[208:215], v3
  s_add_u32 s49, s75, 1179648
  s_add_u32 s61, s49, s56
  v_smfmac_f32_16x16x64_bf16 v[44:47], v[28:31], v[216:223], v3
  ds_read_b128 v[28:31], v2 offset:1024
  s_add_u32 s62, s61, 4096
  s_waitcnt lgkmcnt(4)
  v_smfmac_f32_16x16x64_bf16 v[36:39], v[76:79], v[64:71], v3
  ds_read_b128 v[64:67], v1 offset:6144
  ds_read_b128 v[68:71], v1 offset:7168
  v_smfmac_f32_16x16x64_bf16 v[40:43], v[76:79], v[144:151], v3
  s_add_u32 s63, s49, s57
  s_waitcnt lgkmcnt(4)
  v_smfmac_f32_16x16x64_bf16 v[32:35], v[76:79], v[56:63], v3
  ds_read_b128 v[56:59], v1 offset:4096
  ds_read_b128 v[60:63], v1 offset:5120
  v_smfmac_f32_16x16x64_bf16 v[44:47], v[76:79], v[152:159], v3
  ds_read_b128 v[76:79], v2 offset:6144
  s_waitcnt lgkmcnt(6)
  v_smfmac_f32_16x16x64_bf16 v[36:39], v[24:27], v[104:111], v3
  v_smfmac_f32_16x16x64_bf16 v[32:35], v[24:27], v[96:103], v3
  v_smfmac_f32_16x16x64_bf16 v[40:43], v[24:27], v[224:231], v3
  v_smfmac_f32_16x16x64_bf16 v[44:47], v[24:27], v[232:239], v3
  ds_read_b128 v[24:27], v2 offset:2048
  s_waitcnt lgkmcnt(6)
  v_smfmac_f32_16x16x64_bf16 v[40:43], v[28:31], v[160:167], v3
  s_waitcnt lgkmcnt(4)
  v_smfmac_f32_16x16x64_bf16 v[36:39], v[28:31], v[64:71], v3
  ds_read_b128 v[64:67], v1 offset:10240
  ds_read_b128 v[68:71], v1 offset:11264
  v_smfmac_f32_16x16x64_bf16 v[44:47], v[28:31], v[168:175], v3
  s_waitcnt lgkmcnt(4)
  v_smfmac_f32_16x16x64_bf16 v[32:35], v[28:31], v[56:63], v3
  ds_read_b128 v[56:59], v1 offset:8192
  ds_read_b128 v[60:63], v1 offset:9216
  s_waitcnt lgkmcnt(5)
  v_smfmac_f32_16x16x64_bf16 v[36:39], v[76:79], v[120:127], v3
  v_smfmac_f32_16x16x64_bf16 v[32:35], v[76:79], v[112:119], v3
  v_smfmac_f32_16x16x64_bf16 v[40:43], v[76:79], v[240:247], v3
  v_smfmac_f32_16x16x64_bf16 v[44:47], v[76:79], v[248:255], v3
  s_waitcnt lgkmcnt(4)
  v_smfmac_f32_16x16x64_bf16 v[40:43], v[24:27], v[176:183], v3
  v_smfmac_f32_16x16x64_bf16 v[44:47], v[24:27], v[184:191], v3
  s_waitcnt lgkmcnt(2)
  v_smfmac_f32_16x16x64_bf16 v[36:39], v[24:27], v[64:71], v3
  buffer_load_dwordx4 v[64:67], v0, s[44:47], s65 offen sc1
  buffer_load_dwordx4 v[68:71], v0, s[44:47], s65 offen offset:1024 sc1
  s_waitcnt vmcnt(8)
  v_cvt_pk_bf16_f32 v16, v40, v41
  s_waitcnt lgkmcnt(0)
  v_smfmac_f32_16x16x64_bf16 v[32:35], v[24:27], v[56:63], v3
  buffer_load_dword v8, off, s[44:47], s91 sc1
  s_nop 0
  v_cvt_pk_bf16_f32 v14, v36, v37
  v_cvt_pk_bf16_f32 v15, v38, v39
  v_cvt_pk_bf16_f32 v17, v42, v43
  v_cvt_pk_bf16_f32 v18, v44, v45
  s_nop 1
  v_cvt_pk_bf16_f32 v12, v32, v33
  v_cvt_pk_bf16_f32 v13, v34, v35
  v_cvt_pk_bf16_f32 v19, v46, v47
  v_mfma_f32_16x16x16_bf16 v[36:39], v[14:15], v[4:5], 0
  v_mov_b64 v[56:57], 0
  v_mov_b64 v[58:59], 0
  v_mov_b64 v[60:61], 0
  v_mfma_f32_16x16x16_bf16 v[32:35], v[12:13], v[4:5], 0
  v_mov_b64 v[62:63], 0
  s_mov_b64 exec, 1
  buffer_store_dword v11, off, s[44:47], s90 sc1
  s_mov_b64 exec, -1
  v_mfma_f32_16x16x16_bf16 v[40:43], v[16:17], v[4:5], 0
  v_cvt_pk_bf16_f32 v14, v36, v37
  s_nop 1
  v_cvt_pk_bf16_f32 v12, v32, v33
  v_cvt_pk_bf16_f32 v13, v34, v35
  v_mfma_f32_16x16x16_bf16 v[44:47], v[18:19], v[4:5], 0
  v_cvt_pk_bf16_f32 v15, v38, v39
  v_smfmac_f32_16x16x64_bf16 v[56:59], v[28:31], a[48:55], v3
  v_cvt_pk_bf16_f32 v16, v40, v41
  v_cvt_pk_bf16_f32 v17, v42, v43
  s_nop 1
  v_cvt_pk_bf16_f32 v18, v44, v45
  v_cvt_pk_bf16_f32 v19, v46, v47
  s_waitcnt vmcnt(8)
  v_mfma_f32_16x16x32_bf16 v[36:39], v[48:51], v[12:15], 0
  buffer_store_dwordx4 v[16:19], v0, s[44:47], s66 offen sc1
  s_waitcnt vmcnt(8)
  v_mfma_f32_16x16x32_bf16 v[40:43], v[52:55], v[12:15], 0
  v_smfmac_f32_16x16x64_bf16 v[60:63], v[28:31], a[56:63], v3
  v_smfmac_f32_16x16x64_bf16 v[56:59], v[76:79], a[128:135], v3
  v_cndmask_b32 v36, v40, v36, s[84:85]
  v_mfma_f32_16x16x32_bf16 v[32:35], v[16:19], v[12:15], 0
  v_cndmask_b32 v37, v41, v37, s[84:85]
  v_cndmask_b32 v38, v42, v38, s[84:85]
  v_cndmask_b32 v39, v43, v39, s[84:85]
  ds_write_b128 v2, v[36:39] offset:14336
  ds_read_b128 v[28:31], v2 offset:3072
  s_mov_b64 exec, s[84:85]
  s_nop 1
  ds_write2_b32 v10, v32, v34 offset0:192 offset1:193
  s_mov_b64 exec, -1
  v_smfmac_f32_16x16x64_bf16 v[60:63], v[76:79], a[136:143], v3
  ds_read_b128 v[20:23], v2 offset:7168
  ds_read_b128 v[76:79], v1 offset:25600
  v_smfmac_f32_16x16x64_bf16 v[56:59], v[24:27], a[64:71], v3
  v_smfmac_f32_16x16x64_bf16 v[60:63], v[24:27], a[72:79], v3
  ds_read_b128 v[24:27], v2 offset:8192
  v_mov_b64 v[16:17], 0
  v_mov_b64 v[18:19], 0
  s_waitcnt lgkmcnt(3)
  s_barrier
  ds_read_b128 v[40:43], v2 offset:11264
  ds_read_b128 v[44:47], v2 offset:12288
  ds_read_b128 v[48:51], v2 offset:13312
  ds_read_b64 v[52:53], v10 offset:0
  ds_read_b64 v[72:73], v10 offset:256
  ds_read_b64 v[12:13], v10 offset:512
  v_smfmac_f32_16x16x64_bf16 v[56:59], v[28:31], a[80:87], v3
  v_smfmac_f32_16x16x64_bf16 v[60:63], v[28:31], a[88:95], v3
  ds_read_b128 v[28:31], v2 offset:4096
  s_waitcnt lgkmcnt(9)
  v_smfmac_f32_16x16x64_bf16 v[56:59], v[20:23], a[144:151], v3
  v_smfmac_f32_16x16x64_bf16 v[60:63], v[20:23], a[152:159], v3
  ds_read_b128 v[20:23], v2 offset:0
  s_waitcnt lgkmcnt(8)
  v_smfmac_f32_16x16x64_bf16 v[56:59], v[24:27], a[160:167], v3
  v_smfmac_f32_16x16x64_bf16 v[60:63], v[24:27], a[168:175], v3
  ds_read_b128 v[24:27], v2 offset:5120
  s_waitcnt lgkmcnt(8)
  v_add_f32 v36, v36, v40
  v_add_f32 v37, v37, v41
  v_add_f32 v38, v38, v42
  v_add_f32 v39, v39, v43
  s_waitcnt lgkmcnt(6)
  v_pk_add_f32 v[44:45], v[44:45], v[48:49]
  v_pk_add_f32 v[46:47], v[46:47], v[50:51]
  v_pk_add_f32 v[36:37], v[36:37], v[44:45]
  v_pk_add_f32 v[38:39], v[38:39], v[46:47]
  s_waitcnt lgkmcnt(4)
  v_pk_add_f32 v[52:53], v[52:53], v[72:73]
  s_waitcnt lgkmcnt(3)
  v_add_f32 v32, v32, v12
  v_add_f32 v34, v34, v13
  v_add_f32 v32, v32, v52
  v_add_f32 v34, v34, v53
  v_max3_f32 v72, v36, v37, v38
  v_max3_f32 v73, v39, v32, v34
  v_max_f32 v72, v72, v73
  s_waitcnt lgkmcnt(2)
  v_smfmac_f32_16x16x64_bf16 v[56:59], v[28:31], a[96:103], v3
  v_max_f32_dpp v72, v72, v72 quad_perm:[1,0,3,2] row_mask:0xf bank_mask:0xf
  v_mov_b32 v73, v72
  v_smfmac_f32_16x16x64_bf16 v[60:63], v[28:31], a[104:111], v3
  s_nop 0
  v_permlane16_swap_b32 v72, v73
  v_max_f32 v72, v72, v73
  v_mov_b32 v73, v72
  s_waitcnt lgkmcnt(1)
  v_smfmac_f32_16x16x64_bf16 v[56:59], v[20:23], a[32:39], v3
  v_permlane32_swap_b32 v72, v73
  v_max_f32 v72, v72, v73
  v_mul_f32 v72, s80, v72
  v_fma_f32 v36, v36, s88, -v72
  v_fma_f32 v37, v37, s88, -v72
  v_pk_fma_f32 v[38:39], v[38:39], s[88:89], v[72:73] op_sel_hi:[1,1,0] neg_lo:[0,0,1] neg_hi:[0,0,1]
  v_fma_f32 v32, v32, s80, -v72
  v_fma_f32 v34, v34, s80, -v72
  v_exp_f32 v36, v36
  v_exp_f32 v37, v37
  v_exp_f32 v38, v38
  v_exp_f32 v39, v39
  v_smfmac_f32_16x16x64_bf16 v[60:63], v[20:23], a[40:47], v3
  v_exp_f32 v32, v32
  v_exp_f32 v34, v34
  v_add_f32 v73, v36, v37
  v_add_f32 v74, v38, v39
  v_add_f32 v75, v32, v34
  v_add_f32 v73, v73, v74
  s_waitcnt lgkmcnt(0)
  v_smfmac_f32_16x16x64_bf16 v[56:59], v[24:27], a[112:119], v3
  v_smfmac_f32_16x16x64_bf16 v[60:63], v[24:27], a[120:127], v3
  v_fmac_f32 v73, 0.5, v75
  v_cvt_pk_bf16_f32 v40, v36, v37
  v_cvt_pk_bf16_f32 v41, v38, v39
  v_add_f32_dpp v73, v73, v73 quad_perm:[1,0,3,2] row_mask:0xf bank_mask:0xf
  v_mov_b32_dpp v42, v40 quad_perm:[1,0,3,2] row_mask:0xf bank_mask:0xf
  v_mov_b32_dpp v43, v41 quad_perm:[1,0,3,2] row_mask:0xf bank_mask:0xf
  v_mov_b32 v74, v73
  s_waitcnt vmcnt(4)
  v_mfma_f32_16x16x32_bf16 v[52:55], v[64:67], v[40:43], 0
  ds_read_b128 v[64:67], v1 offset:22528
  v_permlane16_swap_b32 v73, v74
  s_waitcnt vmcnt(3)
  v_mfma_f32_16x16x32_bf16 v[12:15], v[68:71], v[40:43], 0
  ds_read_b128 v[68:71], v1 offset:23552
  v_cvt_pk_bf16_f32 v44, v32, v32
  v_cvt_pk_bf16_f32 v45, v34, v34
  v_cvt_pk_bf16_f32 v48, v56, v57
  v_cvt_pk_bf16_f32 v49, v58, v59
  v_cvt_pk_bf16_f32 v50, v60, v61
  v_cvt_pk_bf16_f32 v51, v62, v63
  v_add_f32 v73, v73, v74
  v_mov_b32 v74, v73
  v_mfma_f32_16x16x16_bf16 v[52:55], v[48:49], v[44:45], v[52:55]
  buffer_store_dwordx4 v[48:51], v0, s[44:47], s66 offen offset:1024 sc1
  s_cmp_eq_u32 s36, 63
  s_cbranch_scc1 .Lconcat_heads__mha_block__memory_aug_recurrent_mem_tr__prompt_kernelrec_w3_exit
  v_mfma_f32_16x16x16_bf16 v[12:15], v[50:51], v[44:45], v[12:15]
  v_permlane32_swap_b32 v73, v74
  v_add_f32 v73, v73, v74
  v_rcp_f32 v72, v73
  ds_read_b128 v[56:59], v1 offset:20480
  v_mul_f32 v52, v52, v72
  v_mul_f32 v53, v53, v72
  v_pk_mul_f32 v[54:55], v[54:55], v[72:73] op_sel_hi:[1,0]
  s_nop 0
  v_pk_mul_f32 v[12:13], v[12:13], v[72:73] op_sel_hi:[1,0]
  v_pk_mul_f32 v[14:15], v[14:15], v[72:73] op_sel_hi:[1,0]
  v_cvt_pk_bf16_f32 v44, v52, v53
  v_cvt_pk_bf16_f32 v45, v54, v55
  v_cvt_pk_bf16_f32 v46, v12, v13
  v_cvt_pk_bf16_f32 v47, v14, v15
  s_mov_b64 exec, s[84:85]
  ds_write_b64 v9, v[44:45] offset:1536
  ds_write_b64 v9, v[46:47] offset:1792
  s_mov_b64 exec, -1
  ds_read_b128 v[60:63], v1 offset:21504
  v_mov_b64 v[12:13], 0
  v_mov_b64 v[14:15], 0
  ds_read_b128 v[72:75], v1 offset:24576
  v_mov_b64 v[28:29], 0
  v_mov_b64 v[30:31], 0
  v_mov_b64 v[32:33], 0
  v_mov_b64 v[34:35], 0
  v_mov_b64 v[44:45], 0
  v_mov_b64 v[46:47], 0
  s_waitcnt lgkmcnt(2)
  s_barrier
  ds_read_b128 v[48:51], v2 offset:9216
  ds_read_b128 v[52:55], v2 offset:10240
  v_mov_b64 v[20:21], 0
  v_mov_b64 v[22:23], 0
  v_mov_b64 v[24:25], 0
  v_mov_b64 v[26:27], 0
  v_mov_b64 v[36:37], 0
  v_mov_b64 v[38:39], 0
  v_mov_b64 v[40:41], 0
  v_mov_b64 v[42:43], 0
  s_waitcnt vmcnt(3)
  v_cmp_eq_u32 s[38:39], 0, v8
  s_waitcnt lgkmcnt(1)
  v_smfmac_f32_16x16x64_bf16 v[12:15], v[48:51], a[176:183], v3
  v_smfmac_f32_16x16x64_bf16 v[16:19], v[48:51], a[184:191], v3
  s_waitcnt lgkmcnt(0)
  v_smfmac_f32_16x16x64_bf16 v[12:15], v[52:55], v[56:63], v3
  ds_read_b128 v[56:59], v1 offset:26624
  ds_read_b128 v[60:63], v1 offset:27648
  v_smfmac_f32_16x16x64_bf16 v[16:19], v[52:55], v[64:71], v3
  ds_read_b128 v[64:67], v1 offset:28672
  ds_read_b128 v[68:71], v1 offset:29696
  v_smfmac_f32_16x16x64_bf16 v[28:31], v[48:51], v[72:79], v3
  ds_read_b128 v[72:75], v1 offset:30720
  ds_read_b128 v[76:79], v1 offset:31744
  v_smfmac_f32_16x16x64_bf16 v[44:47], v[48:51], a[240:247], v3
  v_smfmac_f32_16x16x64_bf16 v[44:47], v[52:55], a[248:255], v3
  v_smfmac_f32_16x16x64_bf16 v[20:23], v[48:51], a[192:199], v3
  v_smfmac_f32_16x16x64_bf16 v[24:27], v[48:51], a[200:207], v3
  v_smfmac_f32_16x16x64_bf16 v[20:23], v[52:55], a[224:231], v3
  v_add_f32 v44, v44, v45
  v_add_f32 v46, v46, v47
  v_smfmac_f32_16x16x64_bf16 v[24:27], v[52:55], a[232:239], v3
  s_waitcnt lgkmcnt(4)
  v_smfmac_f32_16x16x64_bf16 v[32:35], v[48:51], v[56:63], v3
  ds_read_b128 v[56:59], v1 offset:32768
  ds_read_b128 v[60:63], v1 offset:33792
  v_cvt_pk_bf16_f32 v44, v44, v46
  s_waitcnt lgkmcnt(4)
  v_smfmac_f32_16x16x64_bf16 v[28:31], v[52:55], v[64:71], v3
  ds_read_b128 v[64:67], v1 offset:34816
  ds_read_b128 v[68:71], v1 offset:35840
  v_add_f32 v12, v12, v13
  v_add_f32 v14, v14, v15
  v_smfmac_f32_16x16x64_bf16 v[36:39], v[48:51], a[208:215], v3
  buffer_store_dword v44, v7, s[40:43], s81 offen offset:768
  v_cvt_pk_bf16_f32 v12, v12, v14
  v_add_f32 v16, v16, v17
  v_add_f32 v18, v18, v19
  s_waitcnt lgkmcnt(4)
  v_smfmac_f32_16x16x64_bf16 v[32:35], v[52:55], v[72:79], v3
  buffer_store_dword v12, v7, s[40:43], s50 offen offset:1536
  v_smfmac_f32_16x16x64_bf16 v[40:43], v[48:51], a[216:223], v3
  v_cvt_pk_bf16_f32 v16, v16, v18
  v_add_f32 v20, v20, v21
  v_add_f32 v22, v22, v23
  buffer_store_dword v16, v7, s[40:43], s50 offen offset:1792
  v_cvt_pk_bf16_f32 v20, v20, v22
  v_add_f32 v24, v24, v25
  v_add_f32 v26, v26, v27
  s_waitcnt lgkmcnt(2)
  v_smfmac_f32_16x16x64_bf16 v[36:39], v[52:55], v[56:63], v3
  buffer_store_dword v20, v7, s[40:43], s50 offen offset:3584
  v_cvt_pk_bf16_f32 v24, v24, v26
  v_add_f32 v28, v28, v29
  v_add_f32 v30, v30, v31
  buffer_store_dword v24, v7, s[40:43], s50 offen offset:3840
  s_waitcnt lgkmcnt(0)
  v_smfmac_f32_16x16x64_bf16 v[40:43], v[52:55], v[64:71], v3
  v_cvt_pk_bf16_f32 v28, v28, v30
  v_add_f32 v32, v32, v33
  v_add_f32 v34, v34, v35
  buffer_store_dword v28, v7, s[40:43], s51 offen offset:1536
  v_cvt_pk_bf16_f32 v32, v32, v34
  v_add_f32 v36, v36, v37
  v_add_f32 v38, v38, v39
  buffer_store_dword v32, v7, s[40:43], s51 offen offset:1792
  v_cvt_pk_bf16_f32 v36, v36, v38
  v_add_f32 v40, v40, v41
  v_add_f32 v42, v42, v43
  buffer_store_dword v36, v7, s[40:43], s51 offen offset:3584
  v_cvt_pk_bf16_f32 v40, v40, v42
  buffer_store_dword v40, v7, s[40:43], s51 offen offset:3840
  s_cmp_eq_u32 s36, 63
  s_cbranch_scc1 .Lconcat_heads__mha_block__memory_aug_recurrent_mem_tr__prompt_kernelrec_w3_exit
  s_cmp_eq_u64 s[38:39], 0
  s_cbranch_scc1 .Lconcat_heads__mha_block__memory_aug_recurrent_mem_tr__prompt_kernelrec_w3_fok
  s_mov_b32 s75, 4000000
.Lconcat_heads__mha_block__memory_aug_recurrent_mem_tr__prompt_kernelrec_w3_fpoll:
  buffer_load_dword v28, off, s[44:47], s91 sc1
  s_waitcnt vmcnt(0)
  v_readfirstlane_b32 s74, v28
  s_sub_u32 s75, s75, 1
  s_cmp_eq_u32 s75, 0
  s_cbranch_scc1 .Lconcat_heads__mha_block__memory_aug_recurrent_mem_tr__prompt_kernelrec_w3_fok
  s_cmp_eq_u32 s74, 0
  s_cbranch_scc1 .Lconcat_heads__mha_block__memory_aug_recurrent_mem_tr__prompt_kernelrec_w3_fpoll
.Lconcat_heads__mha_block__memory_aug_recurrent_mem_tr__prompt_kernelrec_w3_fok:
  s_add_u32 s64, s64, 524288
  s_add_u32 s65, s65, 524288
  s_add_u32 s66, s66, 262144
  s_mov_b32 s68, 400000
  s_lshl_b32 s74, s35, 31
  s_and_b32 s74, s74, 0x1800
  s_add_u32 s58, s64, 524288
  s_add_u32 s58, s58, s74
  s_cmp_ge_u32 s36, 62
  s_cselect_b32 s58, 1073741824, s58
  s_lshl_b32 s74, s36, 7
  s_lshl_b32 s75, s34, 2
  s_add_u32 s74, s74, s75
  s_add_u32 s90, s74, 70008832
  s_min_u32 s75, s36, 60
  s_lshl_b32 s75, s75, 7
  s_lshl_b32 s74, s34, 2
  s_add_u32 s74, s74, s75
  s_add_u32 s91, s74, 69992832
  ds_read_b128 v[56:59], v1 offset:12288
  ds_read_b128 v[60:63], v1 offset:13312
  ds_read_b128 v[64:67], v1 offset:14336
  ds_read_b128 v[68:71], v1 offset:15360
  v_mov_b64 v[32:33], 0
  v_mov_b64 v[34:35], 0
  v_mov_b64 v[36:37], 0
  v_mov_b64 v[38:39], 0
  v_mov_b64 v[40:41], 0
  v_mov_b64 v[42:43], 0
  v_mov_b64 v[44:45], 0
  v_and_b32 v46, 0xf0, v0
  s_nop 7
  s_nop 7
  s_nop 7
  s_nop 7
  s_nop 7
  s_nop 7
  s_nop 7
  s_nop 7
  s_nop 7
  s_nop 7
  s_nop 7
  s_nop 7
  s_nop 7
  s_nop 7
  s_nop 7
  s_nop 7
  s_nop 7
  s_nop 7
  s_nop 7
  s_nop 7
  s_nop 7
  s_nop 6
.Lconcat_heads__mha_block__memory_aug_recurrent_mem_tr__prompt_kernelrec_w3_gpre:
  buffer_load_dwordx4 v[12:15], v0, s[40:43], s61 offen sc1
  buffer_load_dwordx4 v[16:19], v0, s[40:43], s62 offen sc1
  buffer_load_dwordx4 v[20:23], v46, s[40:43], s63 offen sc1
  s_add_u32 s36, s36, 1
  s_nop 7
  s_nop 7
  s_nop 7
  s_nop 0
  s_mov_b64 vcc, -1
  s_branch .Lconcat_heads__mha_block__memory_aug_recurrent_mem_tr__prompt_kernelrec_w3_gl
.Lconcat_heads__mha_block__memory_aug_recurrent_mem_tr__prompt_kernelrec_w3_exit:
.Lconcat_heads__mha_block__memory_aug_recurrent_mem_tr__prompt_kernelrec_done:
  s_waitcnt vmcnt(0)
  s_barrier
  s_cmp_lg_u32 s35, 3
  s_cbranch_scc1 .Lconcat_heads__mha_block__memory_aug_recurrent_mem_tr__prompt_kernelrec_fin
  s_lshl_b32 s74, s34, 2
  s_add_u32 s74, s74, 70016896
  v_mov_b32 v24, 1
  s_mov_b64 exec, 1
  buffer_store_dword v24, off, s[44:47], s74 sc1
  s_mov_b64 exec, -1
.Lconcat_heads__mha_block__memory_aug_recurrent_mem_tr__prompt_kernelrec_fin:
.Lconcat_heads__mha_block__memory_aug_recurrent_mem_tr__prompt_kernel_end:
  s_endpgm
.section .rodata,"a"
.p2align 6
.amdhsa_kernel concat_heads__mha_block__memory_aug_recurrent_mem_tr__prompt_kernel
  .amdhsa_next_free_vgpr 512
  .amdhsa_next_free_sgpr 102
  .amdhsa_accum_offset 256
  .amdhsa_group_segment_fixed_size 0
  .amdhsa_kernarg_size 104
  .amdhsa_user_sgpr_count 2
  .amdhsa_user_sgpr_kernarg_segment_ptr 1
  .amdhsa_system_sgpr_workgroup_id_x 1
.end_amdhsa_kernel
```
